```python
import torch

def _softmax(x, axis=-1):
    return torch.softmax(x, dim=axis)
def _gelu(x):
    return torch.nn.functional.gelu(x, approximate="tanh")
def _silu(x):
    return torch.nn.functional.silu(x)
def _sigmoid(x):
    return torch.sigmoid(x)
def _layernorm(x, axis=-1, eps=1e-5):
    m = x.mean(dim=axis, keepdim=True)
    v = x.var(dim=axis, keepdim=True, unbiased=False)
    return (x - m) / torch.sqrt(v + eps)
def _scatter_add(tgt, idx, src, axis=0):
    return tgt.clone().index_add_(axis, idx, src)
def _segment_sum(src, seg, n):
    out = torch.zeros((n,) + src.shape[1:], dtype=src.dtype)
    return out.index_add_(0, seg, src)
def _pad(x, pw):
    flat = tuple(v for pair in reversed(pw) for v in pair)
    return torch.nn.functional.pad(x, flat)

kernel_name = 'parallel_sum__softmax_full_mha__mixer_s_mlp__prompt'

def setup_inputs():

    _w = (lambda a: (lambda t: t.to(torch.bfloat16) if t.is_floating_point() else t)(torch.as_tensor(a)))
    def _A_setup():
        B, S, D = 1, 2048, 512
        return {
            "x": _w((lambda *s: torch.randn(*s, dtype=torch.bfloat16) * 0.05)(B, S, D)),
            "wqkv": _w((lambda *s: torch.randn(*s, dtype=torch.bfloat16) * 0.1)(D, 3 * D)),
            "wo": _w((lambda *s: torch.randn(*s, dtype=torch.bfloat16) * 0.05)(D, D)),
        }
    _A_in = _A_setup()

    def _B_setup():
        B, S, D, F = 1, 2048, 512, 1376
        return {
            "x":  _w((lambda *s: torch.randn(*s, dtype=torch.bfloat16) * 0.05)(B, S, D)),
            "w1": _w((lambda *s: torch.randn(*s, dtype=torch.bfloat16) * 3.2)(D, D) * (D ** -0.5)),
            "w2": _w((lambda *s: torch.randn(*s, dtype=torch.bfloat16) * 3.2)(D, D) * (D ** -0.5)),
            "w3": _w((lambda *s: torch.randn(*s, dtype=torch.bfloat16) * 3.2)(D, F) * (D ** -0.5)),
            "w4": _w((lambda *s: torch.randn(*s, dtype=torch.bfloat16) * 3.2)(F, D) * (F ** -0.5)),
        }
    _B_in = _B_setup()

    return {
        "A_x": _A_in["x"],
        "A_wqkv": _A_in["wqkv"],
        "A_wo": _A_in["wo"],
        "B_x": _B_in["x"],
        "B_w1": _B_in["w1"],
        "B_w2": _B_in["w2"],
        "B_w3": _B_in["w3"],
        "B_w4": _B_in["w4"],
    }

def reference(A_x, A_wqkv, A_wo, B_x, B_w1, B_w2, B_w3, B_w4):
    def _A_ref(x, wqkv, wo):
        B, S, D = x.shape
        H = 32; Dh = D // H
        qkv = (lambda x, *d: x.permute(*d))((x @ wqkv).reshape(B, S, 3, H, Dh), 2, 0, 3, 1, 4)
        q, k, v = qkv[0], qkv[1], qkv[2]
        scale = Dh ** -0.5
        scores = torch.einsum("bhqd,bhkd->bhqk", q, k) * scale
        p = _softmax(scores, axis=-1)
        o = torch.einsum("bhqk,bhkd->bhqd", p, v)
        return (lambda x, *d: x.permute(*d))(o, 0, 2, 1, 3).reshape(B, S, D) @ wo

    def _B_ref(x, w1, w2, w3, w4):
        B, S, D = x.shape
        h = _gelu(_layernorm(x, axis=-1) @ w1)
        c = D // 4
        g0 = _pad(h[:, :, 0*c:1*c], ((0, 0), (1, 0), (0, 0)))[:, :S, :]
        g1 = _pad(h[:, :, 1*c:2*c], ((0, 0), (0, 1), (0, 0)))[:, 1:, :]
        g2 = _pad(h[:, :, 2*c:3*c], ((0, 0), (2, 0), (0, 0)))[:, :S, :]
        g3 = _pad(h[:, :, 3*c:   ], ((0, 0), (0, 2), (0, 0)))[:, 2:, :]
        hs = torch.concatenate([g0, g1, g2, g3], axis=-1) @ w2
        x1 = x + hs
        h2 = _gelu(_layernorm(x1, axis=-1) @ w3) @ w4
        return x1 + h2

    x = A_x
    xn = _layernorm(x, axis=-1)
    return x + _A_ref(xn, A_wqkv, A_wo) + _B_ref(xn, B_w1, B_w2, B_w3, B_w4)
```

```asm
; @launch kernel=parallel_sum__softmax_full_mha__mixer_s_mlp__prompt_kernel grid=(256,1,1) block=(640,1,1) lds=163840
.amdgcn_target "amdgcn-amd-amdhsa--gfx950"
.text
.globl parallel_sum__softmax_full_mha__mixer_s_mlp__prompt_kernel
.p2align 8
.type parallel_sum__softmax_full_mha__mixer_s_mlp__prompt_kernel,@function
parallel_sum__softmax_full_mha__mixer_s_mlp__prompt_kernel:
    s_cmp_ge_u32 s2, 256
    s_cbranch_scc1 k_end
    s_mov_b32 s92, 0
    s_load_dwordx4 s[24:27], s[0:1], 0
    s_load_dwordx2 s[28:29], s[0:1], 16
    s_load_dwordx2 s[30:31], s[0:1], 32
    s_load_dwordx2 s[32:33], s[0:1], 40
    s_load_dwordx8 s[84:91], s[0:1], 48
    s_load_dwordx2 s[34:35], s[0:1], 80
    v_cmp_gt_u32 vcc, 64, v0
    s_and_saveexec_b64 s[36:37], vcc
    s_cbranch_execz Lz_1
    v_lshlrev_b32 v1, 2, v0
    v_add_u32 v1, 163584, v1
    v_mov_b32 v2, 0
    ds_write_b32 v1, v2
Lz_1:
    s_mov_b64 exec, -1
    v_lshrrev_b32 v1, 6, v0
    s_nop 0
    v_readfirstlane_b32 s58, v1
    v_and_b32 v1, 63, v0
    s_waitcnt lgkmcnt(0)
    s_mov_b32 s12, s34
    s_and_b32 s13, s35, 0xffff
    s_mov_b32 s14, 0x1800000
    s_mov_b32 s15, 0x20000
    s_setprio 3
    s_sub_u32 s36, s58, 5
    s_cmp_ge_u32 s36, 4
    s_cbranch_scc1 Lnl_2
    v_lshlrev_b32 v12, 4, v1
    s_mov_b32 s16, s24
    s_and_b32 s17, s25, 0xffff
    s_mov_b32 s18, 0x200000
    s_mov_b32 s19, 0x20000
    s_lshl_b32 s43, s2, 3
    s_lshl_b32 s44, s36, 1
    s_add_u32 s39, s43, s44
    s_lshl_b32 s43, s39, 10
    buffer_load_dwordx4 v[4:7], v12, s[16:19], s43 offen offset:0
    buffer_load_dwordx4 v[8:11], v12, s[16:19], s43 offen offset:1024
Lnl_2:
    s_barrier
    s_cmp_eq_u32 s58, 9
    s_cbranch_scc1 k_sentinel
    s_cmp_eq_u32 s58, 4
    s_cbranch_scc1 k_loader
    s_cmp_ge_u32 s58, 5
    s_cbranch_scc1 k_chain
    s_mov_b32 s36, s58
    s_and_b32 s43, s2, 7
    s_lshr_b32 s44, s2, 3
    s_lshr_b32 s45, s43, 1
    s_lshl_b32 s45, s45, 2
    s_and_b32 s46, s44, 3
    s_add_u32 s37, s45, s46
    s_and_b32 s45, s43, 1
    s_lshl_b32 s45, s45, 3
    s_lshr_b32 s46, s44, 2
    s_add_u32 s38, s45, s46
    s_mov_b32 s4, s24
    s_and_b32 s5, s25, 0xffff
    s_mov_b32 s6, 0x200000
    s_mov_b32 s7, 0x20000
    s_lshl_b32 s40, s37, 17
    s_lshl_b32 s43, s36, 13
    s_add_u32 s40, s40, s43
    s_and_b32 s43, s37, 3
    s_lshl_b32 s43, s43, 1
    s_add_u32 s43, s43, s38
    s_and_b32 s60, s43, 7
    s_mov_b32 s61, s60
    s_cmp_ge_u32 s38, 12
    s_cbranch_scc1 g1_w1
    s_mov_b32 s8, s26
    s_and_b32 s9, s27, 0xffff
    s_mov_b32 s10, 0x180000
    s_mov_b32 s11, 0x20000
    s_lshl_b32 s39, s38, 8
    s_cmp_ge_u32 s38, 8
    s_cbranch_scc1 g1_v
    s_mul_i32 s42, s36, 49152
    s_add_u32 s42, s42, s39
    s_lshr_b32 s52, s36, 1
    s_and_b32 s53, s36, 1
    s_and_b32 s54, s36, 3
    s_lshr_b32 s55, s36, 2
    s_lshl_b32 s50, s54, 10
    s_add_u32 s51, s50, 49152
    v_lshrrev_b32 v4, 2, v1
    s_mov_b32 s48, 3072
    v_mul_lo_u32 v7, v4, s48
    v_and_b32 v4, 3, v1
    v_lshl_add_u32 v7, v4, 4, v7
    v_lshlrev_b32 v8, 4, v1
    s_and_b32 s48, s36, 1
    s_lshl_b32 s48, s48, 2
    v_lshrrev_b32 v4, 4, v1
    v_add_u32 v4, s48, v4
    v_and_b32 v5, 7, v1
    v_xor_b32 v4, v4, v5
    v_lshrrev_b32 v5, 3, v1
    v_lshlrev_b32 v5, 10, v5
    v_lshl_add_u32 v9, v4, 4, v5
    v_and_b32 v4, 31, v1
    v_lshrrev_b32 v5, 1, v4
    v_and_b32 v5, 7, v5
    v_lshrrev_b32 v6, 5, v1
    v_xor_b32 v5, v5, v6
    v_lshlrev_b32 v4, 7, v4
    s_mul_i32 s48, s52, 8192
    v_add_u32 v4, s48, v4
    v_xor_b32 v6, 0, v5
    v_lshl_add_u32 v10, v6, 4, v4
    v_xor_b32 v6, 2, v5
    v_lshl_add_u32 v11, v6, 4, v4
    v_xor_b32 v6, 4, v5
    v_lshl_add_u32 v12, v6, 4, v4
    v_xor_b32 v6, 6, v5
    v_lshl_add_u32 v13, v6, 4, v4
    v_lshrrev_b32 v4, 5, v1
    v_lshlrev_b32 v4, 9, v4
    v_bfe_u32 v5, v1, 2, 2
    v_lshl_add_u32 v4, v5, 6, v4
    v_bfe_u32 v5, v1, 4, 1
    v_lshl_add_u32 v4, v5, 5, v4
    v_and_b32 v5, 3, v1
    v_lshl_add_u32 v4, v5, 3, v4
    s_mul_i32 s48, s53, 8192
    s_add_u32 s48, s48, 49152
    v_add_u32 v14, s48, v4
    v_mov_b32 v32, 0x3f803f80
    v_mov_b32 v33, 0x3f803f80
    v_mov_b32 v34, 0x3f803f80
    v_mov_b32 v35, 0x3f803f80
    s_add_u32 m0, s50, 0
    s_add_u32 s58, s60, 0
    s_and_b32 s58, s58, 7
    s_lshl_b32 s59, s58, 7
    s_add_u32 s59, s59, s40
    s_mul_i32 s63, s58, 196608
    s_add_u32 s63, s63, s42
    s_add_u32 s48, s59, 0
    buffer_load_dwordx4 v9, s[4:7], s48 offen  lds
    s_add_u32 m0, s50, 4096
    s_add_u32 s48, s59, 32768
    buffer_load_dwordx4 v9, s[4:7], s48 offen  lds
    s_add_u32 m0, s50, 8192
    s_add_u32 s48, s59, 65536
    buffer_load_dwordx4 v9, s[4:7], s48 offen  lds
    s_add_u32 m0, s50, 12288
    s_add_u32 s48, s59, 98304
    buffer_load_dwordx4 v9, s[4:7], s48 offen  lds
    s_add_u32 m0, s51, 0
    s_add_u32 s49, s63, 0
    buffer_load_dwordx4 v7, s[8:11], s49 offen lds
    s_add_u32 m0, s51, 4096
    s_add_u32 s49, s63, 64
    buffer_load_dwordx4 v7, s[8:11], s49 offen lds
    s_add_u32 m0, s51, 8192
    s_add_u32 s49, s63, 128
    buffer_load_dwordx4 v7, s[8:11], s49 offen lds
    s_add_u32 m0, s51, 12288
    s_add_u32 s49, s63, 192
    buffer_load_dwordx4 v7, s[8:11], s49 offen lds
    s_add_u32 m0, s50, 16384
    s_add_u32 s58, s60, 1
    s_and_b32 s58, s58, 7
    s_lshl_b32 s59, s58, 7
    s_add_u32 s59, s59, s40
    s_mul_i32 s63, s58, 196608
    s_add_u32 s63, s63, s42
    s_add_u32 s48, s59, 0
    buffer_load_dwordx4 v9, s[4:7], s48 offen  lds
    s_add_u32 m0, s50, 20480
    s_add_u32 s48, s59, 32768
    buffer_load_dwordx4 v9, s[4:7], s48 offen  lds
    s_add_u32 m0, s50, 24576
    s_add_u32 s48, s59, 65536
    buffer_load_dwordx4 v9, s[4:7], s48 offen  lds
    s_add_u32 m0, s50, 28672
    s_add_u32 s48, s59, 98304
    buffer_load_dwordx4 v9, s[4:7], s48 offen  lds
    s_add_u32 m0, s51, 16384
    s_add_u32 s49, s63, 0
    buffer_load_dwordx4 v7, s[8:11], s49 offen lds
    s_add_u32 m0, s51, 20480
    s_add_u32 s49, s63, 64
    buffer_load_dwordx4 v7, s[8:11], s49 offen lds
    s_add_u32 m0, s51, 24576
    s_add_u32 s49, s63, 128
    buffer_load_dwordx4 v7, s[8:11], s49 offen lds
    s_add_u32 m0, s51, 28672
    s_add_u32 s49, s63, 192
    buffer_load_dwordx4 v7, s[8:11], s49 offen lds
    v_mov_b32 v40, 0
    v_mov_b32 v41, 0
    v_mov_b32 v42, 0
    v_mov_b32 v43, 0
    v_mov_b32 v44, 0
    v_mov_b32 v45, 0
    v_mov_b32 v46, 0
    v_mov_b32 v47, 0
    v_mov_b32 v48, 0
    v_mov_b32 v49, 0
    v_mov_b32 v50, 0
    v_mov_b32 v51, 0
    v_mov_b32 v52, 0
    v_mov_b32 v53, 0
    v_mov_b32 v54, 0
    v_mov_b32 v55, 0
    v_mov_b32 v56, 0
    v_mov_b32 v57, 0
    v_mov_b32 v58, 0
    v_mov_b32 v59, 0
    v_mov_b32 v60, 0
    v_mov_b32 v61, 0
    v_mov_b32 v62, 0
    v_mov_b32 v63, 0
    v_mov_b32 v64, 0
    v_mov_b32 v65, 0
    v_mov_b32 v66, 0
    v_mov_b32 v67, 0
    v_mov_b32 v68, 0
    v_mov_b32 v69, 0
    v_mov_b32 v70, 0
    v_mov_b32 v71, 0
    v_mov_b32 v72, 0
    v_mov_b32 v73, 0
    v_mov_b32 v74, 0
    v_mov_b32 v75, 0
    v_mov_b32 v76, 0
    v_mov_b32 v77, 0
    v_mov_b32 v78, 0
    v_mov_b32 v79, 0
    v_mov_b32 v80, 0
    v_mov_b32 v81, 0
    v_mov_b32 v82, 0
    v_mov_b32 v83, 0
    v_mov_b32 v84, 0
    v_mov_b32 v85, 0
    v_mov_b32 v86, 0
    v_mov_b32 v87, 0
    v_mov_b32 v88, 0
    v_mov_b32 v89, 0
    v_mov_b32 v90, 0
    v_mov_b32 v91, 0
    v_mov_b32 v92, 0
    v_mov_b32 v93, 0
    v_mov_b32 v94, 0
    v_mov_b32 v95, 0
    v_mov_b32 v96, 0
    v_mov_b32 v97, 0
    v_mov_b32 v98, 0
    v_mov_b32 v99, 0
    v_mov_b32 v100, 0
    v_mov_b32 v101, 0
    v_mov_b32 v102, 0
    v_mov_b32 v103, 0
    s_waitcnt vmcnt(8) lgkmcnt(0)
    s_barrier
    ds_read_b128 v[104:107], v10 offset:0
    ds_read_b64_tr_b16 v[120:121], v14 offset:0
    ds_read_b64_tr_b16 v[122:123], v14 offset:256
    ds_read_b64_tr_b16 v[124:125], v14 offset:4096
    ds_read_b64_tr_b16 v[126:127], v14 offset:4352
    ds_read_b128 v[108:111], v10 offset:4096
    s_waitcnt lgkmcnt(3)
    v_mfma_f32_32x32x16_bf16 v[40:55], v[120:123], v[104:107], v[40:55]
    ds_read_b128 v[112:115], v11 offset:0
    ds_read_b64_tr_b16 v[128:129], v14 offset:1024
    s_waitcnt lgkmcnt(3)
    v_mfma_f32_32x32x16_bf16 v[56:71], v[124:127], v[104:107], v[56:71]
    ds_read_b64_tr_b16 v[130:131], v14 offset:1280
    ds_read_b64_tr_b16 v[132:133], v14 offset:5120
    s_waitcnt lgkmcnt(4)
    v_mfma_f32_32x32x16_bf16 v[72:87], v[120:123], v[108:111], v[72:87]
    ds_read_b64_tr_b16 v[134:135], v14 offset:5376
    ds_read_b128 v[116:119], v11 offset:4096
    s_add_u32 m0, s50, 32768
    s_add_u32 s58, s60, 2
    s_and_b32 s58, s58, 7
    s_lshl_b32 s59, s58, 7
    s_add_u32 s59, s59, s40
    s_mul_i32 s63, s58, 196608
    s_add_u32 s63, s63, s42
    s_add_u32 s48, s59, 0
    buffer_load_dwordx4 v9, s[4:7], s48 offen  lds
    v_mfma_f32_32x32x16_bf16 v[88:103], v[124:127], v[108:111], v[88:103]
    s_add_u32 m0, s50, 36864
    s_add_u32 s48, s59, 32768
    buffer_load_dwordx4 v9, s[4:7], s48 offen  lds
    s_cmp_lg_u32 s52, 0
    s_cbranch_scc1 Lc0_3
    v_mfma_f32_32x32x16_bf16 v[16:31], v[32:35], v[120:123], 0
    s_branch Lc1_4
Lc0_3:
    v_mfma_f32_32x32x16_bf16 v[16:31], v[32:35], v[124:127], 0
Lc1_4:
    s_waitcnt lgkmcnt(3)
    v_mfma_f32_32x32x16_bf16 v[40:55], v[128:131], v[112:115], v[40:55]
    ds_read_b128 v[104:107], v12 offset:0
    ds_read_b64_tr_b16 v[120:121], v14 offset:2048
    s_waitcnt lgkmcnt(3)
    v_mfma_f32_32x32x16_bf16 v[56:71], v[132:135], v[112:115], v[56:71]
    ds_read_b64_tr_b16 v[122:123], v14 offset:2304
    ds_read_b64_tr_b16 v[124:125], v14 offset:6144
    s_waitcnt lgkmcnt(4)
    v_mfma_f32_32x32x16_bf16 v[72:87], v[128:131], v[116:119], v[72:87]
    ds_read_b64_tr_b16 v[126:127], v14 offset:6400
    ds_read_b128 v[108:111], v12 offset:4096
    s_add_u32 m0, s50, 40960
    s_add_u32 s48, s59, 65536
    buffer_load_dwordx4 v9, s[4:7], s48 offen  lds
    v_mfma_f32_32x32x16_bf16 v[88:103], v[132:135], v[116:119], v[88:103]
    s_add_u32 m0, s50, 45056
    s_add_u32 s48, s59, 98304
    buffer_load_dwordx4 v9, s[4:7], s48 offen  lds
    s_cmp_lg_u32 s52, 0
    s_cbranch_scc1 Lc0_5
    v_mfma_f32_32x32x16_bf16 v[16:31], v[32:35], v[128:131], v[16:31]
    s_branch Lc1_6
Lc0_5:
    v_mfma_f32_32x32x16_bf16 v[16:31], v[32:35], v[132:135], v[16:31]
Lc1_6:
    s_waitcnt lgkmcnt(3)
    v_mfma_f32_32x32x16_bf16 v[40:55], v[120:123], v[104:107], v[40:55]
    ds_read_b128 v[112:115], v13 offset:0
    ds_read_b64_tr_b16 v[128:129], v14 offset:3072
    s_waitcnt lgkmcnt(3)
    v_mfma_f32_32x32x16_bf16 v[56:71], v[124:127], v[104:107], v[56:71]
    ds_read_b64_tr_b16 v[130:131], v14 offset:3328
    ds_read_b64_tr_b16 v[132:133], v14 offset:7168
    s_waitcnt lgkmcnt(4)
    v_mfma_f32_32x32x16_bf16 v[72:87], v[120:123], v[108:111], v[72:87]
    ds_read_b64_tr_b16 v[134:135], v14 offset:7424
    ds_read_b128 v[116:119], v13 offset:4096
    s_add_u32 m0, s51, 32768
    s_add_u32 s49, s63, 0
    buffer_load_dwordx4 v7, s[8:11], s49 offen lds
    v_mfma_f32_32x32x16_bf16 v[88:103], v[124:127], v[108:111], v[88:103]
    s_add_u32 m0, s51, 36864
    s_add_u32 s49, s63, 64
    buffer_load_dwordx4 v7, s[8:11], s49 offen lds
    s_cmp_lg_u32 s52, 0
    s_cbranch_scc1 Lc0_7
    v_mfma_f32_32x32x16_bf16 v[16:31], v[32:35], v[120:123], v[16:31]
    s_branch Lc1_8
Lc0_7:
    v_mfma_f32_32x32x16_bf16 v[16:31], v[32:35], v[124:127], v[16:31]
Lc1_8:
    s_add_u32 m0, s51, 40960
    s_add_u32 s49, s63, 128
    buffer_load_dwordx4 v7, s[8:11], s49 offen lds
    s_add_u32 m0, s51, 45056
    s_add_u32 s49, s63, 192
    buffer_load_dwordx4 v7, s[8:11], s49 offen lds
    s_waitcnt vmcnt(8) lgkmcnt(0)
    s_barrier
    v_mfma_f32_32x32x16_bf16 v[40:55], v[128:131], v[112:115], v[40:55]
    ds_read_b128 v[104:107], v10 offset:16384
    ds_read_b64_tr_b16 v[120:121], v14 offset:16384
    v_mfma_f32_32x32x16_bf16 v[56:71], v[132:135], v[112:115], v[56:71]
    ds_read_b64_tr_b16 v[122:123], v14 offset:16640
    ds_read_b64_tr_b16 v[124:125], v14 offset:20480
    v_mfma_f32_32x32x16_bf16 v[72:87], v[128:131], v[116:119], v[72:87]
    ds_read_b64_tr_b16 v[126:127], v14 offset:20736
    ds_read_b128 v[108:111], v10 offset:20480
    s_add_u32 m0, s50, 0
    s_add_u32 s58, s60, 3
    s_and_b32 s58, s58, 7
    s_lshl_b32 s59, s58, 7
    s_add_u32 s59, s59, s40
    s_mul_i32 s63, s58, 196608
    s_add_u32 s63, s63, s42
    s_add_u32 s48, s59, 0
    buffer_load_dwordx4 v9, s[4:7], s48 offen  lds
    v_mfma_f32_32x32x16_bf16 v[88:103], v[132:135], v[116:119], v[88:103]
    s_add_u32 m0, s50, 4096
    s_add_u32 s48, s59, 32768
    buffer_load_dwordx4 v9, s[4:7], s48 offen  lds
    s_cmp_lg_u32 s52, 0
    s_cbranch_scc1 Lc0_9
    v_mfma_f32_32x32x16_bf16 v[16:31], v[32:35], v[128:131], v[16:31]
    s_branch Lc1_10
Lc0_9:
    v_mfma_f32_32x32x16_bf16 v[16:31], v[32:35], v[132:135], v[16:31]
Lc1_10:
    s_waitcnt lgkmcnt(3)
    v_mfma_f32_32x32x16_bf16 v[40:55], v[120:123], v[104:107], v[40:55]
    ds_read_b128 v[112:115], v11 offset:16384
    ds_read_b64_tr_b16 v[128:129], v14 offset:17408
    s_waitcnt lgkmcnt(3)
    v_mfma_f32_32x32x16_bf16 v[56:71], v[124:127], v[104:107], v[56:71]
    ds_read_b64_tr_b16 v[130:131], v14 offset:17664
    ds_read_b64_tr_b16 v[132:133], v14 offset:21504
    s_waitcnt lgkmcnt(4)
    v_mfma_f32_32x32x16_bf16 v[72:87], v[120:123], v[108:111], v[72:87]
    ds_read_b64_tr_b16 v[134:135], v14 offset:21760
    ds_read_b128 v[116:119], v11 offset:20480
    s_add_u32 m0, s50, 8192
    s_add_u32 s48, s59, 65536
    buffer_load_dwordx4 v9, s[4:7], s48 offen  lds
    v_mfma_f32_32x32x16_bf16 v[88:103], v[124:127], v[108:111], v[88:103]
    s_add_u32 m0, s50, 12288
    s_add_u32 s48, s59, 98304
    buffer_load_dwordx4 v9, s[4:7], s48 offen  lds
    s_cmp_lg_u32 s52, 0
    s_cbranch_scc1 Lc0_11
    v_mfma_f32_32x32x16_bf16 v[16:31], v[32:35], v[120:123], v[16:31]
    s_branch Lc1_12
Lc0_11:
    v_mfma_f32_32x32x16_bf16 v[16:31], v[32:35], v[124:127], v[16:31]
Lc1_12:
    s_waitcnt lgkmcnt(3)
    v_mfma_f32_32x32x16_bf16 v[40:55], v[128:131], v[112:115], v[40:55]
    ds_read_b128 v[104:107], v12 offset:16384
    ds_read_b64_tr_b16 v[120:121], v14 offset:18432
    s_waitcnt lgkmcnt(3)
    v_mfma_f32_32x32x16_bf16 v[56:71], v[132:135], v[112:115], v[56:71]
    ds_read_b64_tr_b16 v[122:123], v14 offset:18688
    ds_read_b64_tr_b16 v[124:125], v14 offset:22528
    s_waitcnt lgkmcnt(4)
    v_mfma_f32_32x32x16_bf16 v[72:87], v[128:131], v[116:119], v[72:87]
    ds_read_b64_tr_b16 v[126:127], v14 offset:22784
    ds_read_b128 v[108:111], v12 offset:20480
    s_add_u32 m0, s51, 0
    s_add_u32 s49, s63, 0
    buffer_load_dwordx4 v7, s[8:11], s49 offen lds
    v_mfma_f32_32x32x16_bf16 v[88:103], v[132:135], v[116:119], v[88:103]
    s_add_u32 m0, s51, 4096
    s_add_u32 s49, s63, 64
    buffer_load_dwordx4 v7, s[8:11], s49 offen lds
    s_cmp_lg_u32 s52, 0
    s_cbranch_scc1 Lc0_13
    v_mfma_f32_32x32x16_bf16 v[16:31], v[32:35], v[128:131], v[16:31]
    s_branch Lc1_14
Lc0_13:
    v_mfma_f32_32x32x16_bf16 v[16:31], v[32:35], v[132:135], v[16:31]
Lc1_14:
    s_waitcnt lgkmcnt(3)
    v_mfma_f32_32x32x16_bf16 v[40:55], v[120:123], v[104:107], v[40:55]
    ds_read_b128 v[112:115], v13 offset:16384
    ds_read_b64_tr_b16 v[128:129], v14 offset:19456
    s_waitcnt lgkmcnt(3)
    v_mfma_f32_32x32x16_bf16 v[56:71], v[124:127], v[104:107], v[56:71]
    ds_read_b64_tr_b16 v[130:131], v14 offset:19712
    ds_read_b64_tr_b16 v[132:133], v14 offset:23552
    s_waitcnt lgkmcnt(4)
    v_mfma_f32_32x32x16_bf16 v[72:87], v[120:123], v[108:111], v[72:87]
    ds_read_b64_tr_b16 v[134:135], v14 offset:23808
    ds_read_b128 v[116:119], v13 offset:20480
    s_add_u32 m0, s51, 8192
    s_add_u32 s49, s63, 128
    buffer_load_dwordx4 v7, s[8:11], s49 offen lds
    v_mfma_f32_32x32x16_bf16 v[88:103], v[124:127], v[108:111], v[88:103]
    s_cmp_lg_u32 s52, 0
    s_cbranch_scc1 Lc0_15
    v_mfma_f32_32x32x16_bf16 v[16:31], v[32:35], v[120:123], v[16:31]
    s_branch Lc1_16
Lc0_15:
    v_mfma_f32_32x32x16_bf16 v[16:31], v[32:35], v[124:127], v[16:31]
Lc1_16:
    s_add_u32 m0, s51, 12288
    s_add_u32 s49, s63, 192
    buffer_load_dwordx4 v7, s[8:11], s49 offen lds
    s_waitcnt vmcnt(8) lgkmcnt(0)
    s_barrier
    v_mfma_f32_32x32x16_bf16 v[40:55], v[128:131], v[112:115], v[40:55]
    ds_read_b128 v[104:107], v10 offset:32768
    ds_read_b64_tr_b16 v[120:121], v14 offset:32768
    v_mfma_f32_32x32x16_bf16 v[56:71], v[132:135], v[112:115], v[56:71]
    ds_read_b64_tr_b16 v[122:123], v14 offset:33024
    ds_read_b64_tr_b16 v[124:125], v14 offset:36864
    v_mfma_f32_32x32x16_bf16 v[72:87], v[128:131], v[116:119], v[72:87]
    ds_read_b64_tr_b16 v[126:127], v14 offset:37120
    ds_read_b128 v[108:111], v10 offset:36864
    s_add_u32 m0, s50, 16384
    s_add_u32 s58, s60, 4
    s_and_b32 s58, s58, 7
    s_lshl_b32 s59, s58, 7
    s_add_u32 s59, s59, s40
    s_mul_i32 s63, s58, 196608
    s_add_u32 s63, s63, s42
    s_add_u32 s48, s59, 0
    buffer_load_dwordx4 v9, s[4:7], s48 offen  lds
    v_mfma_f32_32x32x16_bf16 v[88:103], v[132:135], v[116:119], v[88:103]
    s_add_u32 m0, s50, 20480
    s_add_u32 s48, s59, 32768
    buffer_load_dwordx4 v9, s[4:7], s48 offen  lds
    s_cmp_lg_u32 s52, 0
    s_cbranch_scc1 Lc0_17
    v_mfma_f32_32x32x16_bf16 v[16:31], v[32:35], v[128:131], v[16:31]
    s_branch Lc1_18
Lc0_17:
    v_mfma_f32_32x32x16_bf16 v[16:31], v[32:35], v[132:135], v[16:31]
Lc1_18:
    s_waitcnt lgkmcnt(3)
    v_mfma_f32_32x32x16_bf16 v[40:55], v[120:123], v[104:107], v[40:55]
    ds_read_b128 v[112:115], v11 offset:32768
    ds_read_b64_tr_b16 v[128:129], v14 offset:33792
    s_waitcnt lgkmcnt(3)
    v_mfma_f32_32x32x16_bf16 v[56:71], v[124:127], v[104:107], v[56:71]
    ds_read_b64_tr_b16 v[130:131], v14 offset:34048
    ds_read_b64_tr_b16 v[132:133], v14 offset:37888
    s_waitcnt lgkmcnt(4)
    v_mfma_f32_32x32x16_bf16 v[72:87], v[120:123], v[108:111], v[72:87]
    ds_read_b64_tr_b16 v[134:135], v14 offset:38144
    ds_read_b128 v[116:119], v11 offset:36864
    s_add_u32 m0, s50, 24576
    s_add_u32 s48, s59, 65536
    buffer_load_dwordx4 v9, s[4:7], s48 offen  lds
    v_mfma_f32_32x32x16_bf16 v[88:103], v[124:127], v[108:111], v[88:103]
    s_add_u32 m0, s50, 28672
    s_add_u32 s48, s59, 98304
    buffer_load_dwordx4 v9, s[4:7], s48 offen  lds
    s_cmp_lg_u32 s52, 0
    s_cbranch_scc1 Lc0_19
    v_mfma_f32_32x32x16_bf16 v[16:31], v[32:35], v[120:123], v[16:31]
    s_branch Lc1_20
Lc0_19:
    v_mfma_f32_32x32x16_bf16 v[16:31], v[32:35], v[124:127], v[16:31]
Lc1_20:
    s_waitcnt lgkmcnt(3)
    v_mfma_f32_32x32x16_bf16 v[40:55], v[128:131], v[112:115], v[40:55]
    ds_read_b128 v[104:107], v12 offset:32768
    ds_read_b64_tr_b16 v[120:121], v14 offset:34816
    s_waitcnt lgkmcnt(3)
    v_mfma_f32_32x32x16_bf16 v[56:71], v[132:135], v[112:115], v[56:71]
    ds_read_b64_tr_b16 v[122:123], v14 offset:35072
    ds_read_b64_tr_b16 v[124:125], v14 offset:38912
    s_waitcnt lgkmcnt(4)
    v_mfma_f32_32x32x16_bf16 v[72:87], v[128:131], v[116:119], v[72:87]
    ds_read_b64_tr_b16 v[126:127], v14 offset:39168
    ds_read_b128 v[108:111], v12 offset:36864
    s_add_u32 m0, s51, 16384
    s_add_u32 s49, s63, 0
    buffer_load_dwordx4 v7, s[8:11], s49 offen lds
    v_mfma_f32_32x32x16_bf16 v[88:103], v[132:135], v[116:119], v[88:103]
    s_add_u32 m0, s51, 20480
    s_add_u32 s49, s63, 64
    buffer_load_dwordx4 v7, s[8:11], s49 offen lds
    s_cmp_lg_u32 s52, 0
    s_cbranch_scc1 Lc0_21
    v_mfma_f32_32x32x16_bf16 v[16:31], v[32:35], v[128:131], v[16:31]
    s_branch Lc1_22
Lc0_21:
    v_mfma_f32_32x32x16_bf16 v[16:31], v[32:35], v[132:135], v[16:31]
Lc1_22:
    s_waitcnt lgkmcnt(3)
    v_mfma_f32_32x32x16_bf16 v[40:55], v[120:123], v[104:107], v[40:55]
    ds_read_b128 v[112:115], v13 offset:32768
    ds_read_b64_tr_b16 v[128:129], v14 offset:35840
    s_waitcnt lgkmcnt(3)
    v_mfma_f32_32x32x16_bf16 v[56:71], v[124:127], v[104:107], v[56:71]
    ds_read_b64_tr_b16 v[130:131], v14 offset:36096
    ds_read_b64_tr_b16 v[132:133], v14 offset:39936
    s_waitcnt lgkmcnt(4)
    v_mfma_f32_32x32x16_bf16 v[72:87], v[120:123], v[108:111], v[72:87]
    ds_read_b64_tr_b16 v[134:135], v14 offset:40192
    ds_read_b128 v[116:119], v13 offset:36864
    s_add_u32 m0, s51, 24576
    s_add_u32 s49, s63, 128
    buffer_load_dwordx4 v7, s[8:11], s49 offen lds
    v_mfma_f32_32x32x16_bf16 v[88:103], v[124:127], v[108:111], v[88:103]
    s_cmp_lg_u32 s52, 0
    s_cbranch_scc1 Lc0_23
    v_mfma_f32_32x32x16_bf16 v[16:31], v[32:35], v[120:123], v[16:31]
    s_branch Lc1_24
Lc0_23:
    v_mfma_f32_32x32x16_bf16 v[16:31], v[32:35], v[124:127], v[16:31]
Lc1_24:
    s_add_u32 m0, s51, 28672
    s_add_u32 s49, s63, 192
    buffer_load_dwordx4 v7, s[8:11], s49 offen lds
    s_waitcnt vmcnt(8) lgkmcnt(0)
    s_barrier
    v_mfma_f32_32x32x16_bf16 v[40:55], v[128:131], v[112:115], v[40:55]
    ds_read_b128 v[104:107], v10 offset:0
    ds_read_b64_tr_b16 v[120:121], v14 offset:0
    v_mfma_f32_32x32x16_bf16 v[56:71], v[132:135], v[112:115], v[56:71]
    ds_read_b64_tr_b16 v[122:123], v14 offset:256
    ds_read_b64_tr_b16 v[124:125], v14 offset:4096
    v_mfma_f32_32x32x16_bf16 v[72:87], v[128:131], v[116:119], v[72:87]
    ds_read_b64_tr_b16 v[126:127], v14 offset:4352
    ds_read_b128 v[108:111], v10 offset:4096
    s_add_u32 m0, s50, 32768
    s_add_u32 s58, s60, 5
    s_and_b32 s58, s58, 7
    s_lshl_b32 s59, s58, 7
    s_add_u32 s59, s59, s40
    s_mul_i32 s63, s58, 196608
    s_add_u32 s63, s63, s42
    s_add_u32 s48, s59, 0
    buffer_load_dwordx4 v9, s[4:7], s48 offen  lds
    v_mfma_f32_32x32x16_bf16 v[88:103], v[132:135], v[116:119], v[88:103]
    s_add_u32 m0, s50, 36864
    s_add_u32 s48, s59, 32768
    buffer_load_dwordx4 v9, s[4:7], s48 offen  lds
    s_cmp_lg_u32 s52, 0
    s_cbranch_scc1 Lc0_25
    v_mfma_f32_32x32x16_bf16 v[16:31], v[32:35], v[128:131], v[16:31]
    s_branch Lc1_26
Lc0_25:
    v_mfma_f32_32x32x16_bf16 v[16:31], v[32:35], v[132:135], v[16:31]
Lc1_26:
    s_waitcnt lgkmcnt(3)
    v_mfma_f32_32x32x16_bf16 v[40:55], v[120:123], v[104:107], v[40:55]
    ds_read_b128 v[112:115], v11 offset:0
    ds_read_b64_tr_b16 v[128:129], v14 offset:1024
    s_waitcnt lgkmcnt(3)
    v_mfma_f32_32x32x16_bf16 v[56:71], v[124:127], v[104:107], v[56:71]
    ds_read_b64_tr_b16 v[130:131], v14 offset:1280
    ds_read_b64_tr_b16 v[132:133], v14 offset:5120
    s_waitcnt lgkmcnt(4)
    v_mfma_f32_32x32x16_bf16 v[72:87], v[120:123], v[108:111], v[72:87]
    ds_read_b64_tr_b16 v[134:135], v14 offset:5376
    ds_read_b128 v[116:119], v11 offset:4096
    s_add_u32 m0, s50, 40960
    s_add_u32 s48, s59, 65536
    buffer_load_dwordx4 v9, s[4:7], s48 offen  lds
    v_mfma_f32_32x32x16_bf16 v[88:103], v[124:127], v[108:111], v[88:103]
    s_add_u32 m0, s50, 45056
    s_add_u32 s48, s59, 98304
    buffer_load_dwordx4 v9, s[4:7], s48 offen  lds
    s_cmp_lg_u32 s52, 0
    s_cbranch_scc1 Lc0_27
    v_mfma_f32_32x32x16_bf16 v[16:31], v[32:35], v[120:123], v[16:31]
    s_branch Lc1_28
Lc0_27:
    v_mfma_f32_32x32x16_bf16 v[16:31], v[32:35], v[124:127], v[16:31]
Lc1_28:
    s_waitcnt lgkmcnt(3)
    v_mfma_f32_32x32x16_bf16 v[40:55], v[128:131], v[112:115], v[40:55]
    ds_read_b128 v[104:107], v12 offset:0
    ds_read_b64_tr_b16 v[120:121], v14 offset:2048
    s_waitcnt lgkmcnt(3)
    v_mfma_f32_32x32x16_bf16 v[56:71], v[132:135], v[112:115], v[56:71]
    ds_read_b64_tr_b16 v[122:123], v14 offset:2304
    ds_read_b64_tr_b16 v[124:125], v14 offset:6144
    s_waitcnt lgkmcnt(4)
    v_mfma_f32_32x32x16_bf16 v[72:87], v[128:131], v[116:119], v[72:87]
    ds_read_b64_tr_b16 v[126:127], v14 offset:6400
    ds_read_b128 v[108:111], v12 offset:4096
    s_add_u32 m0, s51, 32768
    s_add_u32 s49, s63, 0
    buffer_load_dwordx4 v7, s[8:11], s49 offen lds
    v_mfma_f32_32x32x16_bf16 v[88:103], v[132:135], v[116:119], v[88:103]
    s_add_u32 m0, s51, 36864
    s_add_u32 s49, s63, 64
    buffer_load_dwordx4 v7, s[8:11], s49 offen lds
    s_cmp_lg_u32 s52, 0
    s_cbranch_scc1 Lc0_29
    v_mfma_f32_32x32x16_bf16 v[16:31], v[32:35], v[128:131], v[16:31]
    s_branch Lc1_30
Lc0_29:
    v_mfma_f32_32x32x16_bf16 v[16:31], v[32:35], v[132:135], v[16:31]
Lc1_30:
    s_waitcnt lgkmcnt(3)
    v_mfma_f32_32x32x16_bf16 v[40:55], v[120:123], v[104:107], v[40:55]
    ds_read_b128 v[112:115], v13 offset:0
    ds_read_b64_tr_b16 v[128:129], v14 offset:3072
    s_waitcnt lgkmcnt(3)
    v_mfma_f32_32x32x16_bf16 v[56:71], v[124:127], v[104:107], v[56:71]
    ds_read_b64_tr_b16 v[130:131], v14 offset:3328
    ds_read_b64_tr_b16 v[132:133], v14 offset:7168
    s_waitcnt lgkmcnt(4)
    v_mfma_f32_32x32x16_bf16 v[72:87], v[120:123], v[108:111], v[72:87]
    ds_read_b64_tr_b16 v[134:135], v14 offset:7424
    ds_read_b128 v[116:119], v13 offset:4096
    s_add_u32 m0, s51, 40960
    s_add_u32 s49, s63, 128
    buffer_load_dwordx4 v7, s[8:11], s49 offen lds
    v_mfma_f32_32x32x16_bf16 v[88:103], v[124:127], v[108:111], v[88:103]
    s_cmp_lg_u32 s52, 0
    s_cbranch_scc1 Lc0_31
    v_mfma_f32_32x32x16_bf16 v[16:31], v[32:35], v[120:123], v[16:31]
    s_branch Lc1_32
Lc0_31:
    v_mfma_f32_32x32x16_bf16 v[16:31], v[32:35], v[124:127], v[16:31]
Lc1_32:
    s_add_u32 m0, s51, 45056
    s_add_u32 s49, s63, 192
    buffer_load_dwordx4 v7, s[8:11], s49 offen lds
    s_waitcnt vmcnt(8) lgkmcnt(0)
    s_barrier
    v_mfma_f32_32x32x16_bf16 v[40:55], v[128:131], v[112:115], v[40:55]
    ds_read_b128 v[104:107], v10 offset:16384
    ds_read_b64_tr_b16 v[120:121], v14 offset:16384
    v_mfma_f32_32x32x16_bf16 v[56:71], v[132:135], v[112:115], v[56:71]
    ds_read_b64_tr_b16 v[122:123], v14 offset:16640
    ds_read_b64_tr_b16 v[124:125], v14 offset:20480
    v_mfma_f32_32x32x16_bf16 v[72:87], v[128:131], v[116:119], v[72:87]
    ds_read_b64_tr_b16 v[126:127], v14 offset:20736
    ds_read_b128 v[108:111], v10 offset:20480
    s_add_u32 m0, s50, 0
    s_add_u32 s58, s60, 6
    s_and_b32 s58, s58, 7
    s_lshl_b32 s59, s58, 7
    s_add_u32 s59, s59, s40
    s_mul_i32 s63, s58, 196608
    s_add_u32 s63, s63, s42
    s_add_u32 s48, s59, 0
    buffer_load_dwordx4 v9, s[4:7], s48 offen  lds
    v_mfma_f32_32x32x16_bf16 v[88:103], v[132:135], v[116:119], v[88:103]
    s_add_u32 m0, s50, 4096
    s_add_u32 s48, s59, 32768
    buffer_load_dwordx4 v9, s[4:7], s48 offen  lds
    s_cmp_lg_u32 s52, 0
    s_cbranch_scc1 Lc0_33
    v_mfma_f32_32x32x16_bf16 v[16:31], v[32:35], v[128:131], v[16:31]
    s_branch Lc1_34
Lc0_33:
    v_mfma_f32_32x32x16_bf16 v[16:31], v[32:35], v[132:135], v[16:31]
Lc1_34:
    s_waitcnt lgkmcnt(3)
    v_mfma_f32_32x32x16_bf16 v[40:55], v[120:123], v[104:107], v[40:55]
    ds_read_b128 v[112:115], v11 offset:16384
    ds_read_b64_tr_b16 v[128:129], v14 offset:17408
    s_waitcnt lgkmcnt(3)
    v_mfma_f32_32x32x16_bf16 v[56:71], v[124:127], v[104:107], v[56:71]
    ds_read_b64_tr_b16 v[130:131], v14 offset:17664
    ds_read_b64_tr_b16 v[132:133], v14 offset:21504
    s_waitcnt lgkmcnt(4)
    v_mfma_f32_32x32x16_bf16 v[72:87], v[120:123], v[108:111], v[72:87]
    ds_read_b64_tr_b16 v[134:135], v14 offset:21760
    ds_read_b128 v[116:119], v11 offset:20480
    s_add_u32 m0, s50, 8192
    s_add_u32 s48, s59, 65536
    buffer_load_dwordx4 v9, s[4:7], s48 offen  lds
    v_mfma_f32_32x32x16_bf16 v[88:103], v[124:127], v[108:111], v[88:103]
    s_add_u32 m0, s50, 12288
    s_add_u32 s48, s59, 98304
    buffer_load_dwordx4 v9, s[4:7], s48 offen  lds
    s_cmp_lg_u32 s52, 0
    s_cbranch_scc1 Lc0_35
    v_mfma_f32_32x32x16_bf16 v[16:31], v[32:35], v[120:123], v[16:31]
    s_branch Lc1_36
Lc0_35:
    v_mfma_f32_32x32x16_bf16 v[16:31], v[32:35], v[124:127], v[16:31]
Lc1_36:
    s_waitcnt lgkmcnt(3)
    v_mfma_f32_32x32x16_bf16 v[40:55], v[128:131], v[112:115], v[40:55]
    ds_read_b128 v[104:107], v12 offset:16384
    ds_read_b64_tr_b16 v[120:121], v14 offset:18432
    s_waitcnt lgkmcnt(3)
    v_mfma_f32_32x32x16_bf16 v[56:71], v[132:135], v[112:115], v[56:71]
    ds_read_b64_tr_b16 v[122:123], v14 offset:18688
    ds_read_b64_tr_b16 v[124:125], v14 offset:22528
    s_waitcnt lgkmcnt(4)
    v_mfma_f32_32x32x16_bf16 v[72:87], v[128:131], v[116:119], v[72:87]
    ds_read_b64_tr_b16 v[126:127], v14 offset:22784
    ds_read_b128 v[108:111], v12 offset:20480
    s_add_u32 m0, s51, 0
    s_add_u32 s49, s63, 0
    buffer_load_dwordx4 v7, s[8:11], s49 offen lds
    v_mfma_f32_32x32x16_bf16 v[88:103], v[132:135], v[116:119], v[88:103]
    s_add_u32 m0, s51, 4096
    s_add_u32 s49, s63, 64
    buffer_load_dwordx4 v7, s[8:11], s49 offen lds
    s_cmp_lg_u32 s52, 0
    s_cbranch_scc1 Lc0_37
    v_mfma_f32_32x32x16_bf16 v[16:31], v[32:35], v[128:131], v[16:31]
    s_branch Lc1_38
Lc0_37:
    v_mfma_f32_32x32x16_bf16 v[16:31], v[32:35], v[132:135], v[16:31]
Lc1_38:
    s_waitcnt lgkmcnt(3)
    v_mfma_f32_32x32x16_bf16 v[40:55], v[120:123], v[104:107], v[40:55]
    ds_read_b128 v[112:115], v13 offset:16384
    ds_read_b64_tr_b16 v[128:129], v14 offset:19456
    s_waitcnt lgkmcnt(3)
    v_mfma_f32_32x32x16_bf16 v[56:71], v[124:127], v[104:107], v[56:71]
    ds_read_b64_tr_b16 v[130:131], v14 offset:19712
    ds_read_b64_tr_b16 v[132:133], v14 offset:23552
    s_waitcnt lgkmcnt(4)
    v_mfma_f32_32x32x16_bf16 v[72:87], v[120:123], v[108:111], v[72:87]
    ds_read_b64_tr_b16 v[134:135], v14 offset:23808
    ds_read_b128 v[116:119], v13 offset:20480
    s_add_u32 m0, s51, 8192
    s_add_u32 s49, s63, 128
    buffer_load_dwordx4 v7, s[8:11], s49 offen lds
    v_mfma_f32_32x32x16_bf16 v[88:103], v[124:127], v[108:111], v[88:103]
    s_cmp_lg_u32 s52, 0
    s_cbranch_scc1 Lc0_39
    v_mfma_f32_32x32x16_bf16 v[16:31], v[32:35], v[120:123], v[16:31]
    s_branch Lc1_40
Lc0_39:
    v_mfma_f32_32x32x16_bf16 v[16:31], v[32:35], v[124:127], v[16:31]
Lc1_40:
    s_add_u32 m0, s51, 12288
    s_add_u32 s49, s63, 192
    buffer_load_dwordx4 v7, s[8:11], s49 offen lds
    s_waitcnt vmcnt(8) lgkmcnt(0)
    s_barrier
    v_mfma_f32_32x32x16_bf16 v[40:55], v[128:131], v[112:115], v[40:55]
    ds_read_b128 v[104:107], v10 offset:32768
    ds_read_b64_tr_b16 v[120:121], v14 offset:32768
    v_mfma_f32_32x32x16_bf16 v[56:71], v[132:135], v[112:115], v[56:71]
    ds_read_b64_tr_b16 v[122:123], v14 offset:33024
    ds_read_b64_tr_b16 v[124:125], v14 offset:36864
    v_mfma_f32_32x32x16_bf16 v[72:87], v[128:131], v[116:119], v[72:87]
    ds_read_b64_tr_b16 v[126:127], v14 offset:37120
    ds_read_b128 v[108:111], v10 offset:36864
    s_add_u32 m0, s50, 16384
    s_add_u32 s58, s60, 7
    s_and_b32 s58, s58, 7
    s_lshl_b32 s59, s58, 7
    s_add_u32 s59, s59, s40
    s_mul_i32 s63, s58, 196608
    s_add_u32 s63, s63, s42
    s_add_u32 s48, s59, 0
    buffer_load_dwordx4 v9, s[4:7], s48 offen  lds
    v_mfma_f32_32x32x16_bf16 v[88:103], v[132:135], v[116:119], v[88:103]
    s_add_u32 m0, s50, 20480
    s_add_u32 s48, s59, 32768
    buffer_load_dwordx4 v9, s[4:7], s48 offen  lds
    s_cmp_lg_u32 s52, 0
    s_cbranch_scc1 Lc0_41
    v_mfma_f32_32x32x16_bf16 v[16:31], v[32:35], v[128:131], v[16:31]
    s_branch Lc1_42
Lc0_41:
    v_mfma_f32_32x32x16_bf16 v[16:31], v[32:35], v[132:135], v[16:31]
Lc1_42:
    s_waitcnt lgkmcnt(3)
    v_mfma_f32_32x32x16_bf16 v[40:55], v[120:123], v[104:107], v[40:55]
    ds_read_b128 v[112:115], v11 offset:32768
    ds_read_b64_tr_b16 v[128:129], v14 offset:33792
    s_waitcnt lgkmcnt(3)
    v_mfma_f32_32x32x16_bf16 v[56:71], v[124:127], v[104:107], v[56:71]
    ds_read_b64_tr_b16 v[130:131], v14 offset:34048
    ds_read_b64_tr_b16 v[132:133], v14 offset:37888
    s_waitcnt lgkmcnt(4)
    v_mfma_f32_32x32x16_bf16 v[72:87], v[120:123], v[108:111], v[72:87]
    ds_read_b64_tr_b16 v[134:135], v14 offset:38144
    ds_read_b128 v[116:119], v11 offset:36864
    s_add_u32 m0, s50, 24576
    s_add_u32 s48, s59, 65536
    buffer_load_dwordx4 v9, s[4:7], s48 offen  lds
    v_mfma_f32_32x32x16_bf16 v[88:103], v[124:127], v[108:111], v[88:103]
    s_add_u32 m0, s50, 28672
    s_add_u32 s48, s59, 98304
    buffer_load_dwordx4 v9, s[4:7], s48 offen  lds
    s_cmp_lg_u32 s52, 0
    s_cbranch_scc1 Lc0_43
    v_mfma_f32_32x32x16_bf16 v[16:31], v[32:35], v[120:123], v[16:31]
    s_branch Lc1_44
Lc0_43:
    v_mfma_f32_32x32x16_bf16 v[16:31], v[32:35], v[124:127], v[16:31]
Lc1_44:
    s_waitcnt lgkmcnt(3)
    v_mfma_f32_32x32x16_bf16 v[40:55], v[128:131], v[112:115], v[40:55]
    ds_read_b128 v[104:107], v12 offset:32768
    ds_read_b64_tr_b16 v[120:121], v14 offset:34816
    s_waitcnt lgkmcnt(3)
    v_mfma_f32_32x32x16_bf16 v[56:71], v[132:135], v[112:115], v[56:71]
    ds_read_b64_tr_b16 v[122:123], v14 offset:35072
    ds_read_b64_tr_b16 v[124:125], v14 offset:38912
    s_waitcnt lgkmcnt(4)
    v_mfma_f32_32x32x16_bf16 v[72:87], v[128:131], v[116:119], v[72:87]
    ds_read_b64_tr_b16 v[126:127], v14 offset:39168
    ds_read_b128 v[108:111], v12 offset:36864
    s_add_u32 m0, s51, 16384
    s_add_u32 s49, s63, 0
    buffer_load_dwordx4 v7, s[8:11], s49 offen lds
    v_mfma_f32_32x32x16_bf16 v[88:103], v[132:135], v[116:119], v[88:103]
    s_add_u32 m0, s51, 20480
    s_add_u32 s49, s63, 64
    buffer_load_dwordx4 v7, s[8:11], s49 offen lds
    s_cmp_lg_u32 s52, 0
    s_cbranch_scc1 Lc0_45
    v_mfma_f32_32x32x16_bf16 v[16:31], v[32:35], v[128:131], v[16:31]
    s_branch Lc1_46
Lc0_45:
    v_mfma_f32_32x32x16_bf16 v[16:31], v[32:35], v[132:135], v[16:31]
Lc1_46:
    s_waitcnt lgkmcnt(3)
    v_mfma_f32_32x32x16_bf16 v[40:55], v[120:123], v[104:107], v[40:55]
    ds_read_b128 v[112:115], v13 offset:32768
    ds_read_b64_tr_b16 v[128:129], v14 offset:35840
    s_waitcnt lgkmcnt(3)
    v_mfma_f32_32x32x16_bf16 v[56:71], v[124:127], v[104:107], v[56:71]
    ds_read_b64_tr_b16 v[130:131], v14 offset:36096
    ds_read_b64_tr_b16 v[132:133], v14 offset:39936
    s_waitcnt lgkmcnt(4)
    v_mfma_f32_32x32x16_bf16 v[72:87], v[120:123], v[108:111], v[72:87]
    ds_read_b64_tr_b16 v[134:135], v14 offset:40192
    ds_read_b128 v[116:119], v13 offset:36864
    s_add_u32 m0, s51, 24576
    s_add_u32 s49, s63, 128
    buffer_load_dwordx4 v7, s[8:11], s49 offen lds
    v_mfma_f32_32x32x16_bf16 v[88:103], v[124:127], v[108:111], v[88:103]
    s_cmp_lg_u32 s52, 0
    s_cbranch_scc1 Lc0_47
    v_mfma_f32_32x32x16_bf16 v[16:31], v[32:35], v[120:123], v[16:31]
    s_branch Lc1_48
Lc0_47:
    v_mfma_f32_32x32x16_bf16 v[16:31], v[32:35], v[124:127], v[16:31]
Lc1_48:
    s_add_u32 m0, s51, 28672
    s_add_u32 s49, s63, 192
    buffer_load_dwordx4 v7, s[8:11], s49 offen lds
    s_waitcnt vmcnt(8) lgkmcnt(0)
    s_barrier
    v_mfma_f32_32x32x16_bf16 v[40:55], v[128:131], v[112:115], v[40:55]
    ds_read_b128 v[104:107], v10 offset:0
    ds_read_b64_tr_b16 v[120:121], v14 offset:0
    v_mfma_f32_32x32x16_bf16 v[56:71], v[132:135], v[112:115], v[56:71]
    ds_read_b64_tr_b16 v[122:123], v14 offset:256
    ds_read_b64_tr_b16 v[124:125], v14 offset:4096
    v_mfma_f32_32x32x16_bf16 v[72:87], v[128:131], v[116:119], v[72:87]
    ds_read_b64_tr_b16 v[126:127], v14 offset:4352
    ds_read_b128 v[108:111], v10 offset:4096
    v_mfma_f32_32x32x16_bf16 v[88:103], v[132:135], v[116:119], v[88:103]
    s_cmp_lg_u32 s52, 0
    s_cbranch_scc1 Lc0_49
    v_mfma_f32_32x32x16_bf16 v[16:31], v[32:35], v[128:131], v[16:31]
    s_branch Lc1_50
Lc0_49:
    v_mfma_f32_32x32x16_bf16 v[16:31], v[32:35], v[132:135], v[16:31]
Lc1_50:
    s_waitcnt lgkmcnt(3)
    v_mfma_f32_32x32x16_bf16 v[40:55], v[120:123], v[104:107], v[40:55]
    ds_read_b128 v[112:115], v11 offset:0
    ds_read_b64_tr_b16 v[128:129], v14 offset:1024
    s_waitcnt lgkmcnt(3)
    v_mfma_f32_32x32x16_bf16 v[56:71], v[124:127], v[104:107], v[56:71]
    ds_read_b64_tr_b16 v[130:131], v14 offset:1280
    ds_read_b64_tr_b16 v[132:133], v14 offset:5120
    s_waitcnt lgkmcnt(4)
    v_mfma_f32_32x32x16_bf16 v[72:87], v[120:123], v[108:111], v[72:87]
    ds_read_b64_tr_b16 v[134:135], v14 offset:5376
    ds_read_b128 v[116:119], v11 offset:4096
    v_mfma_f32_32x32x16_bf16 v[88:103], v[124:127], v[108:111], v[88:103]
    s_cmp_lg_u32 s52, 0
    s_cbranch_scc1 Lc0_51
    v_mfma_f32_32x32x16_bf16 v[16:31], v[32:35], v[120:123], v[16:31]
    s_branch Lc1_52
Lc0_51:
    v_mfma_f32_32x32x16_bf16 v[16:31], v[32:35], v[124:127], v[16:31]
Lc1_52:
    s_waitcnt lgkmcnt(3)
    v_mfma_f32_32x32x16_bf16 v[40:55], v[128:131], v[112:115], v[40:55]
    ds_read_b128 v[104:107], v12 offset:0
    ds_read_b64_tr_b16 v[120:121], v14 offset:2048
    s_waitcnt lgkmcnt(3)
    v_mfma_f32_32x32x16_bf16 v[56:71], v[132:135], v[112:115], v[56:71]
    ds_read_b64_tr_b16 v[122:123], v14 offset:2304
    ds_read_b64_tr_b16 v[124:125], v14 offset:6144
    s_waitcnt lgkmcnt(4)
    v_mfma_f32_32x32x16_bf16 v[72:87], v[128:131], v[116:119], v[72:87]
    ds_read_b64_tr_b16 v[126:127], v14 offset:6400
    ds_read_b128 v[108:111], v12 offset:4096
    v_mfma_f32_32x32x16_bf16 v[88:103], v[132:135], v[116:119], v[88:103]
    s_cmp_lg_u32 s52, 0
    s_cbranch_scc1 Lc0_53
    v_mfma_f32_32x32x16_bf16 v[16:31], v[32:35], v[128:131], v[16:31]
    s_branch Lc1_54
Lc0_53:
    v_mfma_f32_32x32x16_bf16 v[16:31], v[32:35], v[132:135], v[16:31]
Lc1_54:
    s_waitcnt lgkmcnt(3)
    v_mfma_f32_32x32x16_bf16 v[40:55], v[120:123], v[104:107], v[40:55]
    ds_read_b128 v[112:115], v13 offset:0
    ds_read_b64_tr_b16 v[128:129], v14 offset:3072
    s_waitcnt lgkmcnt(3)
    v_mfma_f32_32x32x16_bf16 v[56:71], v[124:127], v[104:107], v[56:71]
    ds_read_b64_tr_b16 v[130:131], v14 offset:3328
    ds_read_b64_tr_b16 v[132:133], v14 offset:7168
    s_waitcnt lgkmcnt(4)
    v_mfma_f32_32x32x16_bf16 v[72:87], v[120:123], v[108:111], v[72:87]
    ds_read_b64_tr_b16 v[134:135], v14 offset:7424
    ds_read_b128 v[116:119], v13 offset:4096
    v_mfma_f32_32x32x16_bf16 v[88:103], v[124:127], v[108:111], v[88:103]
    s_cmp_lg_u32 s52, 0
    s_cbranch_scc1 Lc0_55
    v_mfma_f32_32x32x16_bf16 v[16:31], v[32:35], v[120:123], v[16:31]
    s_branch Lc1_56
Lc0_55:
    v_mfma_f32_32x32x16_bf16 v[16:31], v[32:35], v[124:127], v[16:31]
Lc1_56:
    s_waitcnt vmcnt(0) lgkmcnt(0)
    s_barrier
    v_and_b32 v38, 127, v0
    v_lshlrev_b32 v38, 2, v38
    s_lshl_b32 s43, s37, 9
    s_add_u32 s43, s43, 0x1600000
    buffer_load_dword v36, v38, s[12:15], s43 offen sc1
    s_add_u32 s43, s43, 0x2000
    buffer_load_dword v37, v38, s[12:15], s43 offen sc1
    v_mfma_f32_32x32x16_bf16 v[40:55], v[128:131], v[112:115], v[40:55]
    ds_read_b128 v[104:107], v10 offset:16384
    ds_read_b64_tr_b16 v[120:121], v14 offset:16384
    v_mfma_f32_32x32x16_bf16 v[56:71], v[132:135], v[112:115], v[56:71]
    ds_read_b64_tr_b16 v[122:123], v14 offset:16640
    ds_read_b64_tr_b16 v[124:125], v14 offset:20480
    v_mfma_f32_32x32x16_bf16 v[72:87], v[128:131], v[116:119], v[72:87]
    ds_read_b64_tr_b16 v[126:127], v14 offset:20736
    ds_read_b128 v[108:111], v10 offset:20480
    v_mfma_f32_32x32x16_bf16 v[88:103], v[132:135], v[116:119], v[88:103]
    s_cmp_lg_u32 s52, 0
    s_cbranch_scc1 Lc0_57
    v_mfma_f32_32x32x16_bf16 v[16:31], v[32:35], v[128:131], v[16:31]
    s_branch Lc1_58
Lc0_57:
    v_mfma_f32_32x32x16_bf16 v[16:31], v[32:35], v[132:135], v[16:31]
Lc1_58:
    s_waitcnt lgkmcnt(3)
    v_mfma_f32_32x32x16_bf16 v[40:55], v[120:123], v[104:107], v[40:55]
    ds_read_b128 v[112:115], v11 offset:16384
    ds_read_b64_tr_b16 v[128:129], v14 offset:17408
    s_waitcnt lgkmcnt(3)
    v_mfma_f32_32x32x16_bf16 v[56:71], v[124:127], v[104:107], v[56:71]
    ds_read_b64_tr_b16 v[130:131], v14 offset:17664
    ds_read_b64_tr_b16 v[132:133], v14 offset:21504
    s_waitcnt lgkmcnt(4)
    v_mfma_f32_32x32x16_bf16 v[72:87], v[120:123], v[108:111], v[72:87]
    ds_read_b64_tr_b16 v[134:135], v14 offset:21760
    ds_read_b128 v[116:119], v11 offset:20480
    v_mfma_f32_32x32x16_bf16 v[88:103], v[124:127], v[108:111], v[88:103]
    s_cmp_lg_u32 s52, 0
    s_cbranch_scc1 Lc0_59
    v_mfma_f32_32x32x16_bf16 v[16:31], v[32:35], v[120:123], v[16:31]
    s_branch Lc1_60
Lc0_59:
    v_mfma_f32_32x32x16_bf16 v[16:31], v[32:35], v[124:127], v[16:31]
Lc1_60:
    s_waitcnt lgkmcnt(3)
    v_mfma_f32_32x32x16_bf16 v[40:55], v[128:131], v[112:115], v[40:55]
    ds_read_b128 v[104:107], v12 offset:16384
    ds_read_b64_tr_b16 v[120:121], v14 offset:18432
    s_waitcnt lgkmcnt(3)
    v_mfma_f32_32x32x16_bf16 v[56:71], v[132:135], v[112:115], v[56:71]
    ds_read_b64_tr_b16 v[122:123], v14 offset:18688
    ds_read_b64_tr_b16 v[124:125], v14 offset:22528
    s_waitcnt lgkmcnt(4)
    v_mfma_f32_32x32x16_bf16 v[72:87], v[128:131], v[116:119], v[72:87]
    ds_read_b64_tr_b16 v[126:127], v14 offset:22784
    ds_read_b128 v[108:111], v12 offset:20480
    v_mfma_f32_32x32x16_bf16 v[88:103], v[132:135], v[116:119], v[88:103]
    s_cmp_lg_u32 s52, 0
    s_cbranch_scc1 Lc0_61
    v_mfma_f32_32x32x16_bf16 v[16:31], v[32:35], v[128:131], v[16:31]
    s_branch Lc1_62
Lc0_61:
    v_mfma_f32_32x32x16_bf16 v[16:31], v[32:35], v[132:135], v[16:31]
Lc1_62:
    s_waitcnt lgkmcnt(3)
    v_mfma_f32_32x32x16_bf16 v[40:55], v[120:123], v[104:107], v[40:55]
    ds_read_b128 v[112:115], v13 offset:16384
    ds_read_b64_tr_b16 v[128:129], v14 offset:19456
    s_waitcnt lgkmcnt(3)
    v_mfma_f32_32x32x16_bf16 v[56:71], v[124:127], v[104:107], v[56:71]
    ds_read_b64_tr_b16 v[130:131], v14 offset:19712
    ds_read_b64_tr_b16 v[132:133], v14 offset:23552
    s_waitcnt lgkmcnt(4)
    v_mfma_f32_32x32x16_bf16 v[72:87], v[120:123], v[108:111], v[72:87]
    ds_read_b64_tr_b16 v[134:135], v14 offset:23808
    ds_read_b128 v[116:119], v13 offset:20480
    v_mfma_f32_32x32x16_bf16 v[88:103], v[124:127], v[108:111], v[88:103]
    s_cmp_lg_u32 s52, 0
    s_cbranch_scc1 Lc0_63
    v_mfma_f32_32x32x16_bf16 v[16:31], v[32:35], v[120:123], v[16:31]
    s_branch Lc1_64
Lc0_63:
    v_mfma_f32_32x32x16_bf16 v[16:31], v[32:35], v[124:127], v[16:31]
Lc1_64:
    s_waitcnt lgkmcnt(3)
    v_mfma_f32_32x32x16_bf16 v[40:55], v[128:131], v[112:115], v[40:55]
    s_waitcnt lgkmcnt(1)
    v_mfma_f32_32x32x16_bf16 v[56:71], v[132:135], v[112:115], v[56:71]
    s_waitcnt lgkmcnt(0)
    v_mfma_f32_32x32x16_bf16 v[72:87], v[128:131], v[116:119], v[72:87]
    v_mfma_f32_32x32x16_bf16 v[88:103], v[132:135], v[116:119], v[88:103]
    s_cmp_lg_u32 s52, 0
    s_cbranch_scc1 Lc0_65
    v_mfma_f32_32x32x16_bf16 v[16:31], v[32:35], v[128:131], v[16:31]
    s_branch Lc1_66
Lc0_65:
    v_mfma_f32_32x32x16_bf16 v[16:31], v[32:35], v[132:135], v[16:31]
Lc1_66:
    s_waitcnt lgkmcnt(0)
    s_mov_b32 s45, 1.0
    s_mov_b32 s62, 0x3eb8aa3b
    s_cmp_lt_u32 s38, 4
    s_cselect_b32 s45, s62, s45
    v_and_b32 v4, 31, v1
    v_lshlrev_b32 v4, 2, v4
    s_lshl_b32 s43, s53, 8
    s_lshl_b32 s44, s52, 7
    s_add_u32 s43, s43, s44
    s_add_u32 s43, s43, 147456
    v_add_u32 v5, s43, v4
    v_add_u32 v38, 147456, v38
    s_waitcnt vmcnt(0)
    v_mul_f32 v36, s45, v36
    v_mul_f32 v37, s45, v37
    s_nop 3
    ds_write_b32 v5, v16 offset:9216
    s_cmp_ge_u32 s36, 2
    s_cbranch_scc1 Ltk_67
    ds_write_b32 v38, v36 offset:8192
    ds_write_b32 v38, v37 offset:8704
Ltk_67:
    s_waitcnt lgkmcnt(0)
    s_barrier
    v_and_b32 v4, 31, v1
    v_lshlrev_b32 v4, 2, v4
    v_lshrrev_b32 v5, 5, v1
    v_lshlrev_b32 v5, 4, v5
    v_add_u32 v4, 147456, v4
    v_add_u32 v5, 147456, v5
    s_lshl_b32 s43, s37, 2
    s_lshl_b32 s44, s52, 1
    s_add_u32 s43, s43, s44
    s_lshl_b32 s43, s43, 5
    s_and_b32 s44, s38, 3
    s_lshl_b32 s44, s44, 3
    s_add_u32 s43, s43, s44
    s_lshl_b32 s44, s53, 2
    s_add_u32 s43, s43, s44
    s_lshl_b32 s43, s43, 10
    s_lshr_b32 s44, s38, 2
    s_lshl_b32 s44, s44, 21
    s_add_u32 s43, s43, s44
    v_lshlrev_b32 v156, 4, v1
    s_lshl_b32 s44, s52, 8
    v_add_u32 v4, s44, v4
    s_lshl_b32 s44, s53, 8
    v_add_u32 v5, s44, v5
    ds_read_b128 v[104:107], v5 offset:9216
    ds_read_b128 v[108:111], v5 offset:9248
    ds_read_b128 v[112:115], v5 offset:9280
    ds_read_b128 v[116:119], v5 offset:9312
    ds_read_b128 v[120:123], v5 offset:9344
    ds_read_b128 v[124:127], v5 offset:9376
    ds_read_b128 v[128:131], v5 offset:9408
    ds_read_b128 v[132:135], v5 offset:9440
    ds_read_b32 v136, v4 offset:8192
    ds_read_b32 v137, v4 offset:8704
    ds_read_b32 v138, v4 offset:8320
    ds_read_b32 v139, v4 offset:8832
    s_waitcnt lgkmcnt(0)
    v_pk_mul_f32 v[40:41], v[40:41], v[136:137] op_sel:[0,1] op_sel_hi:[1,1]
    v_pk_mul_f32 v[42:43], v[42:43], v[136:137] op_sel:[0,1] op_sel_hi:[1,1]
    v_pk_mul_f32 v[44:45], v[44:45], v[136:137] op_sel:[0,1] op_sel_hi:[1,1]
    v_pk_mul_f32 v[46:47], v[46:47], v[136:137] op_sel:[0,1] op_sel_hi:[1,1]
    v_pk_mul_f32 v[48:49], v[48:49], v[136:137] op_sel:[0,1] op_sel_hi:[1,1]
    v_pk_mul_f32 v[50:51], v[50:51], v[136:137] op_sel:[0,1] op_sel_hi:[1,1]
    v_pk_mul_f32 v[52:53], v[52:53], v[136:137] op_sel:[0,1] op_sel_hi:[1,1]
    v_pk_mul_f32 v[54:55], v[54:55], v[136:137] op_sel:[0,1] op_sel_hi:[1,1]
    v_pk_fma_f32 v[40:41], v[136:137], v[104:105], v[40:41] op_sel:[0,0,0] op_sel_hi:[0,1,1]
    v_pk_fma_f32 v[42:43], v[136:137], v[106:107], v[42:43] op_sel:[0,0,0] op_sel_hi:[0,1,1]
    v_pk_fma_f32 v[44:45], v[136:137], v[108:109], v[44:45] op_sel:[0,0,0] op_sel_hi:[0,1,1]
    v_pk_fma_f32 v[46:47], v[136:137], v[110:111], v[46:47] op_sel:[0,0,0] op_sel_hi:[0,1,1]
    v_pk_fma_f32 v[48:49], v[136:137], v[112:113], v[48:49] op_sel:[0,0,0] op_sel_hi:[0,1,1]
    v_pk_fma_f32 v[50:51], v[136:137], v[114:115], v[50:51] op_sel:[0,0,0] op_sel_hi:[0,1,1]
    v_pk_fma_f32 v[52:53], v[136:137], v[116:117], v[52:53] op_sel:[0,0,0] op_sel_hi:[0,1,1]
    v_pk_fma_f32 v[54:55], v[136:137], v[118:119], v[54:55] op_sel:[0,0,0] op_sel_hi:[0,1,1]
    v_cvt_pk_bf16_f32 v140, v40, v41
    v_cvt_pk_bf16_f32 v141, v42, v43
    v_cvt_pk_bf16_f32 v142, v44, v45
    v_cvt_pk_bf16_f32 v143, v46, v47
    v_cvt_pk_bf16_f32 v144, v48, v49
    v_cvt_pk_bf16_f32 v145, v50, v51
    v_cvt_pk_bf16_f32 v146, v52, v53
    v_cvt_pk_bf16_f32 v147, v54, v55
    s_add_u32 s44, s43, 0
    s_nop 0
    v_permlane32_swap_b32 v140, v142
    v_permlane32_swap_b32 v141, v143
    v_permlane32_swap_b32 v144, v146
    v_permlane32_swap_b32 v145, v147
    s_nop 1
    buffer_store_dwordx4 v[140:143], v156, s[12:15], s44 offen offset:0 sc1
    buffer_store_dwordx4 v[144:147], v156, s[12:15], s44 offen offset:1024 sc1
    v_pk_mul_f32 v[56:57], v[56:57], v[136:137] op_sel:[0,1] op_sel_hi:[1,1]
    v_pk_mul_f32 v[58:59], v[58:59], v[136:137] op_sel:[0,1] op_sel_hi:[1,1]
    v_pk_mul_f32 v[60:61], v[60:61], v[136:137] op_sel:[0,1] op_sel_hi:[1,1]
    v_pk_mul_f32 v[62:63], v[62:63], v[136:137] op_sel:[0,1] op_sel_hi:[1,1]
    v_pk_mul_f32 v[64:65], v[64:65], v[136:137] op_sel:[0,1] op_sel_hi:[1,1]
    v_pk_mul_f32 v[66:67], v[66:67], v[136:137] op_sel:[0,1] op_sel_hi:[1,1]
    v_pk_mul_f32 v[68:69], v[68:69], v[136:137] op_sel:[0,1] op_sel_hi:[1,1]
    v_pk_mul_f32 v[70:71], v[70:71], v[136:137] op_sel:[0,1] op_sel_hi:[1,1]
    v_pk_fma_f32 v[56:57], v[136:137], v[120:121], v[56:57] op_sel:[0,0,0] op_sel_hi:[0,1,1]
    v_pk_fma_f32 v[58:59], v[136:137], v[122:123], v[58:59] op_sel:[0,0,0] op_sel_hi:[0,1,1]
    v_pk_fma_f32 v[60:61], v[136:137], v[124:125], v[60:61] op_sel:[0,0,0] op_sel_hi:[0,1,1]
    v_pk_fma_f32 v[62:63], v[136:137], v[126:127], v[62:63] op_sel:[0,0,0] op_sel_hi:[0,1,1]
    v_pk_fma_f32 v[64:65], v[136:137], v[128:129], v[64:65] op_sel:[0,0,0] op_sel_hi:[0,1,1]
    v_pk_fma_f32 v[66:67], v[136:137], v[130:131], v[66:67] op_sel:[0,0,0] op_sel_hi:[0,1,1]
    v_pk_fma_f32 v[68:69], v[136:137], v[132:133], v[68:69] op_sel:[0,0,0] op_sel_hi:[0,1,1]
    v_pk_fma_f32 v[70:71], v[136:137], v[134:135], v[70:71] op_sel:[0,0,0] op_sel_hi:[0,1,1]
    v_cvt_pk_bf16_f32 v148, v56, v57
    v_cvt_pk_bf16_f32 v149, v58, v59
    v_cvt_pk_bf16_f32 v150, v60, v61
    v_cvt_pk_bf16_f32 v151, v62, v63
    v_cvt_pk_bf16_f32 v152, v64, v65
    v_cvt_pk_bf16_f32 v153, v66, v67
    v_cvt_pk_bf16_f32 v154, v68, v69
    v_cvt_pk_bf16_f32 v155, v70, v71
    s_add_u32 s44, s43, 2048
    s_nop 0
    v_permlane32_swap_b32 v148, v150
    v_permlane32_swap_b32 v149, v151
    v_permlane32_swap_b32 v152, v154
    v_permlane32_swap_b32 v153, v155
    s_nop 1
    buffer_store_dwordx4 v[148:151], v156, s[12:15], s44 offen offset:0 sc1
    buffer_store_dwordx4 v[152:155], v156, s[12:15], s44 offen offset:1024 sc1
    v_pk_mul_f32 v[72:73], v[72:73], v[138:139] op_sel:[0,1] op_sel_hi:[1,1]
    v_pk_mul_f32 v[74:75], v[74:75], v[138:139] op_sel:[0,1] op_sel_hi:[1,1]
    v_pk_mul_f32 v[76:77], v[76:77], v[138:139] op_sel:[0,1] op_sel_hi:[1,1]
    v_pk_mul_f32 v[78:79], v[78:79], v[138:139] op_sel:[0,1] op_sel_hi:[1,1]
    v_pk_mul_f32 v[80:81], v[80:81], v[138:139] op_sel:[0,1] op_sel_hi:[1,1]
    v_pk_mul_f32 v[82:83], v[82:83], v[138:139] op_sel:[0,1] op_sel_hi:[1,1]
    v_pk_mul_f32 v[84:85], v[84:85], v[138:139] op_sel:[0,1] op_sel_hi:[1,1]
    v_pk_mul_f32 v[86:87], v[86:87], v[138:139] op_sel:[0,1] op_sel_hi:[1,1]
    v_pk_fma_f32 v[72:73], v[138:139], v[104:105], v[72:73] op_sel:[0,0,0] op_sel_hi:[0,1,1]
    v_pk_fma_f32 v[74:75], v[138:139], v[106:107], v[74:75] op_sel:[0,0,0] op_sel_hi:[0,1,1]
    v_pk_fma_f32 v[76:77], v[138:139], v[108:109], v[76:77] op_sel:[0,0,0] op_sel_hi:[0,1,1]
    v_pk_fma_f32 v[78:79], v[138:139], v[110:111], v[78:79] op_sel:[0,0,0] op_sel_hi:[0,1,1]
    v_pk_fma_f32 v[80:81], v[138:139], v[112:113], v[80:81] op_sel:[0,0,0] op_sel_hi:[0,1,1]
    v_pk_fma_f32 v[82:83], v[138:139], v[114:115], v[82:83] op_sel:[0,0,0] op_sel_hi:[0,1,1]
    v_pk_fma_f32 v[84:85], v[138:139], v[116:117], v[84:85] op_sel:[0,0,0] op_sel_hi:[0,1,1]
    v_pk_fma_f32 v[86:87], v[138:139], v[118:119], v[86:87] op_sel:[0,0,0] op_sel_hi:[0,1,1]
    v_cvt_pk_bf16_f32 v140, v72, v73
    v_cvt_pk_bf16_f32 v141, v74, v75
    v_cvt_pk_bf16_f32 v142, v76, v77
    v_cvt_pk_bf16_f32 v143, v78, v79
    v_cvt_pk_bf16_f32 v144, v80, v81
    v_cvt_pk_bf16_f32 v145, v82, v83
    v_cvt_pk_bf16_f32 v146, v84, v85
    v_cvt_pk_bf16_f32 v147, v86, v87
    s_add_u32 s44, s43, 32768
    s_nop 0
    v_permlane32_swap_b32 v140, v142
    v_permlane32_swap_b32 v141, v143
    v_permlane32_swap_b32 v144, v146
    v_permlane32_swap_b32 v145, v147
    s_nop 1
    buffer_store_dwordx4 v[140:143], v156, s[12:15], s44 offen offset:0 sc1
    buffer_store_dwordx4 v[144:147], v156, s[12:15], s44 offen offset:1024 sc1
    v_pk_mul_f32 v[88:89], v[88:89], v[138:139] op_sel:[0,1] op_sel_hi:[1,1]
    v_pk_mul_f32 v[90:91], v[90:91], v[138:139] op_sel:[0,1] op_sel_hi:[1,1]
    v_pk_mul_f32 v[92:93], v[92:93], v[138:139] op_sel:[0,1] op_sel_hi:[1,1]
    v_pk_mul_f32 v[94:95], v[94:95], v[138:139] op_sel:[0,1] op_sel_hi:[1,1]
    v_pk_mul_f32 v[96:97], v[96:97], v[138:139] op_sel:[0,1] op_sel_hi:[1,1]
    v_pk_mul_f32 v[98:99], v[98:99], v[138:139] op_sel:[0,1] op_sel_hi:[1,1]
    v_pk_mul_f32 v[100:101], v[100:101], v[138:139] op_sel:[0,1] op_sel_hi:[1,1]
    v_pk_mul_f32 v[102:103], v[102:103], v[138:139] op_sel:[0,1] op_sel_hi:[1,1]
    v_pk_fma_f32 v[88:89], v[138:139], v[120:121], v[88:89] op_sel:[0,0,0] op_sel_hi:[0,1,1]
    v_pk_fma_f32 v[90:91], v[138:139], v[122:123], v[90:91] op_sel:[0,0,0] op_sel_hi:[0,1,1]
    v_pk_fma_f32 v[92:93], v[138:139], v[124:125], v[92:93] op_sel:[0,0,0] op_sel_hi:[0,1,1]
    v_pk_fma_f32 v[94:95], v[138:139], v[126:127], v[94:95] op_sel:[0,0,0] op_sel_hi:[0,1,1]
    v_pk_fma_f32 v[96:97], v[138:139], v[128:129], v[96:97] op_sel:[0,0,0] op_sel_hi:[0,1,1]
    v_pk_fma_f32 v[98:99], v[138:139], v[130:131], v[98:99] op_sel:[0,0,0] op_sel_hi:[0,1,1]
    v_pk_fma_f32 v[100:101], v[138:139], v[132:133], v[100:101] op_sel:[0,0,0] op_sel_hi:[0,1,1]
    v_pk_fma_f32 v[102:103], v[138:139], v[134:135], v[102:103] op_sel:[0,0,0] op_sel_hi:[0,1,1]
    v_cvt_pk_bf16_f32 v148, v88, v89
    v_cvt_pk_bf16_f32 v149, v90, v91
    v_cvt_pk_bf16_f32 v150, v92, v93
    v_cvt_pk_bf16_f32 v151, v94, v95
    v_cvt_pk_bf16_f32 v152, v96, v97
    v_cvt_pk_bf16_f32 v153, v98, v99
    v_cvt_pk_bf16_f32 v154, v100, v101
    v_cvt_pk_bf16_f32 v155, v102, v103
    s_add_u32 s44, s43, 34816
    s_nop 0
    v_permlane32_swap_b32 v148, v150
    v_permlane32_swap_b32 v149, v151
    v_permlane32_swap_b32 v152, v154
    v_permlane32_swap_b32 v153, v155
    s_nop 1
    buffer_store_dwordx4 v[148:151], v156, s[12:15], s44 offen offset:0 sc1
    buffer_store_dwordx4 v[152:155], v156, s[12:15], s44 offen offset:1024 sc1
    s_waitcnt vmcnt(0)
    s_barrier
    s_cmp_lg_u32 s36, 0
    s_cbranch_scc1 Lsig_68
    s_and_b32 s43, s38, 3
    s_lshl_b32 s43, s43, 3
    v_lshrrev_b32 v2, 3, v1
    v_add_u32 v2, s43, v2
    v_and_b32 v3, 3, v2
    v_lshrrev_b32 v2, 2, v2
    v_lshl_add_u32 v2, v3, 3, v2
    v_and_b32 v3, 7, v1
    v_lshl_add_u32 v2, v3, 5, v2
    v_lshlrev_b32 v2, 7, v2
    s_lshl_b32 s43, 1, s37
    v_mov_b32 v3, s43
    s_and_b32 s43, s38, 12
    s_add_u32 s43, s43, 0x1680014
    s_mov_b32 exec_lo, 0xffffffff
    s_mov_b32 exec_hi, 0xffffffff
    buffer_atomic_or v3, v2, s[12:15], s43 offen sc1
    s_mov_b64 exec, -1
Lsig_68:
    s_branch g1_done
g1_v:
    s_mul_i32 s42, s36, 49152
    s_add_u32 s42, s42, s39
    s_lshr_b32 s52, s36, 1
    s_and_b32 s53, s36, 1
    s_and_b32 s54, s36, 3
    s_lshr_b32 s55, s36, 2
    s_lshl_b32 s50, s54, 10
    s_add_u32 s51, s50, 49152
    v_lshrrev_b32 v4, 2, v1
    s_mov_b32 s48, 3072
    v_mul_lo_u32 v7, v4, s48
    v_and_b32 v4, 3, v1
    v_lshl_add_u32 v7, v4, 4, v7
    v_lshlrev_b32 v8, 4, v1
    s_and_b32 s48, s36, 1
    s_lshl_b32 s48, s48, 2
    v_lshrrev_b32 v4, 4, v1
    v_add_u32 v4, s48, v4
    v_and_b32 v5, 7, v1
    v_xor_b32 v4, v4, v5
    v_lshrrev_b32 v5, 3, v1
    v_lshlrev_b32 v5, 10, v5
    v_lshl_add_u32 v9, v4, 4, v5
    v_and_b32 v4, 31, v1
    v_lshrrev_b32 v5, 1, v4
    v_and_b32 v5, 7, v5
    v_lshrrev_b32 v6, 5, v1
    v_xor_b32 v5, v5, v6
    v_lshlrev_b32 v4, 7, v4
    s_mul_i32 s48, s52, 8192
    v_add_u32 v4, s48, v4
    v_xor_b32 v6, 0, v5
    v_lshl_add_u32 v10, v6, 4, v4
    v_xor_b32 v6, 2, v5
    v_lshl_add_u32 v11, v6, 4, v4
    v_xor_b32 v6, 4, v5
    v_lshl_add_u32 v12, v6, 4, v4
    v_xor_b32 v6, 6, v5
    v_lshl_add_u32 v13, v6, 4, v4
    v_lshrrev_b32 v4, 5, v1
    v_lshlrev_b32 v4, 9, v4
    v_bfe_u32 v5, v1, 2, 2
    v_lshl_add_u32 v4, v5, 6, v4
    v_bfe_u32 v5, v1, 4, 1
    v_lshl_add_u32 v4, v5, 5, v4
    v_and_b32 v5, 3, v1
    v_lshl_add_u32 v4, v5, 3, v4
    s_mul_i32 s48, s53, 8192
    s_add_u32 s48, s48, 49152
    v_add_u32 v14, s48, v4
    v_mov_b32 v32, 0x3f803f80
    v_mov_b32 v33, 0x3f803f80
    v_mov_b32 v34, 0x3f803f80
    v_mov_b32 v35, 0x3f803f80
    s_add_u32 m0, s50, 0
    s_add_u32 s58, s60, 0
    s_and_b32 s58, s58, 7
    s_lshl_b32 s59, s58, 7
    s_add_u32 s59, s59, s40
    s_mul_i32 s63, s58, 196608
    s_add_u32 s63, s63, s42
    s_add_u32 s48, s59, 0
    buffer_load_dwordx4 v9, s[4:7], s48 offen  lds
    s_add_u32 m0, s50, 4096
    s_add_u32 s48, s59, 32768
    buffer_load_dwordx4 v9, s[4:7], s48 offen  lds
    s_add_u32 m0, s50, 8192
    s_add_u32 s48, s59, 65536
    buffer_load_dwordx4 v9, s[4:7], s48 offen  lds
    s_add_u32 m0, s50, 12288
    s_add_u32 s48, s59, 98304
    buffer_load_dwordx4 v9, s[4:7], s48 offen  lds
    s_add_u32 m0, s51, 0
    s_add_u32 s49, s63, 0
    buffer_load_dwordx4 v7, s[8:11], s49 offen lds
    s_add_u32 m0, s51, 4096
    s_add_u32 s49, s63, 64
    buffer_load_dwordx4 v7, s[8:11], s49 offen lds
    s_add_u32 m0, s51, 8192
    s_add_u32 s49, s63, 128
    buffer_load_dwordx4 v7, s[8:11], s49 offen lds
    s_add_u32 m0, s51, 12288
    s_add_u32 s49, s63, 192
    buffer_load_dwordx4 v7, s[8:11], s49 offen lds
    s_add_u32 m0, s50, 16384
    s_add_u32 s58, s60, 1
    s_and_b32 s58, s58, 7
    s_lshl_b32 s59, s58, 7
    s_add_u32 s59, s59, s40
    s_mul_i32 s63, s58, 196608
    s_add_u32 s63, s63, s42
    s_add_u32 s48, s59, 0
    buffer_load_dwordx4 v9, s[4:7], s48 offen  lds
    s_add_u32 m0, s50, 20480
    s_add_u32 s48, s59, 32768
    buffer_load_dwordx4 v9, s[4:7], s48 offen  lds
    s_add_u32 m0, s50, 24576
    s_add_u32 s48, s59, 65536
    buffer_load_dwordx4 v9, s[4:7], s48 offen  lds
    s_add_u32 m0, s50, 28672
    s_add_u32 s48, s59, 98304
    buffer_load_dwordx4 v9, s[4:7], s48 offen  lds
    s_add_u32 m0, s51, 16384
    s_add_u32 s49, s63, 0
    buffer_load_dwordx4 v7, s[8:11], s49 offen lds
    s_add_u32 m0, s51, 20480
    s_add_u32 s49, s63, 64
    buffer_load_dwordx4 v7, s[8:11], s49 offen lds
    s_add_u32 m0, s51, 24576
    s_add_u32 s49, s63, 128
    buffer_load_dwordx4 v7, s[8:11], s49 offen lds
    s_add_u32 m0, s51, 28672
    s_add_u32 s49, s63, 192
    buffer_load_dwordx4 v7, s[8:11], s49 offen lds
    v_mov_b32 v40, 0
    v_mov_b32 v41, 0
    v_mov_b32 v42, 0
    v_mov_b32 v43, 0
    v_mov_b32 v44, 0
    v_mov_b32 v45, 0
    v_mov_b32 v46, 0
    v_mov_b32 v47, 0
    v_mov_b32 v48, 0
    v_mov_b32 v49, 0
    v_mov_b32 v50, 0
    v_mov_b32 v51, 0
    v_mov_b32 v52, 0
    v_mov_b32 v53, 0
    v_mov_b32 v54, 0
    v_mov_b32 v55, 0
    v_mov_b32 v56, 0
    v_mov_b32 v57, 0
    v_mov_b32 v58, 0
    v_mov_b32 v59, 0
    v_mov_b32 v60, 0
    v_mov_b32 v61, 0
    v_mov_b32 v62, 0
    v_mov_b32 v63, 0
    v_mov_b32 v64, 0
    v_mov_b32 v65, 0
    v_mov_b32 v66, 0
    v_mov_b32 v67, 0
    v_mov_b32 v68, 0
    v_mov_b32 v69, 0
    v_mov_b32 v70, 0
    v_mov_b32 v71, 0
    v_mov_b32 v72, 0
    v_mov_b32 v73, 0
    v_mov_b32 v74, 0
    v_mov_b32 v75, 0
    v_mov_b32 v76, 0
    v_mov_b32 v77, 0
    v_mov_b32 v78, 0
    v_mov_b32 v79, 0
    v_mov_b32 v80, 0
    v_mov_b32 v81, 0
    v_mov_b32 v82, 0
    v_mov_b32 v83, 0
    v_mov_b32 v84, 0
    v_mov_b32 v85, 0
    v_mov_b32 v86, 0
    v_mov_b32 v87, 0
    v_mov_b32 v88, 0
    v_mov_b32 v89, 0
    v_mov_b32 v90, 0
    v_mov_b32 v91, 0
    v_mov_b32 v92, 0
    v_mov_b32 v93, 0
    v_mov_b32 v94, 0
    v_mov_b32 v95, 0
    v_mov_b32 v96, 0
    v_mov_b32 v97, 0
    v_mov_b32 v98, 0
    v_mov_b32 v99, 0
    v_mov_b32 v100, 0
    v_mov_b32 v101, 0
    v_mov_b32 v102, 0
    v_mov_b32 v103, 0
    s_waitcnt vmcnt(8) lgkmcnt(0)
    s_barrier
    ds_read_b128 v[104:107], v10 offset:0
    ds_read_b64_tr_b16 v[120:121], v14 offset:0
    ds_read_b64_tr_b16 v[122:123], v14 offset:256
    ds_read_b64_tr_b16 v[124:125], v14 offset:4096
    ds_read_b64_tr_b16 v[126:127], v14 offset:4352
    ds_read_b128 v[108:111], v10 offset:4096
    s_waitcnt lgkmcnt(3)
    v_mfma_f32_32x32x16_bf16 v[40:55], v[104:107], v[120:123], v[40:55]
    ds_read_b128 v[112:115], v11 offset:0
    ds_read_b64_tr_b16 v[128:129], v14 offset:1024
    s_waitcnt lgkmcnt(3)
    v_mfma_f32_32x32x16_bf16 v[56:71], v[104:107], v[124:127], v[56:71]
    ds_read_b64_tr_b16 v[130:131], v14 offset:1280
    ds_read_b64_tr_b16 v[132:133], v14 offset:5120
    s_waitcnt lgkmcnt(4)
    v_mfma_f32_32x32x16_bf16 v[72:87], v[108:111], v[120:123], v[72:87]
    ds_read_b64_tr_b16 v[134:135], v14 offset:5376
    ds_read_b128 v[116:119], v11 offset:4096
    s_add_u32 m0, s50, 32768
    s_add_u32 s58, s60, 2
    s_and_b32 s58, s58, 7
    s_lshl_b32 s59, s58, 7
    s_add_u32 s59, s59, s40
    s_mul_i32 s63, s58, 196608
    s_add_u32 s63, s63, s42
    s_add_u32 s48, s59, 0
    buffer_load_dwordx4 v9, s[4:7], s48 offen  lds
    v_mfma_f32_32x32x16_bf16 v[88:103], v[108:111], v[124:127], v[88:103]
    s_add_u32 m0, s50, 36864
    s_add_u32 s48, s59, 32768
    buffer_load_dwordx4 v9, s[4:7], s48 offen  lds
    s_cmp_lg_u32 s52, 0
    s_cbranch_scc1 Lc0_69
    v_mfma_f32_32x32x16_bf16 v[16:31], v[32:35], v[120:123], 0
    s_branch Lc1_70
Lc0_69:
    v_mfma_f32_32x32x16_bf16 v[16:31], v[32:35], v[124:127], 0
Lc1_70:
    s_waitcnt lgkmcnt(3)
    v_mfma_f32_32x32x16_bf16 v[40:55], v[112:115], v[128:131], v[40:55]
    ds_read_b128 v[104:107], v12 offset:0
    ds_read_b64_tr_b16 v[120:121], v14 offset:2048
    s_waitcnt lgkmcnt(3)
    v_mfma_f32_32x32x16_bf16 v[56:71], v[112:115], v[132:135], v[56:71]
    ds_read_b64_tr_b16 v[122:123], v14 offset:2304
    ds_read_b64_tr_b16 v[124:125], v14 offset:6144
    s_waitcnt lgkmcnt(4)
    v_mfma_f32_32x32x16_bf16 v[72:87], v[116:119], v[128:131], v[72:87]
    ds_read_b64_tr_b16 v[126:127], v14 offset:6400
    ds_read_b128 v[108:111], v12 offset:4096
    s_add_u32 m0, s50, 40960
    s_add_u32 s48, s59, 65536
    buffer_load_dwordx4 v9, s[4:7], s48 offen  lds
    v_mfma_f32_32x32x16_bf16 v[88:103], v[116:119], v[132:135], v[88:103]
    s_add_u32 m0, s50, 45056
    s_add_u32 s48, s59, 98304
    buffer_load_dwordx4 v9, s[4:7], s48 offen  lds
    s_cmp_lg_u32 s52, 0
    s_cbranch_scc1 Lc0_71
    v_mfma_f32_32x32x16_bf16 v[16:31], v[32:35], v[128:131], v[16:31]
    s_branch Lc1_72
Lc0_71:
    v_mfma_f32_32x32x16_bf16 v[16:31], v[32:35], v[132:135], v[16:31]
Lc1_72:
    s_waitcnt lgkmcnt(3)
    v_mfma_f32_32x32x16_bf16 v[40:55], v[104:107], v[120:123], v[40:55]
    ds_read_b128 v[112:115], v13 offset:0
    ds_read_b64_tr_b16 v[128:129], v14 offset:3072
    s_waitcnt lgkmcnt(3)
    v_mfma_f32_32x32x16_bf16 v[56:71], v[104:107], v[124:127], v[56:71]
    ds_read_b64_tr_b16 v[130:131], v14 offset:3328
    ds_read_b64_tr_b16 v[132:133], v14 offset:7168
    s_waitcnt lgkmcnt(4)
    v_mfma_f32_32x32x16_bf16 v[72:87], v[108:111], v[120:123], v[72:87]
    ds_read_b64_tr_b16 v[134:135], v14 offset:7424
    ds_read_b128 v[116:119], v13 offset:4096
    s_add_u32 m0, s51, 32768
    s_add_u32 s49, s63, 0
    buffer_load_dwordx4 v7, s[8:11], s49 offen lds
    v_mfma_f32_32x32x16_bf16 v[88:103], v[108:111], v[124:127], v[88:103]
    s_add_u32 m0, s51, 36864
    s_add_u32 s49, s63, 64
    buffer_load_dwordx4 v7, s[8:11], s49 offen lds
    s_cmp_lg_u32 s52, 0
    s_cbranch_scc1 Lc0_73
    v_mfma_f32_32x32x16_bf16 v[16:31], v[32:35], v[120:123], v[16:31]
    s_branch Lc1_74
Lc0_73:
    v_mfma_f32_32x32x16_bf16 v[16:31], v[32:35], v[124:127], v[16:31]
Lc1_74:
    s_add_u32 m0, s51, 40960
    s_add_u32 s49, s63, 128
    buffer_load_dwordx4 v7, s[8:11], s49 offen lds
    s_add_u32 m0, s51, 45056
    s_add_u32 s49, s63, 192
    buffer_load_dwordx4 v7, s[8:11], s49 offen lds
    s_waitcnt vmcnt(8) lgkmcnt(0)
    s_barrier
    v_mfma_f32_32x32x16_bf16 v[40:55], v[112:115], v[128:131], v[40:55]
    ds_read_b128 v[104:107], v10 offset:16384
    ds_read_b64_tr_b16 v[120:121], v14 offset:16384
    v_mfma_f32_32x32x16_bf16 v[56:71], v[112:115], v[132:135], v[56:71]
    ds_read_b64_tr_b16 v[122:123], v14 offset:16640
    ds_read_b64_tr_b16 v[124:125], v14 offset:20480
    v_mfma_f32_32x32x16_bf16 v[72:87], v[116:119], v[128:131], v[72:87]
    ds_read_b64_tr_b16 v[126:127], v14 offset:20736
    ds_read_b128 v[108:111], v10 offset:20480
    s_add_u32 m0, s50, 0
    s_add_u32 s58, s60, 3
    s_and_b32 s58, s58, 7
    s_lshl_b32 s59, s58, 7
    s_add_u32 s59, s59, s40
    s_mul_i32 s63, s58, 196608
    s_add_u32 s63, s63, s42
    s_add_u32 s48, s59, 0
    buffer_load_dwordx4 v9, s[4:7], s48 offen  lds
    v_mfma_f32_32x32x16_bf16 v[88:103], v[116:119], v[132:135], v[88:103]
    s_add_u32 m0, s50, 4096
    s_add_u32 s48, s59, 32768
    buffer_load_dwordx4 v9, s[4:7], s48 offen  lds
    s_cmp_lg_u32 s52, 0
    s_cbranch_scc1 Lc0_75
    v_mfma_f32_32x32x16_bf16 v[16:31], v[32:35], v[128:131], v[16:31]
    s_branch Lc1_76
Lc0_75:
    v_mfma_f32_32x32x16_bf16 v[16:31], v[32:35], v[132:135], v[16:31]
Lc1_76:
    s_waitcnt lgkmcnt(3)
    v_mfma_f32_32x32x16_bf16 v[40:55], v[104:107], v[120:123], v[40:55]
    ds_read_b128 v[112:115], v11 offset:16384
    ds_read_b64_tr_b16 v[128:129], v14 offset:17408
    s_waitcnt lgkmcnt(3)
    v_mfma_f32_32x32x16_bf16 v[56:71], v[104:107], v[124:127], v[56:71]
    ds_read_b64_tr_b16 v[130:131], v14 offset:17664
    ds_read_b64_tr_b16 v[132:133], v14 offset:21504
    s_waitcnt lgkmcnt(4)
    v_mfma_f32_32x32x16_bf16 v[72:87], v[108:111], v[120:123], v[72:87]
    ds_read_b64_tr_b16 v[134:135], v14 offset:21760
    ds_read_b128 v[116:119], v11 offset:20480
    s_add_u32 m0, s50, 8192
    s_add_u32 s48, s59, 65536
    buffer_load_dwordx4 v9, s[4:7], s48 offen  lds
    v_mfma_f32_32x32x16_bf16 v[88:103], v[108:111], v[124:127], v[88:103]
    s_add_u32 m0, s50, 12288
    s_add_u32 s48, s59, 98304
    buffer_load_dwordx4 v9, s[4:7], s48 offen  lds
    s_cmp_lg_u32 s52, 0
    s_cbranch_scc1 Lc0_77
    v_mfma_f32_32x32x16_bf16 v[16:31], v[32:35], v[120:123], v[16:31]
    s_branch Lc1_78
Lc0_77:
    v_mfma_f32_32x32x16_bf16 v[16:31], v[32:35], v[124:127], v[16:31]
Lc1_78:
    s_waitcnt lgkmcnt(3)
    v_mfma_f32_32x32x16_bf16 v[40:55], v[112:115], v[128:131], v[40:55]
    ds_read_b128 v[104:107], v12 offset:16384
    ds_read_b64_tr_b16 v[120:121], v14 offset:18432
    s_waitcnt lgkmcnt(3)
    v_mfma_f32_32x32x16_bf16 v[56:71], v[112:115], v[132:135], v[56:71]
    ds_read_b64_tr_b16 v[122:123], v14 offset:18688
    ds_read_b64_tr_b16 v[124:125], v14 offset:22528
    s_waitcnt lgkmcnt(4)
    v_mfma_f32_32x32x16_bf16 v[72:87], v[116:119], v[128:131], v[72:87]
    ds_read_b64_tr_b16 v[126:127], v14 offset:22784
    ds_read_b128 v[108:111], v12 offset:20480
    s_add_u32 m0, s51, 0
    s_add_u32 s49, s63, 0
    buffer_load_dwordx4 v7, s[8:11], s49 offen lds
    v_mfma_f32_32x32x16_bf16 v[88:103], v[116:119], v[132:135], v[88:103]
    s_add_u32 m0, s51, 4096
    s_add_u32 s49, s63, 64
    buffer_load_dwordx4 v7, s[8:11], s49 offen lds
    s_cmp_lg_u32 s52, 0
    s_cbranch_scc1 Lc0_79
    v_mfma_f32_32x32x16_bf16 v[16:31], v[32:35], v[128:131], v[16:31]
    s_branch Lc1_80
Lc0_79:
    v_mfma_f32_32x32x16_bf16 v[16:31], v[32:35], v[132:135], v[16:31]
Lc1_80:
    s_waitcnt lgkmcnt(3)
    v_mfma_f32_32x32x16_bf16 v[40:55], v[104:107], v[120:123], v[40:55]
    ds_read_b128 v[112:115], v13 offset:16384
    ds_read_b64_tr_b16 v[128:129], v14 offset:19456
    s_waitcnt lgkmcnt(3)
    v_mfma_f32_32x32x16_bf16 v[56:71], v[104:107], v[124:127], v[56:71]
    ds_read_b64_tr_b16 v[130:131], v14 offset:19712
    ds_read_b64_tr_b16 v[132:133], v14 offset:23552
    s_waitcnt lgkmcnt(4)
    v_mfma_f32_32x32x16_bf16 v[72:87], v[108:111], v[120:123], v[72:87]
    ds_read_b64_tr_b16 v[134:135], v14 offset:23808
    ds_read_b128 v[116:119], v13 offset:20480
    s_add_u32 m0, s51, 8192
    s_add_u32 s49, s63, 128
    buffer_load_dwordx4 v7, s[8:11], s49 offen lds
    v_mfma_f32_32x32x16_bf16 v[88:103], v[108:111], v[124:127], v[88:103]
    s_cmp_lg_u32 s52, 0
    s_cbranch_scc1 Lc0_81
    v_mfma_f32_32x32x16_bf16 v[16:31], v[32:35], v[120:123], v[16:31]
    s_branch Lc1_82
Lc0_81:
    v_mfma_f32_32x32x16_bf16 v[16:31], v[32:35], v[124:127], v[16:31]
Lc1_82:
    s_add_u32 m0, s51, 12288
    s_add_u32 s49, s63, 192
    buffer_load_dwordx4 v7, s[8:11], s49 offen lds
    s_waitcnt vmcnt(8) lgkmcnt(0)
    s_barrier
    v_mfma_f32_32x32x16_bf16 v[40:55], v[112:115], v[128:131], v[40:55]
    ds_read_b128 v[104:107], v10 offset:32768
    ds_read_b64_tr_b16 v[120:121], v14 offset:32768
    v_mfma_f32_32x32x16_bf16 v[56:71], v[112:115], v[132:135], v[56:71]
    ds_read_b64_tr_b16 v[122:123], v14 offset:33024
    ds_read_b64_tr_b16 v[124:125], v14 offset:36864
    v_mfma_f32_32x32x16_bf16 v[72:87], v[116:119], v[128:131], v[72:87]
    ds_read_b64_tr_b16 v[126:127], v14 offset:37120
    ds_read_b128 v[108:111], v10 offset:36864
    s_add_u32 m0, s50, 16384
    s_add_u32 s58, s60, 4
    s_and_b32 s58, s58, 7
    s_lshl_b32 s59, s58, 7
    s_add_u32 s59, s59, s40
    s_mul_i32 s63, s58, 196608
    s_add_u32 s63, s63, s42
    s_add_u32 s48, s59, 0
    buffer_load_dwordx4 v9, s[4:7], s48 offen  lds
    v_mfma_f32_32x32x16_bf16 v[88:103], v[116:119], v[132:135], v[88:103]
    s_add_u32 m0, s50, 20480
    s_add_u32 s48, s59, 32768
    buffer_load_dwordx4 v9, s[4:7], s48 offen  lds
    s_cmp_lg_u32 s52, 0
    s_cbranch_scc1 Lc0_83
    v_mfma_f32_32x32x16_bf16 v[16:31], v[32:35], v[128:131], v[16:31]
    s_branch Lc1_84
Lc0_83:
    v_mfma_f32_32x32x16_bf16 v[16:31], v[32:35], v[132:135], v[16:31]
Lc1_84:
    s_waitcnt lgkmcnt(3)
    v_mfma_f32_32x32x16_bf16 v[40:55], v[104:107], v[120:123], v[40:55]
    ds_read_b128 v[112:115], v11 offset:32768
    ds_read_b64_tr_b16 v[128:129], v14 offset:33792
    s_waitcnt lgkmcnt(3)
    v_mfma_f32_32x32x16_bf16 v[56:71], v[104:107], v[124:127], v[56:71]
    ds_read_b64_tr_b16 v[130:131], v14 offset:34048
    ds_read_b64_tr_b16 v[132:133], v14 offset:37888
    s_waitcnt lgkmcnt(4)
    v_mfma_f32_32x32x16_bf16 v[72:87], v[108:111], v[120:123], v[72:87]
    ds_read_b64_tr_b16 v[134:135], v14 offset:38144
    ds_read_b128 v[116:119], v11 offset:36864
    s_add_u32 m0, s50, 24576
    s_add_u32 s48, s59, 65536
    buffer_load_dwordx4 v9, s[4:7], s48 offen  lds
    v_mfma_f32_32x32x16_bf16 v[88:103], v[108:111], v[124:127], v[88:103]
    s_add_u32 m0, s50, 28672
    s_add_u32 s48, s59, 98304
    buffer_load_dwordx4 v9, s[4:7], s48 offen  lds
    s_cmp_lg_u32 s52, 0
    s_cbranch_scc1 Lc0_85
    v_mfma_f32_32x32x16_bf16 v[16:31], v[32:35], v[120:123], v[16:31]
    s_branch Lc1_86
Lc0_85:
    v_mfma_f32_32x32x16_bf16 v[16:31], v[32:35], v[124:127], v[16:31]
Lc1_86:
    s_waitcnt lgkmcnt(3)
    v_mfma_f32_32x32x16_bf16 v[40:55], v[112:115], v[128:131], v[40:55]
    ds_read_b128 v[104:107], v12 offset:32768
    ds_read_b64_tr_b16 v[120:121], v14 offset:34816
    s_waitcnt lgkmcnt(3)
    v_mfma_f32_32x32x16_bf16 v[56:71], v[112:115], v[132:135], v[56:71]
    ds_read_b64_tr_b16 v[122:123], v14 offset:35072
    ds_read_b64_tr_b16 v[124:125], v14 offset:38912
    s_waitcnt lgkmcnt(4)
    v_mfma_f32_32x32x16_bf16 v[72:87], v[116:119], v[128:131], v[72:87]
    ds_read_b64_tr_b16 v[126:127], v14 offset:39168
    ds_read_b128 v[108:111], v12 offset:36864
    s_add_u32 m0, s51, 16384
    s_add_u32 s49, s63, 0
    buffer_load_dwordx4 v7, s[8:11], s49 offen lds
    v_mfma_f32_32x32x16_bf16 v[88:103], v[116:119], v[132:135], v[88:103]
    s_add_u32 m0, s51, 20480
    s_add_u32 s49, s63, 64
    buffer_load_dwordx4 v7, s[8:11], s49 offen lds
    s_cmp_lg_u32 s52, 0
    s_cbranch_scc1 Lc0_87
    v_mfma_f32_32x32x16_bf16 v[16:31], v[32:35], v[128:131], v[16:31]
    s_branch Lc1_88
Lc0_87:
    v_mfma_f32_32x32x16_bf16 v[16:31], v[32:35], v[132:135], v[16:31]
Lc1_88:
    s_waitcnt lgkmcnt(3)
    v_mfma_f32_32x32x16_bf16 v[40:55], v[104:107], v[120:123], v[40:55]
    ds_read_b128 v[112:115], v13 offset:32768
    ds_read_b64_tr_b16 v[128:129], v14 offset:35840
    s_waitcnt lgkmcnt(3)
    v_mfma_f32_32x32x16_bf16 v[56:71], v[104:107], v[124:127], v[56:71]
    ds_read_b64_tr_b16 v[130:131], v14 offset:36096
    ds_read_b64_tr_b16 v[132:133], v14 offset:39936
    s_waitcnt lgkmcnt(4)
    v_mfma_f32_32x32x16_bf16 v[72:87], v[108:111], v[120:123], v[72:87]
    ds_read_b64_tr_b16 v[134:135], v14 offset:40192
    ds_read_b128 v[116:119], v13 offset:36864
    s_add_u32 m0, s51, 24576
    s_add_u32 s49, s63, 128
    buffer_load_dwordx4 v7, s[8:11], s49 offen lds
    v_mfma_f32_32x32x16_bf16 v[88:103], v[108:111], v[124:127], v[88:103]
    s_cmp_lg_u32 s52, 0
    s_cbranch_scc1 Lc0_89
    v_mfma_f32_32x32x16_bf16 v[16:31], v[32:35], v[120:123], v[16:31]
    s_branch Lc1_90
Lc0_89:
    v_mfma_f32_32x32x16_bf16 v[16:31], v[32:35], v[124:127], v[16:31]
Lc1_90:
    s_add_u32 m0, s51, 28672
    s_add_u32 s49, s63, 192
    buffer_load_dwordx4 v7, s[8:11], s49 offen lds
    s_waitcnt vmcnt(8) lgkmcnt(0)
    s_barrier
    v_mfma_f32_32x32x16_bf16 v[40:55], v[112:115], v[128:131], v[40:55]
    ds_read_b128 v[104:107], v10 offset:0
    ds_read_b64_tr_b16 v[120:121], v14 offset:0
    v_mfma_f32_32x32x16_bf16 v[56:71], v[112:115], v[132:135], v[56:71]
    ds_read_b64_tr_b16 v[122:123], v14 offset:256
    ds_read_b64_tr_b16 v[124:125], v14 offset:4096
    v_mfma_f32_32x32x16_bf16 v[72:87], v[116:119], v[128:131], v[72:87]
    ds_read_b64_tr_b16 v[126:127], v14 offset:4352
    ds_read_b128 v[108:111], v10 offset:4096
    s_add_u32 m0, s50, 32768
    s_add_u32 s58, s60, 5
    s_and_b32 s58, s58, 7
    s_lshl_b32 s59, s58, 7
    s_add_u32 s59, s59, s40
    s_mul_i32 s63, s58, 196608
    s_add_u32 s63, s63, s42
    s_add_u32 s48, s59, 0
    buffer_load_dwordx4 v9, s[4:7], s48 offen  lds
    v_mfma_f32_32x32x16_bf16 v[88:103], v[116:119], v[132:135], v[88:103]
    s_add_u32 m0, s50, 36864
    s_add_u32 s48, s59, 32768
    buffer_load_dwordx4 v9, s[4:7], s48 offen  lds
    s_cmp_lg_u32 s52, 0
    s_cbranch_scc1 Lc0_91
    v_mfma_f32_32x32x16_bf16 v[16:31], v[32:35], v[128:131], v[16:31]
    s_branch Lc1_92
Lc0_91:
    v_mfma_f32_32x32x16_bf16 v[16:31], v[32:35], v[132:135], v[16:31]
Lc1_92:
    s_waitcnt lgkmcnt(3)
    v_mfma_f32_32x32x16_bf16 v[40:55], v[104:107], v[120:123], v[40:55]
    ds_read_b128 v[112:115], v11 offset:0
    ds_read_b64_tr_b16 v[128:129], v14 offset:1024
    s_waitcnt lgkmcnt(3)
    v_mfma_f32_32x32x16_bf16 v[56:71], v[104:107], v[124:127], v[56:71]
    ds_read_b64_tr_b16 v[130:131], v14 offset:1280
    ds_read_b64_tr_b16 v[132:133], v14 offset:5120
    s_waitcnt lgkmcnt(4)
    v_mfma_f32_32x32x16_bf16 v[72:87], v[108:111], v[120:123], v[72:87]
    ds_read_b64_tr_b16 v[134:135], v14 offset:5376
    ds_read_b128 v[116:119], v11 offset:4096
    s_add_u32 m0, s50, 40960
    s_add_u32 s48, s59, 65536
    buffer_load_dwordx4 v9, s[4:7], s48 offen  lds
    v_mfma_f32_32x32x16_bf16 v[88:103], v[108:111], v[124:127], v[88:103]
    s_add_u32 m0, s50, 45056
    s_add_u32 s48, s59, 98304
    buffer_load_dwordx4 v9, s[4:7], s48 offen  lds
    s_cmp_lg_u32 s52, 0
    s_cbranch_scc1 Lc0_93
    v_mfma_f32_32x32x16_bf16 v[16:31], v[32:35], v[120:123], v[16:31]
    s_branch Lc1_94
Lc0_93:
    v_mfma_f32_32x32x16_bf16 v[16:31], v[32:35], v[124:127], v[16:31]
Lc1_94:
    s_waitcnt lgkmcnt(3)
    v_mfma_f32_32x32x16_bf16 v[40:55], v[112:115], v[128:131], v[40:55]
    ds_read_b128 v[104:107], v12 offset:0
    ds_read_b64_tr_b16 v[120:121], v14 offset:2048
    s_waitcnt lgkmcnt(3)
    v_mfma_f32_32x32x16_bf16 v[56:71], v[112:115], v[132:135], v[56:71]
    ds_read_b64_tr_b16 v[122:123], v14 offset:2304
    ds_read_b64_tr_b16 v[124:125], v14 offset:6144
    s_waitcnt lgkmcnt(4)
    v_mfma_f32_32x32x16_bf16 v[72:87], v[116:119], v[128:131], v[72:87]
    ds_read_b64_tr_b16 v[126:127], v14 offset:6400
    ds_read_b128 v[108:111], v12 offset:4096
    s_add_u32 m0, s51, 32768
    s_add_u32 s49, s63, 0
    buffer_load_dwordx4 v7, s[8:11], s49 offen lds
    v_mfma_f32_32x32x16_bf16 v[88:103], v[116:119], v[132:135], v[88:103]
    s_add_u32 m0, s51, 36864
    s_add_u32 s49, s63, 64
    buffer_load_dwordx4 v7, s[8:11], s49 offen lds
    s_cmp_lg_u32 s52, 0
    s_cbranch_scc1 Lc0_95
    v_mfma_f32_32x32x16_bf16 v[16:31], v[32:35], v[128:131], v[16:31]
    s_branch Lc1_96
Lc0_95:
    v_mfma_f32_32x32x16_bf16 v[16:31], v[32:35], v[132:135], v[16:31]
Lc1_96:
    s_waitcnt lgkmcnt(3)
    v_mfma_f32_32x32x16_bf16 v[40:55], v[104:107], v[120:123], v[40:55]
    ds_read_b128 v[112:115], v13 offset:0
    ds_read_b64_tr_b16 v[128:129], v14 offset:3072
    s_waitcnt lgkmcnt(3)
    v_mfma_f32_32x32x16_bf16 v[56:71], v[104:107], v[124:127], v[56:71]
    ds_read_b64_tr_b16 v[130:131], v14 offset:3328
    ds_read_b64_tr_b16 v[132:133], v14 offset:7168
    s_waitcnt lgkmcnt(4)
    v_mfma_f32_32x32x16_bf16 v[72:87], v[108:111], v[120:123], v[72:87]
    ds_read_b64_tr_b16 v[134:135], v14 offset:7424
    ds_read_b128 v[116:119], v13 offset:4096
    s_add_u32 m0, s51, 40960
    s_add_u32 s49, s63, 128
    buffer_load_dwordx4 v7, s[8:11], s49 offen lds
    v_mfma_f32_32x32x16_bf16 v[88:103], v[108:111], v[124:127], v[88:103]
    s_cmp_lg_u32 s52, 0
    s_cbranch_scc1 Lc0_97
    v_mfma_f32_32x32x16_bf16 v[16:31], v[32:35], v[120:123], v[16:31]
    s_branch Lc1_98
Lc0_97:
    v_mfma_f32_32x32x16_bf16 v[16:31], v[32:35], v[124:127], v[16:31]
Lc1_98:
    s_add_u32 m0, s51, 45056
    s_add_u32 s49, s63, 192
    buffer_load_dwordx4 v7, s[8:11], s49 offen lds
    s_waitcnt vmcnt(8) lgkmcnt(0)
    s_barrier
    v_mfma_f32_32x32x16_bf16 v[40:55], v[112:115], v[128:131], v[40:55]
    ds_read_b128 v[104:107], v10 offset:16384
    ds_read_b64_tr_b16 v[120:121], v14 offset:16384
    v_mfma_f32_32x32x16_bf16 v[56:71], v[112:115], v[132:135], v[56:71]
    ds_read_b64_tr_b16 v[122:123], v14 offset:16640
    ds_read_b64_tr_b16 v[124:125], v14 offset:20480
    v_mfma_f32_32x32x16_bf16 v[72:87], v[116:119], v[128:131], v[72:87]
    ds_read_b64_tr_b16 v[126:127], v14 offset:20736
    ds_read_b128 v[108:111], v10 offset:20480
    s_add_u32 m0, s50, 0
    s_add_u32 s58, s60, 6
    s_and_b32 s58, s58, 7
    s_lshl_b32 s59, s58, 7
    s_add_u32 s59, s59, s40
    s_mul_i32 s63, s58, 196608
    s_add_u32 s63, s63, s42
    s_add_u32 s48, s59, 0
    buffer_load_dwordx4 v9, s[4:7], s48 offen  lds
    v_mfma_f32_32x32x16_bf16 v[88:103], v[116:119], v[132:135], v[88:103]
    s_add_u32 m0, s50, 4096
    s_add_u32 s48, s59, 32768
    buffer_load_dwordx4 v9, s[4:7], s48 offen  lds
    s_cmp_lg_u32 s52, 0
    s_cbranch_scc1 Lc0_99
    v_mfma_f32_32x32x16_bf16 v[16:31], v[32:35], v[128:131], v[16:31]
    s_branch Lc1_100
Lc0_99:
    v_mfma_f32_32x32x16_bf16 v[16:31], v[32:35], v[132:135], v[16:31]
Lc1_100:
    s_waitcnt lgkmcnt(3)
    v_mfma_f32_32x32x16_bf16 v[40:55], v[104:107], v[120:123], v[40:55]
    ds_read_b128 v[112:115], v11 offset:16384
    ds_read_b64_tr_b16 v[128:129], v14 offset:17408
    s_waitcnt lgkmcnt(3)
    v_mfma_f32_32x32x16_bf16 v[56:71], v[104:107], v[124:127], v[56:71]
    ds_read_b64_tr_b16 v[130:131], v14 offset:17664
    ds_read_b64_tr_b16 v[132:133], v14 offset:21504
    s_waitcnt lgkmcnt(4)
    v_mfma_f32_32x32x16_bf16 v[72:87], v[108:111], v[120:123], v[72:87]
    ds_read_b64_tr_b16 v[134:135], v14 offset:21760
    ds_read_b128 v[116:119], v11 offset:20480
    s_add_u32 m0, s50, 8192
    s_add_u32 s48, s59, 65536
    buffer_load_dwordx4 v9, s[4:7], s48 offen  lds
    v_mfma_f32_32x32x16_bf16 v[88:103], v[108:111], v[124:127], v[88:103]
    s_add_u32 m0, s50, 12288
    s_add_u32 s48, s59, 98304
    buffer_load_dwordx4 v9, s[4:7], s48 offen  lds
    s_cmp_lg_u32 s52, 0
    s_cbranch_scc1 Lc0_101
    v_mfma_f32_32x32x16_bf16 v[16:31], v[32:35], v[120:123], v[16:31]
    s_branch Lc1_102
Lc0_101:
    v_mfma_f32_32x32x16_bf16 v[16:31], v[32:35], v[124:127], v[16:31]
Lc1_102:
    s_waitcnt lgkmcnt(3)
    v_mfma_f32_32x32x16_bf16 v[40:55], v[112:115], v[128:131], v[40:55]
    ds_read_b128 v[104:107], v12 offset:16384
    ds_read_b64_tr_b16 v[120:121], v14 offset:18432
    s_waitcnt lgkmcnt(3)
    v_mfma_f32_32x32x16_bf16 v[56:71], v[112:115], v[132:135], v[56:71]
    ds_read_b64_tr_b16 v[122:123], v14 offset:18688
    ds_read_b64_tr_b16 v[124:125], v14 offset:22528
    s_waitcnt lgkmcnt(4)
    v_mfma_f32_32x32x16_bf16 v[72:87], v[116:119], v[128:131], v[72:87]
    ds_read_b64_tr_b16 v[126:127], v14 offset:22784
    ds_read_b128 v[108:111], v12 offset:20480
    s_add_u32 m0, s51, 0
    s_add_u32 s49, s63, 0
    buffer_load_dwordx4 v7, s[8:11], s49 offen lds
    v_mfma_f32_32x32x16_bf16 v[88:103], v[116:119], v[132:135], v[88:103]
    s_add_u32 m0, s51, 4096
    s_add_u32 s49, s63, 64
    buffer_load_dwordx4 v7, s[8:11], s49 offen lds
    s_cmp_lg_u32 s52, 0
    s_cbranch_scc1 Lc0_103
    v_mfma_f32_32x32x16_bf16 v[16:31], v[32:35], v[128:131], v[16:31]
    s_branch Lc1_104
Lc0_103:
    v_mfma_f32_32x32x16_bf16 v[16:31], v[32:35], v[132:135], v[16:31]
Lc1_104:
    s_waitcnt lgkmcnt(3)
    v_mfma_f32_32x32x16_bf16 v[40:55], v[104:107], v[120:123], v[40:55]
    ds_read_b128 v[112:115], v13 offset:16384
    ds_read_b64_tr_b16 v[128:129], v14 offset:19456
    s_waitcnt lgkmcnt(3)
    v_mfma_f32_32x32x16_bf16 v[56:71], v[104:107], v[124:127], v[56:71]
    ds_read_b64_tr_b16 v[130:131], v14 offset:19712
    ds_read_b64_tr_b16 v[132:133], v14 offset:23552
    s_waitcnt lgkmcnt(4)
    v_mfma_f32_32x32x16_bf16 v[72:87], v[108:111], v[120:123], v[72:87]
    ds_read_b64_tr_b16 v[134:135], v14 offset:23808
    ds_read_b128 v[116:119], v13 offset:20480
    s_add_u32 m0, s51, 8192
    s_add_u32 s49, s63, 128
    buffer_load_dwordx4 v7, s[8:11], s49 offen lds
    v_mfma_f32_32x32x16_bf16 v[88:103], v[108:111], v[124:127], v[88:103]
    s_cmp_lg_u32 s52, 0
    s_cbranch_scc1 Lc0_105
    v_mfma_f32_32x32x16_bf16 v[16:31], v[32:35], v[120:123], v[16:31]
    s_branch Lc1_106
Lc0_105:
    v_mfma_f32_32x32x16_bf16 v[16:31], v[32:35], v[124:127], v[16:31]
Lc1_106:
    s_add_u32 m0, s51, 12288
    s_add_u32 s49, s63, 192
    buffer_load_dwordx4 v7, s[8:11], s49 offen lds
    s_waitcnt vmcnt(8) lgkmcnt(0)
    s_barrier
    v_mfma_f32_32x32x16_bf16 v[40:55], v[112:115], v[128:131], v[40:55]
    ds_read_b128 v[104:107], v10 offset:32768
    ds_read_b64_tr_b16 v[120:121], v14 offset:32768
    v_mfma_f32_32x32x16_bf16 v[56:71], v[112:115], v[132:135], v[56:71]
    ds_read_b64_tr_b16 v[122:123], v14 offset:33024
    ds_read_b64_tr_b16 v[124:125], v14 offset:36864
    v_mfma_f32_32x32x16_bf16 v[72:87], v[116:119], v[128:131], v[72:87]
    ds_read_b64_tr_b16 v[126:127], v14 offset:37120
    ds_read_b128 v[108:111], v10 offset:36864
    s_add_u32 m0, s50, 16384
    s_add_u32 s58, s60, 7
    s_and_b32 s58, s58, 7
    s_lshl_b32 s59, s58, 7
    s_add_u32 s59, s59, s40
    s_mul_i32 s63, s58, 196608
    s_add_u32 s63, s63, s42
    s_add_u32 s48, s59, 0
    buffer_load_dwordx4 v9, s[4:7], s48 offen  lds
    v_mfma_f32_32x32x16_bf16 v[88:103], v[116:119], v[132:135], v[88:103]
    s_add_u32 m0, s50, 20480
    s_add_u32 s48, s59, 32768
    buffer_load_dwordx4 v9, s[4:7], s48 offen  lds
    s_cmp_lg_u32 s52, 0
    s_cbranch_scc1 Lc0_107
    v_mfma_f32_32x32x16_bf16 v[16:31], v[32:35], v[128:131], v[16:31]
    s_branch Lc1_108
Lc0_107:
    v_mfma_f32_32x32x16_bf16 v[16:31], v[32:35], v[132:135], v[16:31]
Lc1_108:
    s_waitcnt lgkmcnt(3)
    v_mfma_f32_32x32x16_bf16 v[40:55], v[104:107], v[120:123], v[40:55]
    ds_read_b128 v[112:115], v11 offset:32768
    ds_read_b64_tr_b16 v[128:129], v14 offset:33792
    s_waitcnt lgkmcnt(3)
    v_mfma_f32_32x32x16_bf16 v[56:71], v[104:107], v[124:127], v[56:71]
    ds_read_b64_tr_b16 v[130:131], v14 offset:34048
    ds_read_b64_tr_b16 v[132:133], v14 offset:37888
    s_waitcnt lgkmcnt(4)
    v_mfma_f32_32x32x16_bf16 v[72:87], v[108:111], v[120:123], v[72:87]
    ds_read_b64_tr_b16 v[134:135], v14 offset:38144
    ds_read_b128 v[116:119], v11 offset:36864
    s_add_u32 m0, s50, 24576
    s_add_u32 s48, s59, 65536
    buffer_load_dwordx4 v9, s[4:7], s48 offen  lds
    v_mfma_f32_32x32x16_bf16 v[88:103], v[108:111], v[124:127], v[88:103]
    s_add_u32 m0, s50, 28672
    s_add_u32 s48, s59, 98304
    buffer_load_dwordx4 v9, s[4:7], s48 offen  lds
    s_cmp_lg_u32 s52, 0
    s_cbranch_scc1 Lc0_109
    v_mfma_f32_32x32x16_bf16 v[16:31], v[32:35], v[120:123], v[16:31]
    s_branch Lc1_110
Lc0_109:
    v_mfma_f32_32x32x16_bf16 v[16:31], v[32:35], v[124:127], v[16:31]
Lc1_110:
    s_waitcnt lgkmcnt(3)
    v_mfma_f32_32x32x16_bf16 v[40:55], v[112:115], v[128:131], v[40:55]
    ds_read_b128 v[104:107], v12 offset:32768
    ds_read_b64_tr_b16 v[120:121], v14 offset:34816
    s_waitcnt lgkmcnt(3)
    v_mfma_f32_32x32x16_bf16 v[56:71], v[112:115], v[132:135], v[56:71]
    ds_read_b64_tr_b16 v[122:123], v14 offset:35072
    ds_read_b64_tr_b16 v[124:125], v14 offset:38912
    s_waitcnt lgkmcnt(4)
    v_mfma_f32_32x32x16_bf16 v[72:87], v[116:119], v[128:131], v[72:87]
    ds_read_b64_tr_b16 v[126:127], v14 offset:39168
    ds_read_b128 v[108:111], v12 offset:36864
    s_add_u32 m0, s51, 16384
    s_add_u32 s49, s63, 0
    buffer_load_dwordx4 v7, s[8:11], s49 offen lds
    v_mfma_f32_32x32x16_bf16 v[88:103], v[116:119], v[132:135], v[88:103]
    s_add_u32 m0, s51, 20480
    s_add_u32 s49, s63, 64
    buffer_load_dwordx4 v7, s[8:11], s49 offen lds
    s_cmp_lg_u32 s52, 0
    s_cbranch_scc1 Lc0_111
    v_mfma_f32_32x32x16_bf16 v[16:31], v[32:35], v[128:131], v[16:31]
    s_branch Lc1_112
Lc0_111:
    v_mfma_f32_32x32x16_bf16 v[16:31], v[32:35], v[132:135], v[16:31]
Lc1_112:
    s_waitcnt lgkmcnt(3)
    v_mfma_f32_32x32x16_bf16 v[40:55], v[104:107], v[120:123], v[40:55]
    ds_read_b128 v[112:115], v13 offset:32768
    ds_read_b64_tr_b16 v[128:129], v14 offset:35840
    s_waitcnt lgkmcnt(3)
    v_mfma_f32_32x32x16_bf16 v[56:71], v[104:107], v[124:127], v[56:71]
    ds_read_b64_tr_b16 v[130:131], v14 offset:36096
    ds_read_b64_tr_b16 v[132:133], v14 offset:39936
    s_waitcnt lgkmcnt(4)
    v_mfma_f32_32x32x16_bf16 v[72:87], v[108:111], v[120:123], v[72:87]
    ds_read_b64_tr_b16 v[134:135], v14 offset:40192
    ds_read_b128 v[116:119], v13 offset:36864
    s_add_u32 m0, s51, 24576
    s_add_u32 s49, s63, 128
    buffer_load_dwordx4 v7, s[8:11], s49 offen lds
    v_mfma_f32_32x32x16_bf16 v[88:103], v[108:111], v[124:127], v[88:103]
    s_cmp_lg_u32 s52, 0
    s_cbranch_scc1 Lc0_113
    v_mfma_f32_32x32x16_bf16 v[16:31], v[32:35], v[120:123], v[16:31]
    s_branch Lc1_114
Lc0_113:
    v_mfma_f32_32x32x16_bf16 v[16:31], v[32:35], v[124:127], v[16:31]
Lc1_114:
    s_add_u32 m0, s51, 28672
    s_add_u32 s49, s63, 192
    buffer_load_dwordx4 v7, s[8:11], s49 offen lds
    s_waitcnt vmcnt(8) lgkmcnt(0)
    s_barrier
    v_mfma_f32_32x32x16_bf16 v[40:55], v[112:115], v[128:131], v[40:55]
    ds_read_b128 v[104:107], v10 offset:0
    ds_read_b64_tr_b16 v[120:121], v14 offset:0
    v_mfma_f32_32x32x16_bf16 v[56:71], v[112:115], v[132:135], v[56:71]
    ds_read_b64_tr_b16 v[122:123], v14 offset:256
    ds_read_b64_tr_b16 v[124:125], v14 offset:4096
    v_mfma_f32_32x32x16_bf16 v[72:87], v[116:119], v[128:131], v[72:87]
    ds_read_b64_tr_b16 v[126:127], v14 offset:4352
    ds_read_b128 v[108:111], v10 offset:4096
    v_mfma_f32_32x32x16_bf16 v[88:103], v[116:119], v[132:135], v[88:103]
    s_cmp_lg_u32 s52, 0
    s_cbranch_scc1 Lc0_115
    v_mfma_f32_32x32x16_bf16 v[16:31], v[32:35], v[128:131], v[16:31]
    s_branch Lc1_116
Lc0_115:
    v_mfma_f32_32x32x16_bf16 v[16:31], v[32:35], v[132:135], v[16:31]
Lc1_116:
    s_waitcnt lgkmcnt(3)
    v_mfma_f32_32x32x16_bf16 v[40:55], v[104:107], v[120:123], v[40:55]
    ds_read_b128 v[112:115], v11 offset:0
    ds_read_b64_tr_b16 v[128:129], v14 offset:1024
    s_waitcnt lgkmcnt(3)
    v_mfma_f32_32x32x16_bf16 v[56:71], v[104:107], v[124:127], v[56:71]
    ds_read_b64_tr_b16 v[130:131], v14 offset:1280
    ds_read_b64_tr_b16 v[132:133], v14 offset:5120
    s_waitcnt lgkmcnt(4)
    v_mfma_f32_32x32x16_bf16 v[72:87], v[108:111], v[120:123], v[72:87]
    ds_read_b64_tr_b16 v[134:135], v14 offset:5376
    ds_read_b128 v[116:119], v11 offset:4096
    v_mfma_f32_32x32x16_bf16 v[88:103], v[108:111], v[124:127], v[88:103]
    s_cmp_lg_u32 s52, 0
    s_cbranch_scc1 Lc0_117
    v_mfma_f32_32x32x16_bf16 v[16:31], v[32:35], v[120:123], v[16:31]
    s_branch Lc1_118
Lc0_117:
    v_mfma_f32_32x32x16_bf16 v[16:31], v[32:35], v[124:127], v[16:31]
Lc1_118:
    s_waitcnt lgkmcnt(3)
    v_mfma_f32_32x32x16_bf16 v[40:55], v[112:115], v[128:131], v[40:55]
    ds_read_b128 v[104:107], v12 offset:0
    ds_read_b64_tr_b16 v[120:121], v14 offset:2048
    s_waitcnt lgkmcnt(3)
    v_mfma_f32_32x32x16_bf16 v[56:71], v[112:115], v[132:135], v[56:71]
    ds_read_b64_tr_b16 v[122:123], v14 offset:2304
    ds_read_b64_tr_b16 v[124:125], v14 offset:6144
    s_waitcnt lgkmcnt(4)
    v_mfma_f32_32x32x16_bf16 v[72:87], v[116:119], v[128:131], v[72:87]
    ds_read_b64_tr_b16 v[126:127], v14 offset:6400
    ds_read_b128 v[108:111], v12 offset:4096
    v_mfma_f32_32x32x16_bf16 v[88:103], v[116:119], v[132:135], v[88:103]
    s_cmp_lg_u32 s52, 0
    s_cbranch_scc1 Lc0_119
    v_mfma_f32_32x32x16_bf16 v[16:31], v[32:35], v[128:131], v[16:31]
    s_branch Lc1_120
Lc0_119:
    v_mfma_f32_32x32x16_bf16 v[16:31], v[32:35], v[132:135], v[16:31]
Lc1_120:
    s_waitcnt lgkmcnt(3)
    v_mfma_f32_32x32x16_bf16 v[40:55], v[104:107], v[120:123], v[40:55]
    ds_read_b128 v[112:115], v13 offset:0
    ds_read_b64_tr_b16 v[128:129], v14 offset:3072
    s_waitcnt lgkmcnt(3)
    v_mfma_f32_32x32x16_bf16 v[56:71], v[104:107], v[124:127], v[56:71]
    ds_read_b64_tr_b16 v[130:131], v14 offset:3328
    ds_read_b64_tr_b16 v[132:133], v14 offset:7168
    s_waitcnt lgkmcnt(4)
    v_mfma_f32_32x32x16_bf16 v[72:87], v[108:111], v[120:123], v[72:87]
    ds_read_b64_tr_b16 v[134:135], v14 offset:7424
    ds_read_b128 v[116:119], v13 offset:4096
    v_mfma_f32_32x32x16_bf16 v[88:103], v[108:111], v[124:127], v[88:103]
    s_cmp_lg_u32 s52, 0
    s_cbranch_scc1 Lc0_121
    v_mfma_f32_32x32x16_bf16 v[16:31], v[32:35], v[120:123], v[16:31]
    s_branch Lc1_122
Lc0_121:
    v_mfma_f32_32x32x16_bf16 v[16:31], v[32:35], v[124:127], v[16:31]
Lc1_122:
    s_waitcnt vmcnt(0) lgkmcnt(0)
    s_barrier
    v_and_b32 v38, 127, v0
    v_lshlrev_b32 v38, 2, v38
    s_lshl_b32 s43, s37, 9
    s_add_u32 s43, s43, 0x1600000
    buffer_load_dword v36, v38, s[12:15], s43 offen sc1
    s_add_u32 s43, s43, 0x2000
    buffer_load_dword v37, v38, s[12:15], s43 offen sc1
    v_mfma_f32_32x32x16_bf16 v[40:55], v[112:115], v[128:131], v[40:55]
    ds_read_b128 v[104:107], v10 offset:16384
    ds_read_b64_tr_b16 v[120:121], v14 offset:16384
    v_mfma_f32_32x32x16_bf16 v[56:71], v[112:115], v[132:135], v[56:71]
    ds_read_b64_tr_b16 v[122:123], v14 offset:16640
    ds_read_b64_tr_b16 v[124:125], v14 offset:20480
    v_mfma_f32_32x32x16_bf16 v[72:87], v[116:119], v[128:131], v[72:87]
    ds_read_b64_tr_b16 v[126:127], v14 offset:20736
    ds_read_b128 v[108:111], v10 offset:20480
    v_mfma_f32_32x32x16_bf16 v[88:103], v[116:119], v[132:135], v[88:103]
    s_cmp_lg_u32 s52, 0
    s_cbranch_scc1 Lc0_123
    v_mfma_f32_32x32x16_bf16 v[16:31], v[32:35], v[128:131], v[16:31]
    s_branch Lc1_124
Lc0_123:
    v_mfma_f32_32x32x16_bf16 v[16:31], v[32:35], v[132:135], v[16:31]
Lc1_124:
    s_waitcnt lgkmcnt(3)
    v_mfma_f32_32x32x16_bf16 v[40:55], v[104:107], v[120:123], v[40:55]
    ds_read_b128 v[112:115], v11 offset:16384
    ds_read_b64_tr_b16 v[128:129], v14 offset:17408
    s_waitcnt lgkmcnt(3)
    v_mfma_f32_32x32x16_bf16 v[56:71], v[104:107], v[124:127], v[56:71]
    ds_read_b64_tr_b16 v[130:131], v14 offset:17664
    ds_read_b64_tr_b16 v[132:133], v14 offset:21504
    s_waitcnt lgkmcnt(4)
    v_mfma_f32_32x32x16_bf16 v[72:87], v[108:111], v[120:123], v[72:87]
    ds_read_b64_tr_b16 v[134:135], v14 offset:21760
    ds_read_b128 v[116:119], v11 offset:20480
    v_mfma_f32_32x32x16_bf16 v[88:103], v[108:111], v[124:127], v[88:103]
    s_cmp_lg_u32 s52, 0
    s_cbranch_scc1 Lc0_125
    v_mfma_f32_32x32x16_bf16 v[16:31], v[32:35], v[120:123], v[16:31]
    s_branch Lc1_126
Lc0_125:
    v_mfma_f32_32x32x16_bf16 v[16:31], v[32:35], v[124:127], v[16:31]
Lc1_126:
    s_waitcnt lgkmcnt(3)
    v_mfma_f32_32x32x16_bf16 v[40:55], v[112:115], v[128:131], v[40:55]
    ds_read_b128 v[104:107], v12 offset:16384
    ds_read_b64_tr_b16 v[120:121], v14 offset:18432
    s_waitcnt lgkmcnt(3)
    v_mfma_f32_32x32x16_bf16 v[56:71], v[112:115], v[132:135], v[56:71]
    ds_read_b64_tr_b16 v[122:123], v14 offset:18688
    ds_read_b64_tr_b16 v[124:125], v14 offset:22528
    s_waitcnt lgkmcnt(4)
    v_mfma_f32_32x32x16_bf16 v[72:87], v[116:119], v[128:131], v[72:87]
    ds_read_b64_tr_b16 v[126:127], v14 offset:22784
    ds_read_b128 v[108:111], v12 offset:20480
    v_mfma_f32_32x32x16_bf16 v[88:103], v[116:119], v[132:135], v[88:103]
    s_cmp_lg_u32 s52, 0
    s_cbranch_scc1 Lc0_127
    v_mfma_f32_32x32x16_bf16 v[16:31], v[32:35], v[128:131], v[16:31]
    s_branch Lc1_128
Lc0_127:
    v_mfma_f32_32x32x16_bf16 v[16:31], v[32:35], v[132:135], v[16:31]
Lc1_128:
    s_waitcnt lgkmcnt(3)
    v_mfma_f32_32x32x16_bf16 v[40:55], v[104:107], v[120:123], v[40:55]
    ds_read_b128 v[112:115], v13 offset:16384
    ds_read_b64_tr_b16 v[128:129], v14 offset:19456
    s_waitcnt lgkmcnt(3)
    v_mfma_f32_32x32x16_bf16 v[56:71], v[104:107], v[124:127], v[56:71]
    ds_read_b64_tr_b16 v[130:131], v14 offset:19712
    ds_read_b64_tr_b16 v[132:133], v14 offset:23552
    s_waitcnt lgkmcnt(4)
    v_mfma_f32_32x32x16_bf16 v[72:87], v[108:111], v[120:123], v[72:87]
    ds_read_b64_tr_b16 v[134:135], v14 offset:23808
    ds_read_b128 v[116:119], v13 offset:20480
    v_mfma_f32_32x32x16_bf16 v[88:103], v[108:111], v[124:127], v[88:103]
    s_cmp_lg_u32 s52, 0
    s_cbranch_scc1 Lc0_129
    v_mfma_f32_32x32x16_bf16 v[16:31], v[32:35], v[120:123], v[16:31]
    s_branch Lc1_130
Lc0_129:
    v_mfma_f32_32x32x16_bf16 v[16:31], v[32:35], v[124:127], v[16:31]
Lc1_130:
    s_waitcnt lgkmcnt(3)
    v_mfma_f32_32x32x16_bf16 v[40:55], v[112:115], v[128:131], v[40:55]
    s_waitcnt lgkmcnt(1)
    v_mfma_f32_32x32x16_bf16 v[56:71], v[112:115], v[132:135], v[56:71]
    s_waitcnt lgkmcnt(0)
    v_mfma_f32_32x32x16_bf16 v[72:87], v[116:119], v[128:131], v[72:87]
    v_mfma_f32_32x32x16_bf16 v[88:103], v[116:119], v[132:135], v[88:103]
    s_cmp_lg_u32 s52, 0
    s_cbranch_scc1 Lc0_131
    v_mfma_f32_32x32x16_bf16 v[16:31], v[32:35], v[128:131], v[16:31]
    s_branch Lc1_132
Lc0_131:
    v_mfma_f32_32x32x16_bf16 v[16:31], v[32:35], v[132:135], v[16:31]
Lc1_132:
    s_waitcnt lgkmcnt(0)
    v_and_b32 v4, 31, v1
    v_lshlrev_b32 v4, 2, v4
    s_lshl_b32 s43, s53, 8
    s_lshl_b32 s44, s52, 7
    s_add_u32 s43, s43, s44
    s_add_u32 s43, s43, 147456
    v_add_u32 v5, s43, v4
    v_add_u32 v38, 147456, v38
    s_waitcnt vmcnt(0)
    s_nop 3
    ds_write_b32 v5, v16 offset:9216
    s_cmp_ge_u32 s36, 2
    s_cbranch_scc1 Ltk_133
    ds_write_b32 v38, v36 offset:8192
    ds_write_b32 v38, v37 offset:8704
Ltk_133:
    s_waitcnt lgkmcnt(0)
    s_barrier
    v_and_b32 v4, 31, v1
    v_lshlrev_b32 v4, 2, v4
    v_lshrrev_b32 v5, 5, v1
    v_lshlrev_b32 v5, 4, v5
    v_add_u32 v4, 147456, v4
    v_add_u32 v5, 147456, v5
    s_lshl_b32 s43, s37, 2
    s_lshl_b32 s44, s52, 1
    s_add_u32 s43, s43, s44
    s_lshl_b32 s43, s43, 5
    s_and_b32 s44, s38, 3
    s_lshl_b32 s44, s44, 3
    s_add_u32 s43, s43, s44
    s_lshl_b32 s44, s53, 2
    s_add_u32 s43, s43, s44
    s_lshl_b32 s43, s43, 10
    s_lshr_b32 s44, s38, 2
    s_lshl_b32 s44, s44, 21
    s_add_u32 s43, s43, s44
    v_and_b32 v156, 15, v1
    v_lshlrev_b32 v156, 4, v156
    v_lshrrev_b32 v6, 5, v1
    v_lshl_add_u32 v156, v6, 8, v156
    v_bfe_u32 v6, v1, 4, 1
    v_lshl_add_u32 v156, v6, 10, v156
    s_lshl_b32 s44, s53, 8
    v_add_u32 v4, s44, v4
    s_lshl_b32 s44, s52, 8
    v_add_u32 v5, s44, v5
    ds_read_b32 v136, v4 offset:9216
    ds_read_b32 v137, v4 offset:9344
    ds_read_b128 v[104:107], v5 offset:8192
    ds_read_b128 v[120:123], v5 offset:8704
    ds_read_b128 v[108:111], v5 offset:8224
    ds_read_b128 v[124:127], v5 offset:8736
    ds_read_b128 v[112:115], v5 offset:8256
    ds_read_b128 v[128:131], v5 offset:8768
    ds_read_b128 v[116:119], v5 offset:8288
    ds_read_b128 v[132:135], v5 offset:8800
    s_waitcnt lgkmcnt(0)
    v_pk_mul_f32 v[40:41], v[40:41], v[120:121]
    v_pk_mul_f32 v[42:43], v[42:43], v[122:123]
    v_pk_mul_f32 v[44:45], v[44:45], v[124:125]
    v_pk_mul_f32 v[46:47], v[46:47], v[126:127]
    v_pk_mul_f32 v[48:49], v[48:49], v[128:129]
    v_pk_mul_f32 v[50:51], v[50:51], v[130:131]
    v_pk_mul_f32 v[52:53], v[52:53], v[132:133]
    v_pk_mul_f32 v[54:55], v[54:55], v[134:135]
    v_pk_fma_f32 v[40:41], v[104:105], v[136:137], v[40:41] op_sel:[0,0,0] op_sel_hi:[1,0,1]
    v_pk_fma_f32 v[42:43], v[106:107], v[136:137], v[42:43] op_sel:[0,0,0] op_sel_hi:[1,0,1]
    v_pk_fma_f32 v[44:45], v[108:109], v[136:137], v[44:45] op_sel:[0,0,0] op_sel_hi:[1,0,1]
    v_pk_fma_f32 v[46:47], v[110:111], v[136:137], v[46:47] op_sel:[0,0,0] op_sel_hi:[1,0,1]
    v_pk_fma_f32 v[48:49], v[112:113], v[136:137], v[48:49] op_sel:[0,0,0] op_sel_hi:[1,0,1]
    v_pk_fma_f32 v[50:51], v[114:115], v[136:137], v[50:51] op_sel:[0,0,0] op_sel_hi:[1,0,1]
    v_pk_fma_f32 v[52:53], v[116:117], v[136:137], v[52:53] op_sel:[0,0,0] op_sel_hi:[1,0,1]
    v_pk_fma_f32 v[54:55], v[118:119], v[136:137], v[54:55] op_sel:[0,0,0] op_sel_hi:[1,0,1]
    v_cvt_pk_bf16_f32 v140, v40, v41
    v_cvt_pk_bf16_f32 v141, v42, v43
    v_cvt_pk_bf16_f32 v142, v44, v45
    v_cvt_pk_bf16_f32 v143, v46, v47
    v_cvt_pk_bf16_f32 v144, v48, v49
    v_cvt_pk_bf16_f32 v145, v50, v51
    v_cvt_pk_bf16_f32 v146, v52, v53
    v_cvt_pk_bf16_f32 v147, v54, v55
    s_add_u32 s44, s43, 0
    buffer_store_dwordx4 v[140:143], v156, s[12:15], s44 offen offset:0 sc1
    buffer_store_dwordx4 v[144:147], v156, s[12:15], s44 offen offset:512 sc1
    v_pk_mul_f32 v[56:57], v[56:57], v[120:121]
    v_pk_mul_f32 v[58:59], v[58:59], v[122:123]
    v_pk_mul_f32 v[60:61], v[60:61], v[124:125]
    v_pk_mul_f32 v[62:63], v[62:63], v[126:127]
    v_pk_mul_f32 v[64:65], v[64:65], v[128:129]
    v_pk_mul_f32 v[66:67], v[66:67], v[130:131]
    v_pk_mul_f32 v[68:69], v[68:69], v[132:133]
    v_pk_mul_f32 v[70:71], v[70:71], v[134:135]
    v_pk_fma_f32 v[56:57], v[104:105], v[136:137], v[56:57] op_sel:[0,1,0] op_sel_hi:[1,1,1]
    v_pk_fma_f32 v[58:59], v[106:107], v[136:137], v[58:59] op_sel:[0,1,0] op_sel_hi:[1,1,1]
    v_pk_fma_f32 v[60:61], v[108:109], v[136:137], v[60:61] op_sel:[0,1,0] op_sel_hi:[1,1,1]
    v_pk_fma_f32 v[62:63], v[110:111], v[136:137], v[62:63] op_sel:[0,1,0] op_sel_hi:[1,1,1]
    v_pk_fma_f32 v[64:65], v[112:113], v[136:137], v[64:65] op_sel:[0,1,0] op_sel_hi:[1,1,1]
    v_pk_fma_f32 v[66:67], v[114:115], v[136:137], v[66:67] op_sel:[0,1,0] op_sel_hi:[1,1,1]
    v_pk_fma_f32 v[68:69], v[116:117], v[136:137], v[68:69] op_sel:[0,1,0] op_sel_hi:[1,1,1]
    v_pk_fma_f32 v[70:71], v[118:119], v[136:137], v[70:71] op_sel:[0,1,0] op_sel_hi:[1,1,1]
    v_cvt_pk_bf16_f32 v148, v56, v57
    v_cvt_pk_bf16_f32 v149, v58, v59
    v_cvt_pk_bf16_f32 v150, v60, v61
    v_cvt_pk_bf16_f32 v151, v62, v63
    v_cvt_pk_bf16_f32 v152, v64, v65
    v_cvt_pk_bf16_f32 v153, v66, v67
    v_cvt_pk_bf16_f32 v154, v68, v69
    v_cvt_pk_bf16_f32 v155, v70, v71
    s_add_u32 s44, s43, 2048
    buffer_store_dwordx4 v[148:151], v156, s[12:15], s44 offen offset:0 sc1
    buffer_store_dwordx4 v[152:155], v156, s[12:15], s44 offen offset:512 sc1
    ds_read_b128 v[104:107], v5 offset:8320
    ds_read_b128 v[120:123], v5 offset:8832
    ds_read_b128 v[108:111], v5 offset:8352
    ds_read_b128 v[124:127], v5 offset:8864
    ds_read_b128 v[112:115], v5 offset:8384
    ds_read_b128 v[128:131], v5 offset:8896
    ds_read_b128 v[116:119], v5 offset:8416
    ds_read_b128 v[132:135], v5 offset:8928
    s_waitcnt lgkmcnt(0)
    v_pk_mul_f32 v[72:73], v[72:73], v[120:121]
    v_pk_mul_f32 v[74:75], v[74:75], v[122:123]
    v_pk_mul_f32 v[76:77], v[76:77], v[124:125]
    v_pk_mul_f32 v[78:79], v[78:79], v[126:127]
    v_pk_mul_f32 v[80:81], v[80:81], v[128:129]
    v_pk_mul_f32 v[82:83], v[82:83], v[130:131]
    v_pk_mul_f32 v[84:85], v[84:85], v[132:133]
    v_pk_mul_f32 v[86:87], v[86:87], v[134:135]
    v_pk_fma_f32 v[72:73], v[104:105], v[136:137], v[72:73] op_sel:[0,0,0] op_sel_hi:[1,0,1]
    v_pk_fma_f32 v[74:75], v[106:107], v[136:137], v[74:75] op_sel:[0,0,0] op_sel_hi:[1,0,1]
    v_pk_fma_f32 v[76:77], v[108:109], v[136:137], v[76:77] op_sel:[0,0,0] op_sel_hi:[1,0,1]
    v_pk_fma_f32 v[78:79], v[110:111], v[136:137], v[78:79] op_sel:[0,0,0] op_sel_hi:[1,0,1]
    v_pk_fma_f32 v[80:81], v[112:113], v[136:137], v[80:81] op_sel:[0,0,0] op_sel_hi:[1,0,1]
    v_pk_fma_f32 v[82:83], v[114:115], v[136:137], v[82:83] op_sel:[0,0,0] op_sel_hi:[1,0,1]
    v_pk_fma_f32 v[84:85], v[116:117], v[136:137], v[84:85] op_sel:[0,0,0] op_sel_hi:[1,0,1]
    v_pk_fma_f32 v[86:87], v[118:119], v[136:137], v[86:87] op_sel:[0,0,0] op_sel_hi:[1,0,1]
    v_cvt_pk_bf16_f32 v140, v72, v73
    v_cvt_pk_bf16_f32 v141, v74, v75
    v_cvt_pk_bf16_f32 v142, v76, v77
    v_cvt_pk_bf16_f32 v143, v78, v79
    v_cvt_pk_bf16_f32 v144, v80, v81
    v_cvt_pk_bf16_f32 v145, v82, v83
    v_cvt_pk_bf16_f32 v146, v84, v85
    v_cvt_pk_bf16_f32 v147, v86, v87
    s_add_u32 s44, s43, 32768
    buffer_store_dwordx4 v[140:143], v156, s[12:15], s44 offen offset:0 sc1
    buffer_store_dwordx4 v[144:147], v156, s[12:15], s44 offen offset:512 sc1
    v_pk_mul_f32 v[88:89], v[88:89], v[120:121]
    v_pk_mul_f32 v[90:91], v[90:91], v[122:123]
    v_pk_mul_f32 v[92:93], v[92:93], v[124:125]
    v_pk_mul_f32 v[94:95], v[94:95], v[126:127]
    v_pk_mul_f32 v[96:97], v[96:97], v[128:129]
    v_pk_mul_f32 v[98:99], v[98:99], v[130:131]
    v_pk_mul_f32 v[100:101], v[100:101], v[132:133]
    v_pk_mul_f32 v[102:103], v[102:103], v[134:135]
    v_pk_fma_f32 v[88:89], v[104:105], v[136:137], v[88:89] op_sel:[0,1,0] op_sel_hi:[1,1,1]
    v_pk_fma_f32 v[90:91], v[106:107], v[136:137], v[90:91] op_sel:[0,1,0] op_sel_hi:[1,1,1]
    v_pk_fma_f32 v[92:93], v[108:109], v[136:137], v[92:93] op_sel:[0,1,0] op_sel_hi:[1,1,1]
    v_pk_fma_f32 v[94:95], v[110:111], v[136:137], v[94:95] op_sel:[0,1,0] op_sel_hi:[1,1,1]
    v_pk_fma_f32 v[96:97], v[112:113], v[136:137], v[96:97] op_sel:[0,1,0] op_sel_hi:[1,1,1]
    v_pk_fma_f32 v[98:99], v[114:115], v[136:137], v[98:99] op_sel:[0,1,0] op_sel_hi:[1,1,1]
    v_pk_fma_f32 v[100:101], v[116:117], v[136:137], v[100:101] op_sel:[0,1,0] op_sel_hi:[1,1,1]
    v_pk_fma_f32 v[102:103], v[118:119], v[136:137], v[102:103] op_sel:[0,1,0] op_sel_hi:[1,1,1]
    v_cvt_pk_bf16_f32 v148, v88, v89
    v_cvt_pk_bf16_f32 v149, v90, v91
    v_cvt_pk_bf16_f32 v150, v92, v93
    v_cvt_pk_bf16_f32 v151, v94, v95
    v_cvt_pk_bf16_f32 v152, v96, v97
    v_cvt_pk_bf16_f32 v153, v98, v99
    v_cvt_pk_bf16_f32 v154, v100, v101
    v_cvt_pk_bf16_f32 v155, v102, v103
    s_add_u32 s44, s43, 34816
    buffer_store_dwordx4 v[148:151], v156, s[12:15], s44 offen offset:0 sc1
    buffer_store_dwordx4 v[152:155], v156, s[12:15], s44 offen offset:512 sc1
    s_waitcnt vmcnt(0)
    s_barrier
    s_cmp_lg_u32 s36, 0
    s_cbranch_scc1 Lsig_134
    s_and_b32 s43, s38, 3
    s_lshl_b32 s43, s43, 3
    v_lshrrev_b32 v2, 3, v1
    v_add_u32 v2, s43, v2
    v_and_b32 v3, 3, v2
    v_lshrrev_b32 v2, 2, v2
    v_lshl_add_u32 v2, v3, 3, v2
    v_and_b32 v3, 7, v1
    v_lshl_add_u32 v2, v3, 5, v2
    v_lshlrev_b32 v2, 7, v2
    s_lshl_b32 s43, 1, s37
    v_mov_b32 v3, s43
    s_and_b32 s43, s38, 12
    s_add_u32 s43, s43, 0x1680014
    s_mov_b32 exec_lo, 0xffffffff
    s_mov_b32 exec_hi, 0xffffffff
    buffer_atomic_or v3, v2, s[12:15], s43 offen sc1
    s_mov_b64 exec, -1
Lsig_134:
    s_branch g1_done
g1_w1:
    s_mov_b32 s8, s30
    s_and_b32 s9, s31, 0xffff
    s_mov_b32 s10, 0x80000
    s_mov_b32 s11, 0x20000
    s_sub_u32 s39, s38, 12
    s_lshl_b32 s39, s39, 8
    s_mul_i32 s42, s36, 16384
    s_add_u32 s42, s42, s39
    s_lshr_b32 s52, s36, 1
    s_and_b32 s53, s36, 1
    s_and_b32 s54, s36, 3
    s_lshr_b32 s55, s36, 2
    s_lshl_b32 s50, s54, 10
    s_add_u32 s51, s50, 49152
    v_lshrrev_b32 v4, 2, v1
    s_mov_b32 s48, 1024
    v_mul_lo_u32 v7, v4, s48
    v_and_b32 v4, 3, v1
    v_lshl_add_u32 v7, v4, 4, v7
    v_lshlrev_b32 v8, 4, v1
    s_and_b32 s48, s36, 1
    s_lshl_b32 s48, s48, 2
    v_lshrrev_b32 v4, 4, v1
    v_add_u32 v4, s48, v4
    v_and_b32 v5, 7, v1
    v_xor_b32 v4, v4, v5
    v_lshrrev_b32 v5, 3, v1
    v_lshlrev_b32 v5, 10, v5
    v_lshl_add_u32 v9, v4, 4, v5
    v_and_b32 v4, 31, v1
    v_lshrrev_b32 v5, 1, v4
    v_and_b32 v5, 7, v5
    v_lshrrev_b32 v6, 5, v1
    v_xor_b32 v5, v5, v6
    v_lshlrev_b32 v4, 7, v4
    s_mul_i32 s48, s52, 8192
    v_add_u32 v4, s48, v4
    v_xor_b32 v6, 0, v5
    v_lshl_add_u32 v10, v6, 4, v4
    v_xor_b32 v6, 2, v5
    v_lshl_add_u32 v11, v6, 4, v4
    v_xor_b32 v6, 4, v5
    v_lshl_add_u32 v12, v6, 4, v4
    v_xor_b32 v6, 6, v5
    v_lshl_add_u32 v13, v6, 4, v4
    v_lshrrev_b32 v4, 5, v1
    v_lshlrev_b32 v4, 9, v4
    v_bfe_u32 v5, v1, 2, 2
    v_lshl_add_u32 v4, v5, 6, v4
    v_bfe_u32 v5, v1, 4, 1
    v_lshl_add_u32 v4, v5, 5, v4
    v_and_b32 v5, 3, v1
    v_lshl_add_u32 v4, v5, 3, v4
    s_mul_i32 s48, s53, 8192
    s_add_u32 s48, s48, 49152
    v_add_u32 v14, s48, v4
    v_mov_b32 v32, 0x3f803f80
    v_mov_b32 v33, 0x3f803f80
    v_mov_b32 v34, 0x3f803f80
    v_mov_b32 v35, 0x3f803f80
    s_add_u32 m0, s50, 0
    s_add_u32 s58, s60, 0
    s_and_b32 s58, s58, 7
    s_lshl_b32 s59, s58, 7
    s_add_u32 s59, s59, s40
    s_mul_i32 s63, s58, 65536
    s_add_u32 s63, s63, s42
    s_add_u32 s48, s59, 0
    buffer_load_dwordx4 v9, s[4:7], s48 offen  lds
    s_add_u32 m0, s50, 4096
    s_add_u32 s48, s59, 32768
    buffer_load_dwordx4 v9, s[4:7], s48 offen  lds
    s_add_u32 m0, s50, 8192
    s_add_u32 s48, s59, 65536
    buffer_load_dwordx4 v9, s[4:7], s48 offen  lds
    s_add_u32 m0, s50, 12288
    s_add_u32 s48, s59, 98304
    buffer_load_dwordx4 v9, s[4:7], s48 offen  lds
    s_add_u32 m0, s51, 0
    s_add_u32 s49, s63, 0
    buffer_load_dwordx4 v7, s[8:11], s49 offen lds
    s_add_u32 m0, s51, 4096
    s_add_u32 s49, s63, 64
    buffer_load_dwordx4 v7, s[8:11], s49 offen lds
    s_add_u32 m0, s51, 8192
    s_add_u32 s49, s63, 128
    buffer_load_dwordx4 v7, s[8:11], s49 offen lds
    s_add_u32 m0, s51, 12288
    s_add_u32 s49, s63, 192
    buffer_load_dwordx4 v7, s[8:11], s49 offen lds
    s_add_u32 m0, s50, 16384
    s_add_u32 s58, s60, 1
    s_and_b32 s58, s58, 7
    s_lshl_b32 s59, s58, 7
    s_add_u32 s59, s59, s40
    s_mul_i32 s63, s58, 65536
    s_add_u32 s63, s63, s42
    s_add_u32 s48, s59, 0
    buffer_load_dwordx4 v9, s[4:7], s48 offen  lds
    s_add_u32 m0, s50, 20480
    s_add_u32 s48, s59, 32768
    buffer_load_dwordx4 v9, s[4:7], s48 offen  lds
    s_add_u32 m0, s50, 24576
    s_add_u32 s48, s59, 65536
    buffer_load_dwordx4 v9, s[4:7], s48 offen  lds
    s_add_u32 m0, s50, 28672
    s_add_u32 s48, s59, 98304
    buffer_load_dwordx4 v9, s[4:7], s48 offen  lds
    s_add_u32 m0, s51, 16384
    s_add_u32 s49, s63, 0
    buffer_load_dwordx4 v7, s[8:11], s49 offen lds
    s_add_u32 m0, s51, 20480
    s_add_u32 s49, s63, 64
    buffer_load_dwordx4 v7, s[8:11], s49 offen lds
    s_add_u32 m0, s51, 24576
    s_add_u32 s49, s63, 128
    buffer_load_dwordx4 v7, s[8:11], s49 offen lds
    s_add_u32 m0, s51, 28672
    s_add_u32 s49, s63, 192
    buffer_load_dwordx4 v7, s[8:11], s49 offen lds
    v_mov_b32 v40, 0
    v_mov_b32 v41, 0
    v_mov_b32 v42, 0
    v_mov_b32 v43, 0
    v_mov_b32 v44, 0
    v_mov_b32 v45, 0
    v_mov_b32 v46, 0
    v_mov_b32 v47, 0
    v_mov_b32 v48, 0
    v_mov_b32 v49, 0
    v_mov_b32 v50, 0
    v_mov_b32 v51, 0
    v_mov_b32 v52, 0
    v_mov_b32 v53, 0
    v_mov_b32 v54, 0
    v_mov_b32 v55, 0
    v_mov_b32 v56, 0
    v_mov_b32 v57, 0
    v_mov_b32 v58, 0
    v_mov_b32 v59, 0
    v_mov_b32 v60, 0
    v_mov_b32 v61, 0
    v_mov_b32 v62, 0
    v_mov_b32 v63, 0
    v_mov_b32 v64, 0
    v_mov_b32 v65, 0
    v_mov_b32 v66, 0
    v_mov_b32 v67, 0
    v_mov_b32 v68, 0
    v_mov_b32 v69, 0
    v_mov_b32 v70, 0
    v_mov_b32 v71, 0
    v_mov_b32 v72, 0
    v_mov_b32 v73, 0
    v_mov_b32 v74, 0
    v_mov_b32 v75, 0
    v_mov_b32 v76, 0
    v_mov_b32 v77, 0
    v_mov_b32 v78, 0
    v_mov_b32 v79, 0
    v_mov_b32 v80, 0
    v_mov_b32 v81, 0
    v_mov_b32 v82, 0
    v_mov_b32 v83, 0
    v_mov_b32 v84, 0
    v_mov_b32 v85, 0
    v_mov_b32 v86, 0
    v_mov_b32 v87, 0
    v_mov_b32 v88, 0
    v_mov_b32 v89, 0
    v_mov_b32 v90, 0
    v_mov_b32 v91, 0
    v_mov_b32 v92, 0
    v_mov_b32 v93, 0
    v_mov_b32 v94, 0
    v_mov_b32 v95, 0
    v_mov_b32 v96, 0
    v_mov_b32 v97, 0
    v_mov_b32 v98, 0
    v_mov_b32 v99, 0
    v_mov_b32 v100, 0
    v_mov_b32 v101, 0
    v_mov_b32 v102, 0
    v_mov_b32 v103, 0
    s_waitcnt vmcnt(8) lgkmcnt(0)
    s_barrier
    ds_read_b128 v[104:107], v10 offset:0
    ds_read_b64_tr_b16 v[120:121], v14 offset:0
    ds_read_b64_tr_b16 v[122:123], v14 offset:256
    ds_read_b64_tr_b16 v[124:125], v14 offset:4096
    ds_read_b64_tr_b16 v[126:127], v14 offset:4352
    ds_read_b128 v[108:111], v10 offset:4096
    s_waitcnt lgkmcnt(3)
    v_mfma_f32_32x32x16_bf16 v[40:55], v[120:123], v[104:107], v[40:55]
    ds_read_b128 v[112:115], v11 offset:0
    ds_read_b64_tr_b16 v[128:129], v14 offset:1024
    s_waitcnt lgkmcnt(3)
    v_mfma_f32_32x32x16_bf16 v[56:71], v[124:127], v[104:107], v[56:71]
    ds_read_b64_tr_b16 v[130:131], v14 offset:1280
    ds_read_b64_tr_b16 v[132:133], v14 offset:5120
    s_waitcnt lgkmcnt(4)
    v_mfma_f32_32x32x16_bf16 v[72:87], v[120:123], v[108:111], v[72:87]
    ds_read_b64_tr_b16 v[134:135], v14 offset:5376
    ds_read_b128 v[116:119], v11 offset:4096
    s_add_u32 m0, s50, 32768
    s_add_u32 s58, s60, 2
    s_and_b32 s58, s58, 7
    s_lshl_b32 s59, s58, 7
    s_add_u32 s59, s59, s40
    s_mul_i32 s63, s58, 65536
    s_add_u32 s63, s63, s42
    s_add_u32 s48, s59, 0
    buffer_load_dwordx4 v9, s[4:7], s48 offen  lds
    v_mfma_f32_32x32x16_bf16 v[88:103], v[124:127], v[108:111], v[88:103]
    s_add_u32 m0, s50, 36864
    s_add_u32 s48, s59, 32768
    buffer_load_dwordx4 v9, s[4:7], s48 offen  lds
    s_cmp_lg_u32 s52, 0
    s_cbranch_scc1 Lc0_135
    v_mfma_f32_32x32x16_bf16 v[16:31], v[32:35], v[120:123], 0
    s_branch Lc1_136
Lc0_135:
    v_mfma_f32_32x32x16_bf16 v[16:31], v[32:35], v[124:127], 0
Lc1_136:
    s_waitcnt lgkmcnt(3)
    v_mfma_f32_32x32x16_bf16 v[40:55], v[128:131], v[112:115], v[40:55]
    ds_read_b128 v[104:107], v12 offset:0
    ds_read_b64_tr_b16 v[120:121], v14 offset:2048
    s_waitcnt lgkmcnt(3)
    v_mfma_f32_32x32x16_bf16 v[56:71], v[132:135], v[112:115], v[56:71]
    ds_read_b64_tr_b16 v[122:123], v14 offset:2304
    ds_read_b64_tr_b16 v[124:125], v14 offset:6144
    s_waitcnt lgkmcnt(4)
    v_mfma_f32_32x32x16_bf16 v[72:87], v[128:131], v[116:119], v[72:87]
    ds_read_b64_tr_b16 v[126:127], v14 offset:6400
    ds_read_b128 v[108:111], v12 offset:4096
    s_add_u32 m0, s50, 40960
    s_add_u32 s48, s59, 65536
    buffer_load_dwordx4 v9, s[4:7], s48 offen  lds
    v_mfma_f32_32x32x16_bf16 v[88:103], v[132:135], v[116:119], v[88:103]
    s_add_u32 m0, s50, 45056
    s_add_u32 s48, s59, 98304
    buffer_load_dwordx4 v9, s[4:7], s48 offen  lds
    s_cmp_lg_u32 s52, 0
    s_cbranch_scc1 Lc0_137
    v_mfma_f32_32x32x16_bf16 v[16:31], v[32:35], v[128:131], v[16:31]
    s_branch Lc1_138
Lc0_137:
    v_mfma_f32_32x32x16_bf16 v[16:31], v[32:35], v[132:135], v[16:31]
Lc1_138:
    s_waitcnt lgkmcnt(3)
    v_mfma_f32_32x32x16_bf16 v[40:55], v[120:123], v[104:107], v[40:55]
    ds_read_b128 v[112:115], v13 offset:0
    ds_read_b64_tr_b16 v[128:129], v14 offset:3072
    s_waitcnt lgkmcnt(3)
    v_mfma_f32_32x32x16_bf16 v[56:71], v[124:127], v[104:107], v[56:71]
    ds_read_b64_tr_b16 v[130:131], v14 offset:3328
    ds_read_b64_tr_b16 v[132:133], v14 offset:7168
    s_waitcnt lgkmcnt(4)
    v_mfma_f32_32x32x16_bf16 v[72:87], v[120:123], v[108:111], v[72:87]
    ds_read_b64_tr_b16 v[134:135], v14 offset:7424
    ds_read_b128 v[116:119], v13 offset:4096
    s_add_u32 m0, s51, 32768
    s_add_u32 s49, s63, 0
    buffer_load_dwordx4 v7, s[8:11], s49 offen lds
    v_mfma_f32_32x32x16_bf16 v[88:103], v[124:127], v[108:111], v[88:103]
    s_add_u32 m0, s51, 36864
    s_add_u32 s49, s63, 64
    buffer_load_dwordx4 v7, s[8:11], s49 offen lds
    s_cmp_lg_u32 s52, 0
    s_cbranch_scc1 Lc0_139
    v_mfma_f32_32x32x16_bf16 v[16:31], v[32:35], v[120:123], v[16:31]
    s_branch Lc1_140
Lc0_139:
    v_mfma_f32_32x32x16_bf16 v[16:31], v[32:35], v[124:127], v[16:31]
Lc1_140:
    s_add_u32 m0, s51, 40960
    s_add_u32 s49, s63, 128
    buffer_load_dwordx4 v7, s[8:11], s49 offen lds
    s_add_u32 m0, s51, 45056
    s_add_u32 s49, s63, 192
    buffer_load_dwordx4 v7, s[8:11], s49 offen lds
    s_waitcnt vmcnt(8) lgkmcnt(0)
    s_barrier
    v_mfma_f32_32x32x16_bf16 v[40:55], v[128:131], v[112:115], v[40:55]
    ds_read_b128 v[104:107], v10 offset:16384
    ds_read_b64_tr_b16 v[120:121], v14 offset:16384
    v_mfma_f32_32x32x16_bf16 v[56:71], v[132:135], v[112:115], v[56:71]
    ds_read_b64_tr_b16 v[122:123], v14 offset:16640
    ds_read_b64_tr_b16 v[124:125], v14 offset:20480
    v_mfma_f32_32x32x16_bf16 v[72:87], v[128:131], v[116:119], v[72:87]
    ds_read_b64_tr_b16 v[126:127], v14 offset:20736
    ds_read_b128 v[108:111], v10 offset:20480
    s_add_u32 m0, s50, 0
    s_add_u32 s58, s60, 3
    s_and_b32 s58, s58, 7
    s_lshl_b32 s59, s58, 7
    s_add_u32 s59, s59, s40
    s_mul_i32 s63, s58, 65536
    s_add_u32 s63, s63, s42
    s_add_u32 s48, s59, 0
    buffer_load_dwordx4 v9, s[4:7], s48 offen  lds
    v_mfma_f32_32x32x16_bf16 v[88:103], v[132:135], v[116:119], v[88:103]
    s_add_u32 m0, s50, 4096
    s_add_u32 s48, s59, 32768
    buffer_load_dwordx4 v9, s[4:7], s48 offen  lds
    s_cmp_lg_u32 s52, 0
    s_cbranch_scc1 Lc0_141
    v_mfma_f32_32x32x16_bf16 v[16:31], v[32:35], v[128:131], v[16:31]
    s_branch Lc1_142
Lc0_141:
    v_mfma_f32_32x32x16_bf16 v[16:31], v[32:35], v[132:135], v[16:31]
Lc1_142:
    s_waitcnt lgkmcnt(3)
    v_mfma_f32_32x32x16_bf16 v[40:55], v[120:123], v[104:107], v[40:55]
    ds_read_b128 v[112:115], v11 offset:16384
    ds_read_b64_tr_b16 v[128:129], v14 offset:17408
    s_waitcnt lgkmcnt(3)
    v_mfma_f32_32x32x16_bf16 v[56:71], v[124:127], v[104:107], v[56:71]
    ds_read_b64_tr_b16 v[130:131], v14 offset:17664
    ds_read_b64_tr_b16 v[132:133], v14 offset:21504
    s_waitcnt lgkmcnt(4)
    v_mfma_f32_32x32x16_bf16 v[72:87], v[120:123], v[108:111], v[72:87]
    ds_read_b64_tr_b16 v[134:135], v14 offset:21760
    ds_read_b128 v[116:119], v11 offset:20480
    s_add_u32 m0, s50, 8192
    s_add_u32 s48, s59, 65536
    buffer_load_dwordx4 v9, s[4:7], s48 offen  lds
    v_mfma_f32_32x32x16_bf16 v[88:103], v[124:127], v[108:111], v[88:103]
    s_add_u32 m0, s50, 12288
    s_add_u32 s48, s59, 98304
    buffer_load_dwordx4 v9, s[4:7], s48 offen  lds
    s_cmp_lg_u32 s52, 0
    s_cbranch_scc1 Lc0_143
    v_mfma_f32_32x32x16_bf16 v[16:31], v[32:35], v[120:123], v[16:31]
    s_branch Lc1_144
Lc0_143:
    v_mfma_f32_32x32x16_bf16 v[16:31], v[32:35], v[124:127], v[16:31]
Lc1_144:
    s_waitcnt lgkmcnt(3)
    v_mfma_f32_32x32x16_bf16 v[40:55], v[128:131], v[112:115], v[40:55]
    ds_read_b128 v[104:107], v12 offset:16384
    ds_read_b64_tr_b16 v[120:121], v14 offset:18432
    s_waitcnt lgkmcnt(3)
    v_mfma_f32_32x32x16_bf16 v[56:71], v[132:135], v[112:115], v[56:71]
    ds_read_b64_tr_b16 v[122:123], v14 offset:18688
    ds_read_b64_tr_b16 v[124:125], v14 offset:22528
    s_waitcnt lgkmcnt(4)
    v_mfma_f32_32x32x16_bf16 v[72:87], v[128:131], v[116:119], v[72:87]
    ds_read_b64_tr_b16 v[126:127], v14 offset:22784
    ds_read_b128 v[108:111], v12 offset:20480
    s_add_u32 m0, s51, 0
    s_add_u32 s49, s63, 0
    buffer_load_dwordx4 v7, s[8:11], s49 offen lds
    v_mfma_f32_32x32x16_bf16 v[88:103], v[132:135], v[116:119], v[88:103]
    s_add_u32 m0, s51, 4096
    s_add_u32 s49, s63, 64
    buffer_load_dwordx4 v7, s[8:11], s49 offen lds
    s_cmp_lg_u32 s52, 0
    s_cbranch_scc1 Lc0_145
    v_mfma_f32_32x32x16_bf16 v[16:31], v[32:35], v[128:131], v[16:31]
    s_branch Lc1_146
Lc0_145:
    v_mfma_f32_32x32x16_bf16 v[16:31], v[32:35], v[132:135], v[16:31]
Lc1_146:
    s_waitcnt lgkmcnt(3)
    v_mfma_f32_32x32x16_bf16 v[40:55], v[120:123], v[104:107], v[40:55]
    ds_read_b128 v[112:115], v13 offset:16384
    ds_read_b64_tr_b16 v[128:129], v14 offset:19456
    s_waitcnt lgkmcnt(3)
    v_mfma_f32_32x32x16_bf16 v[56:71], v[124:127], v[104:107], v[56:71]
    ds_read_b64_tr_b16 v[130:131], v14 offset:19712
    ds_read_b64_tr_b16 v[132:133], v14 offset:23552
    s_waitcnt lgkmcnt(4)
    v_mfma_f32_32x32x16_bf16 v[72:87], v[120:123], v[108:111], v[72:87]
    ds_read_b64_tr_b16 v[134:135], v14 offset:23808
    ds_read_b128 v[116:119], v13 offset:20480
    s_add_u32 m0, s51, 8192
    s_add_u32 s49, s63, 128
    buffer_load_dwordx4 v7, s[8:11], s49 offen lds
    v_mfma_f32_32x32x16_bf16 v[88:103], v[124:127], v[108:111], v[88:103]
    s_cmp_lg_u32 s52, 0
    s_cbranch_scc1 Lc0_147
    v_mfma_f32_32x32x16_bf16 v[16:31], v[32:35], v[120:123], v[16:31]
    s_branch Lc1_148
Lc0_147:
    v_mfma_f32_32x32x16_bf16 v[16:31], v[32:35], v[124:127], v[16:31]
Lc1_148:
    s_add_u32 m0, s51, 12288
    s_add_u32 s49, s63, 192
    buffer_load_dwordx4 v7, s[8:11], s49 offen lds
    s_waitcnt vmcnt(8) lgkmcnt(0)
    s_barrier
    v_mfma_f32_32x32x16_bf16 v[40:55], v[128:131], v[112:115], v[40:55]
    ds_read_b128 v[104:107], v10 offset:32768
    ds_read_b64_tr_b16 v[120:121], v14 offset:32768
    v_mfma_f32_32x32x16_bf16 v[56:71], v[132:135], v[112:115], v[56:71]
    ds_read_b64_tr_b16 v[122:123], v14 offset:33024
    ds_read_b64_tr_b16 v[124:125], v14 offset:36864
    v_mfma_f32_32x32x16_bf16 v[72:87], v[128:131], v[116:119], v[72:87]
    ds_read_b64_tr_b16 v[126:127], v14 offset:37120
    ds_read_b128 v[108:111], v10 offset:36864
    s_add_u32 m0, s50, 16384
    s_add_u32 s58, s60, 4
    s_and_b32 s58, s58, 7
    s_lshl_b32 s59, s58, 7
    s_add_u32 s59, s59, s40
    s_mul_i32 s63, s58, 65536
    s_add_u32 s63, s63, s42
    s_add_u32 s48, s59, 0
    buffer_load_dwordx4 v9, s[4:7], s48 offen  lds
    v_mfma_f32_32x32x16_bf16 v[88:103], v[132:135], v[116:119], v[88:103]
    s_add_u32 m0, s50, 20480
    s_add_u32 s48, s59, 32768
    buffer_load_dwordx4 v9, s[4:7], s48 offen  lds
    s_cmp_lg_u32 s52, 0
    s_cbranch_scc1 Lc0_149
    v_mfma_f32_32x32x16_bf16 v[16:31], v[32:35], v[128:131], v[16:31]
    s_branch Lc1_150
Lc0_149:
    v_mfma_f32_32x32x16_bf16 v[16:31], v[32:35], v[132:135], v[16:31]
Lc1_150:
    s_waitcnt lgkmcnt(3)
    v_mfma_f32_32x32x16_bf16 v[40:55], v[120:123], v[104:107], v[40:55]
    ds_read_b128 v[112:115], v11 offset:32768
    ds_read_b64_tr_b16 v[128:129], v14 offset:33792
    s_waitcnt lgkmcnt(3)
    v_mfma_f32_32x32x16_bf16 v[56:71], v[124:127], v[104:107], v[56:71]
    ds_read_b64_tr_b16 v[130:131], v14 offset:34048
    ds_read_b64_tr_b16 v[132:133], v14 offset:37888
    s_waitcnt lgkmcnt(4)
    v_mfma_f32_32x32x16_bf16 v[72:87], v[120:123], v[108:111], v[72:87]
    ds_read_b64_tr_b16 v[134:135], v14 offset:38144
    ds_read_b128 v[116:119], v11 offset:36864
    s_add_u32 m0, s50, 24576
    s_add_u32 s48, s59, 65536
    buffer_load_dwordx4 v9, s[4:7], s48 offen  lds
    v_mfma_f32_32x32x16_bf16 v[88:103], v[124:127], v[108:111], v[88:103]
    s_add_u32 m0, s50, 28672
    s_add_u32 s48, s59, 98304
    buffer_load_dwordx4 v9, s[4:7], s48 offen  lds
    s_cmp_lg_u32 s52, 0
    s_cbranch_scc1 Lc0_151
    v_mfma_f32_32x32x16_bf16 v[16:31], v[32:35], v[120:123], v[16:31]
    s_branch Lc1_152
Lc0_151:
    v_mfma_f32_32x32x16_bf16 v[16:31], v[32:35], v[124:127], v[16:31]
Lc1_152:
    s_waitcnt lgkmcnt(3)
    v_mfma_f32_32x32x16_bf16 v[40:55], v[128:131], v[112:115], v[40:55]
    ds_read_b128 v[104:107], v12 offset:32768
    ds_read_b64_tr_b16 v[120:121], v14 offset:34816
    s_waitcnt lgkmcnt(3)
    v_mfma_f32_32x32x16_bf16 v[56:71], v[132:135], v[112:115], v[56:71]
    ds_read_b64_tr_b16 v[122:123], v14 offset:35072
    ds_read_b64_tr_b16 v[124:125], v14 offset:38912
    s_waitcnt lgkmcnt(4)
    v_mfma_f32_32x32x16_bf16 v[72:87], v[128:131], v[116:119], v[72:87]
    ds_read_b64_tr_b16 v[126:127], v14 offset:39168
    ds_read_b128 v[108:111], v12 offset:36864
    s_add_u32 m0, s51, 16384
    s_add_u32 s49, s63, 0
    buffer_load_dwordx4 v7, s[8:11], s49 offen lds
    v_mfma_f32_32x32x16_bf16 v[88:103], v[132:135], v[116:119], v[88:103]
    s_add_u32 m0, s51, 20480
    s_add_u32 s49, s63, 64
    buffer_load_dwordx4 v7, s[8:11], s49 offen lds
    s_cmp_lg_u32 s52, 0
    s_cbranch_scc1 Lc0_153
    v_mfma_f32_32x32x16_bf16 v[16:31], v[32:35], v[128:131], v[16:31]
    s_branch Lc1_154
Lc0_153:
    v_mfma_f32_32x32x16_bf16 v[16:31], v[32:35], v[132:135], v[16:31]
Lc1_154:
    s_waitcnt lgkmcnt(3)
    v_mfma_f32_32x32x16_bf16 v[40:55], v[120:123], v[104:107], v[40:55]
    ds_read_b128 v[112:115], v13 offset:32768
    ds_read_b64_tr_b16 v[128:129], v14 offset:35840
    s_waitcnt lgkmcnt(3)
    v_mfma_f32_32x32x16_bf16 v[56:71], v[124:127], v[104:107], v[56:71]
    ds_read_b64_tr_b16 v[130:131], v14 offset:36096
    ds_read_b64_tr_b16 v[132:133], v14 offset:39936
    s_waitcnt lgkmcnt(4)
    v_mfma_f32_32x32x16_bf16 v[72:87], v[120:123], v[108:111], v[72:87]
    ds_read_b64_tr_b16 v[134:135], v14 offset:40192
    ds_read_b128 v[116:119], v13 offset:36864
    s_add_u32 m0, s51, 24576
    s_add_u32 s49, s63, 128
    buffer_load_dwordx4 v7, s[8:11], s49 offen lds
    v_mfma_f32_32x32x16_bf16 v[88:103], v[124:127], v[108:111], v[88:103]
    s_cmp_lg_u32 s52, 0
    s_cbranch_scc1 Lc0_155
    v_mfma_f32_32x32x16_bf16 v[16:31], v[32:35], v[120:123], v[16:31]
    s_branch Lc1_156
Lc0_155:
    v_mfma_f32_32x32x16_bf16 v[16:31], v[32:35], v[124:127], v[16:31]
Lc1_156:
    s_add_u32 m0, s51, 28672
    s_add_u32 s49, s63, 192
    buffer_load_dwordx4 v7, s[8:11], s49 offen lds
    s_waitcnt vmcnt(8) lgkmcnt(0)
    s_barrier
    v_mfma_f32_32x32x16_bf16 v[40:55], v[128:131], v[112:115], v[40:55]
    ds_read_b128 v[104:107], v10 offset:0
    ds_read_b64_tr_b16 v[120:121], v14 offset:0
    v_mfma_f32_32x32x16_bf16 v[56:71], v[132:135], v[112:115], v[56:71]
    ds_read_b64_tr_b16 v[122:123], v14 offset:256
    ds_read_b64_tr_b16 v[124:125], v14 offset:4096
    v_mfma_f32_32x32x16_bf16 v[72:87], v[128:131], v[116:119], v[72:87]
    ds_read_b64_tr_b16 v[126:127], v14 offset:4352
    ds_read_b128 v[108:111], v10 offset:4096
    s_add_u32 m0, s50, 32768
    s_add_u32 s58, s60, 5
    s_and_b32 s58, s58, 7
    s_lshl_b32 s59, s58, 7
    s_add_u32 s59, s59, s40
    s_mul_i32 s63, s58, 65536
    s_add_u32 s63, s63, s42
    s_add_u32 s48, s59, 0
    buffer_load_dwordx4 v9, s[4:7], s48 offen  lds
    v_mfma_f32_32x32x16_bf16 v[88:103], v[132:135], v[116:119], v[88:103]
    s_add_u32 m0, s50, 36864
    s_add_u32 s48, s59, 32768
    buffer_load_dwordx4 v9, s[4:7], s48 offen  lds
    s_cmp_lg_u32 s52, 0
    s_cbranch_scc1 Lc0_157
    v_mfma_f32_32x32x16_bf16 v[16:31], v[32:35], v[128:131], v[16:31]
    s_branch Lc1_158
Lc0_157:
    v_mfma_f32_32x32x16_bf16 v[16:31], v[32:35], v[132:135], v[16:31]
Lc1_158:
    s_waitcnt lgkmcnt(3)
    v_mfma_f32_32x32x16_bf16 v[40:55], v[120:123], v[104:107], v[40:55]
    ds_read_b128 v[112:115], v11 offset:0
    ds_read_b64_tr_b16 v[128:129], v14 offset:1024
    s_waitcnt lgkmcnt(3)
    v_mfma_f32_32x32x16_bf16 v[56:71], v[124:127], v[104:107], v[56:71]
    ds_read_b64_tr_b16 v[130:131], v14 offset:1280
    ds_read_b64_tr_b16 v[132:133], v14 offset:5120
    s_waitcnt lgkmcnt(4)
    v_mfma_f32_32x32x16_bf16 v[72:87], v[120:123], v[108:111], v[72:87]
    ds_read_b64_tr_b16 v[134:135], v14 offset:5376
    ds_read_b128 v[116:119], v11 offset:4096
    s_add_u32 m0, s50, 40960
    s_add_u32 s48, s59, 65536
    buffer_load_dwordx4 v9, s[4:7], s48 offen  lds
    v_mfma_f32_32x32x16_bf16 v[88:103], v[124:127], v[108:111], v[88:103]
    s_add_u32 m0, s50, 45056
    s_add_u32 s48, s59, 98304
    buffer_load_dwordx4 v9, s[4:7], s48 offen  lds
    s_cmp_lg_u32 s52, 0
    s_cbranch_scc1 Lc0_159
    v_mfma_f32_32x32x16_bf16 v[16:31], v[32:35], v[120:123], v[16:31]
    s_branch Lc1_160
Lc0_159:
    v_mfma_f32_32x32x16_bf16 v[16:31], v[32:35], v[124:127], v[16:31]
Lc1_160:
    s_waitcnt lgkmcnt(3)
    v_mfma_f32_32x32x16_bf16 v[40:55], v[128:131], v[112:115], v[40:55]
    ds_read_b128 v[104:107], v12 offset:0
    ds_read_b64_tr_b16 v[120:121], v14 offset:2048
    s_waitcnt lgkmcnt(3)
    v_mfma_f32_32x32x16_bf16 v[56:71], v[132:135], v[112:115], v[56:71]
    ds_read_b64_tr_b16 v[122:123], v14 offset:2304
    ds_read_b64_tr_b16 v[124:125], v14 offset:6144
    s_waitcnt lgkmcnt(4)
    v_mfma_f32_32x32x16_bf16 v[72:87], v[128:131], v[116:119], v[72:87]
    ds_read_b64_tr_b16 v[126:127], v14 offset:6400
    ds_read_b128 v[108:111], v12 offset:4096
    s_add_u32 m0, s51, 32768
    s_add_u32 s49, s63, 0
    buffer_load_dwordx4 v7, s[8:11], s49 offen lds
    v_mfma_f32_32x32x16_bf16 v[88:103], v[132:135], v[116:119], v[88:103]
    s_add_u32 m0, s51, 36864
    s_add_u32 s49, s63, 64
    buffer_load_dwordx4 v7, s[8:11], s49 offen lds
    s_cmp_lg_u32 s52, 0
    s_cbranch_scc1 Lc0_161
    v_mfma_f32_32x32x16_bf16 v[16:31], v[32:35], v[128:131], v[16:31]
    s_branch Lc1_162
Lc0_161:
    v_mfma_f32_32x32x16_bf16 v[16:31], v[32:35], v[132:135], v[16:31]
Lc1_162:
    s_waitcnt lgkmcnt(3)
    v_mfma_f32_32x32x16_bf16 v[40:55], v[120:123], v[104:107], v[40:55]
    ds_read_b128 v[112:115], v13 offset:0
    ds_read_b64_tr_b16 v[128:129], v14 offset:3072
    s_waitcnt lgkmcnt(3)
    v_mfma_f32_32x32x16_bf16 v[56:71], v[124:127], v[104:107], v[56:71]
    ds_read_b64_tr_b16 v[130:131], v14 offset:3328
    ds_read_b64_tr_b16 v[132:133], v14 offset:7168
    s_waitcnt lgkmcnt(4)
    v_mfma_f32_32x32x16_bf16 v[72:87], v[120:123], v[108:111], v[72:87]
    ds_read_b64_tr_b16 v[134:135], v14 offset:7424
    ds_read_b128 v[116:119], v13 offset:4096
    s_add_u32 m0, s51, 40960
    s_add_u32 s49, s63, 128
    buffer_load_dwordx4 v7, s[8:11], s49 offen lds
    v_mfma_f32_32x32x16_bf16 v[88:103], v[124:127], v[108:111], v[88:103]
    s_cmp_lg_u32 s52, 0
    s_cbranch_scc1 Lc0_163
    v_mfma_f32_32x32x16_bf16 v[16:31], v[32:35], v[120:123], v[16:31]
    s_branch Lc1_164
Lc0_163:
    v_mfma_f32_32x32x16_bf16 v[16:31], v[32:35], v[124:127], v[16:31]
Lc1_164:
    s_add_u32 m0, s51, 45056
    s_add_u32 s49, s63, 192
    buffer_load_dwordx4 v7, s[8:11], s49 offen lds
    s_waitcnt vmcnt(8) lgkmcnt(0)
    s_barrier
    v_mfma_f32_32x32x16_bf16 v[40:55], v[128:131], v[112:115], v[40:55]
    ds_read_b128 v[104:107], v10 offset:16384
    ds_read_b64_tr_b16 v[120:121], v14 offset:16384
    v_mfma_f32_32x32x16_bf16 v[56:71], v[132:135], v[112:115], v[56:71]
    ds_read_b64_tr_b16 v[122:123], v14 offset:16640
    ds_read_b64_tr_b16 v[124:125], v14 offset:20480
    v_mfma_f32_32x32x16_bf16 v[72:87], v[128:131], v[116:119], v[72:87]
    ds_read_b64_tr_b16 v[126:127], v14 offset:20736
    ds_read_b128 v[108:111], v10 offset:20480
    s_add_u32 m0, s50, 0
    s_add_u32 s58, s60, 6
    s_and_b32 s58, s58, 7
    s_lshl_b32 s59, s58, 7
    s_add_u32 s59, s59, s40
    s_mul_i32 s63, s58, 65536
    s_add_u32 s63, s63, s42
    s_add_u32 s48, s59, 0
    buffer_load_dwordx4 v9, s[4:7], s48 offen  lds
    v_mfma_f32_32x32x16_bf16 v[88:103], v[132:135], v[116:119], v[88:103]
    s_add_u32 m0, s50, 4096
    s_add_u32 s48, s59, 32768
    buffer_load_dwordx4 v9, s[4:7], s48 offen  lds
    s_cmp_lg_u32 s52, 0
    s_cbranch_scc1 Lc0_165
    v_mfma_f32_32x32x16_bf16 v[16:31], v[32:35], v[128:131], v[16:31]
    s_branch Lc1_166
Lc0_165:
    v_mfma_f32_32x32x16_bf16 v[16:31], v[32:35], v[132:135], v[16:31]
Lc1_166:
    s_waitcnt lgkmcnt(3)
    v_mfma_f32_32x32x16_bf16 v[40:55], v[120:123], v[104:107], v[40:55]
    ds_read_b128 v[112:115], v11 offset:16384
    ds_read_b64_tr_b16 v[128:129], v14 offset:17408
    s_waitcnt lgkmcnt(3)
    v_mfma_f32_32x32x16_bf16 v[56:71], v[124:127], v[104:107], v[56:71]
    ds_read_b64_tr_b16 v[130:131], v14 offset:17664
    ds_read_b64_tr_b16 v[132:133], v14 offset:21504
    s_waitcnt lgkmcnt(4)
    v_mfma_f32_32x32x16_bf16 v[72:87], v[120:123], v[108:111], v[72:87]
    ds_read_b64_tr_b16 v[134:135], v14 offset:21760
    ds_read_b128 v[116:119], v11 offset:20480
    s_add_u32 m0, s50, 8192
    s_add_u32 s48, s59, 65536
    buffer_load_dwordx4 v9, s[4:7], s48 offen  lds
    v_mfma_f32_32x32x16_bf16 v[88:103], v[124:127], v[108:111], v[88:103]
    s_add_u32 m0, s50, 12288
    s_add_u32 s48, s59, 98304
    buffer_load_dwordx4 v9, s[4:7], s48 offen  lds
    s_cmp_lg_u32 s52, 0
    s_cbranch_scc1 Lc0_167
    v_mfma_f32_32x32x16_bf16 v[16:31], v[32:35], v[120:123], v[16:31]
    s_branch Lc1_168
Lc0_167:
    v_mfma_f32_32x32x16_bf16 v[16:31], v[32:35], v[124:127], v[16:31]
Lc1_168:
    s_waitcnt lgkmcnt(3)
    v_mfma_f32_32x32x16_bf16 v[40:55], v[128:131], v[112:115], v[40:55]
    ds_read_b128 v[104:107], v12 offset:16384
    ds_read_b64_tr_b16 v[120:121], v14 offset:18432
    s_waitcnt lgkmcnt(3)
    v_mfma_f32_32x32x16_bf16 v[56:71], v[132:135], v[112:115], v[56:71]
    ds_read_b64_tr_b16 v[122:123], v14 offset:18688
    ds_read_b64_tr_b16 v[124:125], v14 offset:22528
    s_waitcnt lgkmcnt(4)
    v_mfma_f32_32x32x16_bf16 v[72:87], v[128:131], v[116:119], v[72:87]
    ds_read_b64_tr_b16 v[126:127], v14 offset:22784
    ds_read_b128 v[108:111], v12 offset:20480
    s_add_u32 m0, s51, 0
    s_add_u32 s49, s63, 0
    buffer_load_dwordx4 v7, s[8:11], s49 offen lds
    v_mfma_f32_32x32x16_bf16 v[88:103], v[132:135], v[116:119], v[88:103]
    s_add_u32 m0, s51, 4096
    s_add_u32 s49, s63, 64
    buffer_load_dwordx4 v7, s[8:11], s49 offen lds
    s_cmp_lg_u32 s52, 0
    s_cbranch_scc1 Lc0_169
    v_mfma_f32_32x32x16_bf16 v[16:31], v[32:35], v[128:131], v[16:31]
    s_branch Lc1_170
Lc0_169:
    v_mfma_f32_32x32x16_bf16 v[16:31], v[32:35], v[132:135], v[16:31]
Lc1_170:
    s_waitcnt lgkmcnt(3)
    v_mfma_f32_32x32x16_bf16 v[40:55], v[120:123], v[104:107], v[40:55]
    ds_read_b128 v[112:115], v13 offset:16384
    ds_read_b64_tr_b16 v[128:129], v14 offset:19456
    s_waitcnt lgkmcnt(3)
    v_mfma_f32_32x32x16_bf16 v[56:71], v[124:127], v[104:107], v[56:71]
    ds_read_b64_tr_b16 v[130:131], v14 offset:19712
    ds_read_b64_tr_b16 v[132:133], v14 offset:23552
    s_waitcnt lgkmcnt(4)
    v_mfma_f32_32x32x16_bf16 v[72:87], v[120:123], v[108:111], v[72:87]
    ds_read_b64_tr_b16 v[134:135], v14 offset:23808
    ds_read_b128 v[116:119], v13 offset:20480
    s_add_u32 m0, s51, 8192
    s_add_u32 s49, s63, 128
    buffer_load_dwordx4 v7, s[8:11], s49 offen lds
    v_mfma_f32_32x32x16_bf16 v[88:103], v[124:127], v[108:111], v[88:103]
    s_cmp_lg_u32 s52, 0
    s_cbranch_scc1 Lc0_171
    v_mfma_f32_32x32x16_bf16 v[16:31], v[32:35], v[120:123], v[16:31]
    s_branch Lc1_172
Lc0_171:
    v_mfma_f32_32x32x16_bf16 v[16:31], v[32:35], v[124:127], v[16:31]
Lc1_172:
    s_add_u32 m0, s51, 12288
    s_add_u32 s49, s63, 192
    buffer_load_dwordx4 v7, s[8:11], s49 offen lds
    s_waitcnt vmcnt(8) lgkmcnt(0)
    s_barrier
    v_mfma_f32_32x32x16_bf16 v[40:55], v[128:131], v[112:115], v[40:55]
    ds_read_b128 v[104:107], v10 offset:32768
    ds_read_b64_tr_b16 v[120:121], v14 offset:32768
    v_mfma_f32_32x32x16_bf16 v[56:71], v[132:135], v[112:115], v[56:71]
    ds_read_b64_tr_b16 v[122:123], v14 offset:33024
    ds_read_b64_tr_b16 v[124:125], v14 offset:36864
    v_mfma_f32_32x32x16_bf16 v[72:87], v[128:131], v[116:119], v[72:87]
    ds_read_b64_tr_b16 v[126:127], v14 offset:37120
    ds_read_b128 v[108:111], v10 offset:36864
    s_add_u32 m0, s50, 16384
    s_add_u32 s58, s60, 7
    s_and_b32 s58, s58, 7
    s_lshl_b32 s59, s58, 7
    s_add_u32 s59, s59, s40
    s_mul_i32 s63, s58, 65536
    s_add_u32 s63, s63, s42
    s_add_u32 s48, s59, 0
    buffer_load_dwordx4 v9, s[4:7], s48 offen  lds
    v_mfma_f32_32x32x16_bf16 v[88:103], v[132:135], v[116:119], v[88:103]
    s_add_u32 m0, s50, 20480
    s_add_u32 s48, s59, 32768
    buffer_load_dwordx4 v9, s[4:7], s48 offen  lds
    s_cmp_lg_u32 s52, 0
    s_cbranch_scc1 Lc0_173
    v_mfma_f32_32x32x16_bf16 v[16:31], v[32:35], v[128:131], v[16:31]
    s_branch Lc1_174
Lc0_173:
    v_mfma_f32_32x32x16_bf16 v[16:31], v[32:35], v[132:135], v[16:31]
Lc1_174:
    s_waitcnt lgkmcnt(3)
    v_mfma_f32_32x32x16_bf16 v[40:55], v[120:123], v[104:107], v[40:55]
    ds_read_b128 v[112:115], v11 offset:32768
    ds_read_b64_tr_b16 v[128:129], v14 offset:33792
    s_waitcnt lgkmcnt(3)
    v_mfma_f32_32x32x16_bf16 v[56:71], v[124:127], v[104:107], v[56:71]
    ds_read_b64_tr_b16 v[130:131], v14 offset:34048
    ds_read_b64_tr_b16 v[132:133], v14 offset:37888
    s_waitcnt lgkmcnt(4)
    v_mfma_f32_32x32x16_bf16 v[72:87], v[120:123], v[108:111], v[72:87]
    ds_read_b64_tr_b16 v[134:135], v14 offset:38144
    ds_read_b128 v[116:119], v11 offset:36864
    s_add_u32 m0, s50, 24576
    s_add_u32 s48, s59, 65536
    buffer_load_dwordx4 v9, s[4:7], s48 offen  lds
    v_mfma_f32_32x32x16_bf16 v[88:103], v[124:127], v[108:111], v[88:103]
    s_add_u32 m0, s50, 28672
    s_add_u32 s48, s59, 98304
    buffer_load_dwordx4 v9, s[4:7], s48 offen  lds
    s_cmp_lg_u32 s52, 0
    s_cbranch_scc1 Lc0_175
    v_mfma_f32_32x32x16_bf16 v[16:31], v[32:35], v[120:123], v[16:31]
    s_branch Lc1_176
Lc0_175:
    v_mfma_f32_32x32x16_bf16 v[16:31], v[32:35], v[124:127], v[16:31]
Lc1_176:
    s_waitcnt lgkmcnt(3)
    v_mfma_f32_32x32x16_bf16 v[40:55], v[128:131], v[112:115], v[40:55]
    ds_read_b128 v[104:107], v12 offset:32768
    ds_read_b64_tr_b16 v[120:121], v14 offset:34816
    s_waitcnt lgkmcnt(3)
    v_mfma_f32_32x32x16_bf16 v[56:71], v[132:135], v[112:115], v[56:71]
    ds_read_b64_tr_b16 v[122:123], v14 offset:35072
    ds_read_b64_tr_b16 v[124:125], v14 offset:38912
    s_waitcnt lgkmcnt(4)
    v_mfma_f32_32x32x16_bf16 v[72:87], v[128:131], v[116:119], v[72:87]
    ds_read_b64_tr_b16 v[126:127], v14 offset:39168
    ds_read_b128 v[108:111], v12 offset:36864
    s_add_u32 m0, s51, 16384
    s_add_u32 s49, s63, 0
    buffer_load_dwordx4 v7, s[8:11], s49 offen lds
    v_mfma_f32_32x32x16_bf16 v[88:103], v[132:135], v[116:119], v[88:103]
    s_add_u32 m0, s51, 20480
    s_add_u32 s49, s63, 64
    buffer_load_dwordx4 v7, s[8:11], s49 offen lds
    s_cmp_lg_u32 s52, 0
    s_cbranch_scc1 Lc0_177
    v_mfma_f32_32x32x16_bf16 v[16:31], v[32:35], v[128:131], v[16:31]
    s_branch Lc1_178
Lc0_177:
    v_mfma_f32_32x32x16_bf16 v[16:31], v[32:35], v[132:135], v[16:31]
Lc1_178:
    s_waitcnt lgkmcnt(3)
    v_mfma_f32_32x32x16_bf16 v[40:55], v[120:123], v[104:107], v[40:55]
    ds_read_b128 v[112:115], v13 offset:32768
    ds_read_b64_tr_b16 v[128:129], v14 offset:35840
    s_waitcnt lgkmcnt(3)
    v_mfma_f32_32x32x16_bf16 v[56:71], v[124:127], v[104:107], v[56:71]
    ds_read_b64_tr_b16 v[130:131], v14 offset:36096
    ds_read_b64_tr_b16 v[132:133], v14 offset:39936
    s_waitcnt lgkmcnt(4)
    v_mfma_f32_32x32x16_bf16 v[72:87], v[120:123], v[108:111], v[72:87]
    ds_read_b64_tr_b16 v[134:135], v14 offset:40192
    ds_read_b128 v[116:119], v13 offset:36864
    s_add_u32 m0, s51, 24576
    s_add_u32 s49, s63, 128
    buffer_load_dwordx4 v7, s[8:11], s49 offen lds
    v_mfma_f32_32x32x16_bf16 v[88:103], v[124:127], v[108:111], v[88:103]
    s_cmp_lg_u32 s52, 0
    s_cbranch_scc1 Lc0_179
    v_mfma_f32_32x32x16_bf16 v[16:31], v[32:35], v[120:123], v[16:31]
    s_branch Lc1_180
Lc0_179:
    v_mfma_f32_32x32x16_bf16 v[16:31], v[32:35], v[124:127], v[16:31]
Lc1_180:
    s_add_u32 m0, s51, 28672
    s_add_u32 s49, s63, 192
    buffer_load_dwordx4 v7, s[8:11], s49 offen lds
    s_waitcnt vmcnt(8) lgkmcnt(0)
    s_barrier
    v_mfma_f32_32x32x16_bf16 v[40:55], v[128:131], v[112:115], v[40:55]
    ds_read_b128 v[104:107], v10 offset:0
    ds_read_b64_tr_b16 v[120:121], v14 offset:0
    v_mfma_f32_32x32x16_bf16 v[56:71], v[132:135], v[112:115], v[56:71]
    ds_read_b64_tr_b16 v[122:123], v14 offset:256
    ds_read_b64_tr_b16 v[124:125], v14 offset:4096
    v_mfma_f32_32x32x16_bf16 v[72:87], v[128:131], v[116:119], v[72:87]
    ds_read_b64_tr_b16 v[126:127], v14 offset:4352
    ds_read_b128 v[108:111], v10 offset:4096
    v_mfma_f32_32x32x16_bf16 v[88:103], v[132:135], v[116:119], v[88:103]
    s_cmp_lg_u32 s52, 0
    s_cbranch_scc1 Lc0_181
    v_mfma_f32_32x32x16_bf16 v[16:31], v[32:35], v[128:131], v[16:31]
    s_branch Lc1_182
Lc0_181:
    v_mfma_f32_32x32x16_bf16 v[16:31], v[32:35], v[132:135], v[16:31]
Lc1_182:
    s_waitcnt lgkmcnt(3)
    v_mfma_f32_32x32x16_bf16 v[40:55], v[120:123], v[104:107], v[40:55]
    ds_read_b128 v[112:115], v11 offset:0
    ds_read_b64_tr_b16 v[128:129], v14 offset:1024
    s_waitcnt lgkmcnt(3)
    v_mfma_f32_32x32x16_bf16 v[56:71], v[124:127], v[104:107], v[56:71]
    ds_read_b64_tr_b16 v[130:131], v14 offset:1280
    ds_read_b64_tr_b16 v[132:133], v14 offset:5120
    s_waitcnt lgkmcnt(4)
    v_mfma_f32_32x32x16_bf16 v[72:87], v[120:123], v[108:111], v[72:87]
    ds_read_b64_tr_b16 v[134:135], v14 offset:5376
    ds_read_b128 v[116:119], v11 offset:4096
    v_mfma_f32_32x32x16_bf16 v[88:103], v[124:127], v[108:111], v[88:103]
    s_cmp_lg_u32 s52, 0
    s_cbranch_scc1 Lc0_183
    v_mfma_f32_32x32x16_bf16 v[16:31], v[32:35], v[120:123], v[16:31]
    s_branch Lc1_184
Lc0_183:
    v_mfma_f32_32x32x16_bf16 v[16:31], v[32:35], v[124:127], v[16:31]
Lc1_184:
    s_waitcnt lgkmcnt(3)
    v_mfma_f32_32x32x16_bf16 v[40:55], v[128:131], v[112:115], v[40:55]
    ds_read_b128 v[104:107], v12 offset:0
    ds_read_b64_tr_b16 v[120:121], v14 offset:2048
    s_waitcnt lgkmcnt(3)
    v_mfma_f32_32x32x16_bf16 v[56:71], v[132:135], v[112:115], v[56:71]
    ds_read_b64_tr_b16 v[122:123], v14 offset:2304
    ds_read_b64_tr_b16 v[124:125], v14 offset:6144
    s_waitcnt lgkmcnt(4)
    v_mfma_f32_32x32x16_bf16 v[72:87], v[128:131], v[116:119], v[72:87]
    ds_read_b64_tr_b16 v[126:127], v14 offset:6400
    ds_read_b128 v[108:111], v12 offset:4096
    v_mfma_f32_32x32x16_bf16 v[88:103], v[132:135], v[116:119], v[88:103]
    s_cmp_lg_u32 s52, 0
    s_cbranch_scc1 Lc0_185
    v_mfma_f32_32x32x16_bf16 v[16:31], v[32:35], v[128:131], v[16:31]
    s_branch Lc1_186
Lc0_185:
    v_mfma_f32_32x32x16_bf16 v[16:31], v[32:35], v[132:135], v[16:31]
Lc1_186:
    s_waitcnt lgkmcnt(3)
    v_mfma_f32_32x32x16_bf16 v[40:55], v[120:123], v[104:107], v[40:55]
    ds_read_b128 v[112:115], v13 offset:0
    ds_read_b64_tr_b16 v[128:129], v14 offset:3072
    s_waitcnt lgkmcnt(3)
    v_mfma_f32_32x32x16_bf16 v[56:71], v[124:127], v[104:107], v[56:71]
    ds_read_b64_tr_b16 v[130:131], v14 offset:3328
    ds_read_b64_tr_b16 v[132:133], v14 offset:7168
    s_waitcnt lgkmcnt(4)
    v_mfma_f32_32x32x16_bf16 v[72:87], v[120:123], v[108:111], v[72:87]
    ds_read_b64_tr_b16 v[134:135], v14 offset:7424
    ds_read_b128 v[116:119], v13 offset:4096
    v_mfma_f32_32x32x16_bf16 v[88:103], v[124:127], v[108:111], v[88:103]
    s_cmp_lg_u32 s52, 0
    s_cbranch_scc1 Lc0_187
    v_mfma_f32_32x32x16_bf16 v[16:31], v[32:35], v[120:123], v[16:31]
    s_branch Lc1_188
Lc0_187:
    v_mfma_f32_32x32x16_bf16 v[16:31], v[32:35], v[124:127], v[16:31]
Lc1_188:
    s_waitcnt vmcnt(0) lgkmcnt(0)
    s_barrier
    v_and_b32 v38, 127, v0
    v_lshlrev_b32 v38, 2, v38
    s_lshl_b32 s43, s37, 9
    s_add_u32 s43, s43, 0x1604000
    buffer_load_dword v36, v38, s[12:15], s43 offen sc1
    s_add_u32 s43, s43, 0x2000
    buffer_load_dword v37, v38, s[12:15], s43 offen sc1
    v_mfma_f32_32x32x16_bf16 v[40:55], v[128:131], v[112:115], v[40:55]
    ds_read_b128 v[104:107], v10 offset:16384
    ds_read_b64_tr_b16 v[120:121], v14 offset:16384
    v_mfma_f32_32x32x16_bf16 v[56:71], v[132:135], v[112:115], v[56:71]
    ds_read_b64_tr_b16 v[122:123], v14 offset:16640
    ds_read_b64_tr_b16 v[124:125], v14 offset:20480
    v_mfma_f32_32x32x16_bf16 v[72:87], v[128:131], v[116:119], v[72:87]
    ds_read_b64_tr_b16 v[126:127], v14 offset:20736
    ds_read_b128 v[108:111], v10 offset:20480
    v_mfma_f32_32x32x16_bf16 v[88:103], v[132:135], v[116:119], v[88:103]
    s_cmp_lg_u32 s52, 0
    s_cbranch_scc1 Lc0_189
    v_mfma_f32_32x32x16_bf16 v[16:31], v[32:35], v[128:131], v[16:31]
    s_branch Lc1_190
Lc0_189:
    v_mfma_f32_32x32x16_bf16 v[16:31], v[32:35], v[132:135], v[16:31]
Lc1_190:
    s_waitcnt lgkmcnt(3)
    v_mfma_f32_32x32x16_bf16 v[40:55], v[120:123], v[104:107], v[40:55]
    ds_read_b128 v[112:115], v11 offset:16384
    ds_read_b64_tr_b16 v[128:129], v14 offset:17408
    s_waitcnt lgkmcnt(3)
    v_mfma_f32_32x32x16_bf16 v[56:71], v[124:127], v[104:107], v[56:71]
    ds_read_b64_tr_b16 v[130:131], v14 offset:17664
    ds_read_b64_tr_b16 v[132:133], v14 offset:21504
    s_waitcnt lgkmcnt(4)
    v_mfma_f32_32x32x16_bf16 v[72:87], v[120:123], v[108:111], v[72:87]
    ds_read_b64_tr_b16 v[134:135], v14 offset:21760
    ds_read_b128 v[116:119], v11 offset:20480
    v_mfma_f32_32x32x16_bf16 v[88:103], v[124:127], v[108:111], v[88:103]
    s_cmp_lg_u32 s52, 0
    s_cbranch_scc1 Lc0_191
    v_mfma_f32_32x32x16_bf16 v[16:31], v[32:35], v[120:123], v[16:31]
    s_branch Lc1_192
Lc0_191:
    v_mfma_f32_32x32x16_bf16 v[16:31], v[32:35], v[124:127], v[16:31]
Lc1_192:
    s_waitcnt lgkmcnt(3)
    v_mfma_f32_32x32x16_bf16 v[40:55], v[128:131], v[112:115], v[40:55]
    ds_read_b128 v[104:107], v12 offset:16384
    ds_read_b64_tr_b16 v[120:121], v14 offset:18432
    s_waitcnt lgkmcnt(3)
    v_mfma_f32_32x32x16_bf16 v[56:71], v[132:135], v[112:115], v[56:71]
    ds_read_b64_tr_b16 v[122:123], v14 offset:18688
    ds_read_b64_tr_b16 v[124:125], v14 offset:22528
    s_waitcnt lgkmcnt(4)
    v_mfma_f32_32x32x16_bf16 v[72:87], v[128:131], v[116:119], v[72:87]
    ds_read_b64_tr_b16 v[126:127], v14 offset:22784
    ds_read_b128 v[108:111], v12 offset:20480
    v_mfma_f32_32x32x16_bf16 v[88:103], v[132:135], v[116:119], v[88:103]
    s_cmp_lg_u32 s52, 0
    s_cbranch_scc1 Lc0_193
    v_mfma_f32_32x32x16_bf16 v[16:31], v[32:35], v[128:131], v[16:31]
    s_branch Lc1_194
Lc0_193:
    v_mfma_f32_32x32x16_bf16 v[16:31], v[32:35], v[132:135], v[16:31]
Lc1_194:
    s_waitcnt lgkmcnt(3)
    v_mfma_f32_32x32x16_bf16 v[40:55], v[120:123], v[104:107], v[40:55]
    ds_read_b128 v[112:115], v13 offset:16384
    ds_read_b64_tr_b16 v[128:129], v14 offset:19456
    s_waitcnt lgkmcnt(3)
    v_mfma_f32_32x32x16_bf16 v[56:71], v[124:127], v[104:107], v[56:71]
    ds_read_b64_tr_b16 v[130:131], v14 offset:19712
    ds_read_b64_tr_b16 v[132:133], v14 offset:23552
    s_waitcnt lgkmcnt(4)
    v_mfma_f32_32x32x16_bf16 v[72:87], v[120:123], v[108:111], v[72:87]
    ds_read_b64_tr_b16 v[134:135], v14 offset:23808
    ds_read_b128 v[116:119], v13 offset:20480
    v_mfma_f32_32x32x16_bf16 v[88:103], v[124:127], v[108:111], v[88:103]
    s_cmp_lg_u32 s52, 0
    s_cbranch_scc1 Lc0_195
    v_mfma_f32_32x32x16_bf16 v[16:31], v[32:35], v[120:123], v[16:31]
    s_branch Lc1_196
Lc0_195:
    v_mfma_f32_32x32x16_bf16 v[16:31], v[32:35], v[124:127], v[16:31]
Lc1_196:
    s_waitcnt lgkmcnt(3)
    v_mfma_f32_32x32x16_bf16 v[40:55], v[128:131], v[112:115], v[40:55]
    s_waitcnt lgkmcnt(1)
    v_mfma_f32_32x32x16_bf16 v[56:71], v[132:135], v[112:115], v[56:71]
    s_waitcnt lgkmcnt(0)
    v_mfma_f32_32x32x16_bf16 v[72:87], v[128:131], v[116:119], v[72:87]
    v_mfma_f32_32x32x16_bf16 v[88:103], v[132:135], v[116:119], v[88:103]
    s_cmp_lg_u32 s52, 0
    s_cbranch_scc1 Lc0_197
    v_mfma_f32_32x32x16_bf16 v[16:31], v[32:35], v[128:131], v[16:31]
    s_branch Lc1_198
Lc0_197:
    v_mfma_f32_32x32x16_bf16 v[16:31], v[32:35], v[132:135], v[16:31]
Lc1_198:
    s_waitcnt lgkmcnt(0)
    v_and_b32 v4, 31, v1
    v_lshlrev_b32 v4, 2, v4
    s_lshl_b32 s43, s53, 8
    s_lshl_b32 s44, s52, 7
    s_add_u32 s43, s43, s44
    s_add_u32 s43, s43, 147456
    v_add_u32 v5, s43, v4
    v_add_u32 v38, 147456, v38
    s_waitcnt vmcnt(0)
    s_nop 3
    ds_write_b32 v5, v16 offset:9216
    s_cmp_ge_u32 s36, 2
    s_cbranch_scc1 Ltk_199
    ds_write_b32 v38, v36 offset:8192
    ds_write_b32 v38, v37 offset:8704
Ltk_199:
    s_waitcnt lgkmcnt(0)
    s_barrier
    v_and_b32 v4, 31, v1
    v_lshlrev_b32 v4, 2, v4
    v_lshrrev_b32 v5, 5, v1
    v_lshlrev_b32 v5, 4, v5
    v_add_u32 v4, 147456, v4
    v_add_u32 v5, 147456, v5
    s_lshl_b32 s43, s37, 2
    s_lshl_b32 s44, s52, 1
    s_add_u32 s43, s43, s44
    s_lshl_b32 s43, s43, 5
    s_and_b32 s44, s38, 3
    s_lshl_b32 s44, s44, 3
    s_add_u32 s43, s43, s44
    s_lshl_b32 s44, s53, 2
    s_add_u32 s43, s43, s44
    s_lshl_b32 s43, s43, 10
    s_lshr_b32 s44, s38, 2
    s_lshl_b32 s44, s44, 21
    s_add_u32 s43, s43, s44
    v_mov_b32 v158, 0xbdd2d3e8
    v_mov_b32 v160, 0xc0135761
    v_mov_b32 v159, 0xbdd2d3e8
    v_mov_b32 v161, 0xc0135761
    s_mov_b32 s45, 0xc0135761
    s_sub_u32 s44, s38, 12
    s_lshr_b32 s62, s44, 1
    s_add_u32 s62, s62, 1
    s_sub_u32 s61, 0, s62
    s_and_b32 s44, s44, 1
    s_cmp_eq_u32 s44, 0
    s_cselect_b32 s62, s62, s61
    s_lshl_b32 s44, s37, 7
    s_add_u32 s62, s62, s44
    s_lshl_b32 s44, s52, 6
    s_add_u32 s62, s62, s44
    s_mov_b32 s61, 2048
    v_and_b32 v6, 31, v1
    v_add_u32 v6, s62, v6
    v_cmp_gt_u32 vcc, s61, v6
    v_lshrrev_b32 v156, 5, v6
    v_lshlrev_b32 v156, 15, v156
    v_and_b32 v6, 31, v6
    v_lshl_add_u32 v156, v6, 4, v156
    v_lshrrev_b32 v6, 5, v1
    v_lshl_add_u32 v156, v6, 9, v156
    v_mov_b32 v6, 0x7f000000
    v_cndmask_b32 v156, v6, v156, vcc
    v_and_b32 v6, 31, v1
    v_add_u32 v6, s62, v6
    v_add_u32 v6, 32, v6
    v_cmp_gt_u32 vcc, s61, v6
    v_lshrrev_b32 v162, 5, v6
    v_lshlrev_b32 v162, 15, v162
    v_and_b32 v6, 31, v6
    v_lshl_add_u32 v162, v6, 4, v162
    v_lshrrev_b32 v6, 5, v1
    v_lshl_add_u32 v162, v6, 9, v162
    v_mov_b32 v6, 0x7f000000
    v_cndmask_b32 v162, v6, v162, vcc
    s_and_b32 s43, s38, 3
    s_lshl_b32 s43, s43, 3
    s_lshl_b32 s44, s53, 2
    s_add_u32 s43, s43, s44
    s_lshl_b32 s43, s43, 10
    s_add_u32 s43, s43, 0x600000
    s_cmp_lg_u32 s52, 0
    s_cbranch_scc1 Lzf_200
    s_and_b32 s44, s38, 1
    s_mul_i32 s44, s44, 15
    s_cmp_lg_u32 s37, s44
    s_cbranch_scc1 Lzf_200
    s_sub_u32 s44, s38, 12
    s_lshr_b32 s61, s44, 1
    s_add_u32 s61, s61, 1
    v_and_b32 v6, 31, v1
    v_cmp_gt_u32 vcc, s61, v6
    s_and_b32 s44, s44, 1
    s_mul_i32 s61, s44, 31
    v_xor_b32 v6, s61, v6
    v_lshlrev_b32 v6, 4, v6
    s_mul_i32 s61, s44, 2064384
    v_add_u32 v6, s61, v6
    v_lshrrev_b32 v16, 5, v1
    v_lshl_add_u32 v6, v16, 9, v6
    v_mov_b32 v16, 0
    v_mov_b32 v17, 0
    v_mov_b32 v18, 0
    v_mov_b32 v19, 0
    s_and_saveexec_b64 s[62:63], vcc
    buffer_store_dwordx4 v[16:19], v6, s[12:15], s43 offen offset:0 sc1
    buffer_store_dwordx4 v[16:19], v6, s[12:15], s43 offen offset:1024 sc1
    buffer_store_dwordx4 v[16:19], v6, s[12:15], s43 offen offset:2048 sc1
    buffer_store_dwordx4 v[16:19], v6, s[12:15], s43 offen offset:3072 sc1
    s_mov_b64 exec, -1
Lzf_200:
    s_lshl_b32 s44, s52, 8
    v_add_u32 v4, s44, v4
    s_lshl_b32 s44, s53, 8
    v_add_u32 v5, s44, v5
    ds_read_b128 v[104:107], v5 offset:9216
    ds_read_b128 v[108:111], v5 offset:9248
    ds_read_b128 v[112:115], v5 offset:9280
    ds_read_b128 v[116:119], v5 offset:9312
    ds_read_b128 v[120:123], v5 offset:9344
    ds_read_b128 v[124:127], v5 offset:9376
    ds_read_b128 v[128:131], v5 offset:9408
    ds_read_b128 v[132:135], v5 offset:9440
    ds_read_b32 v136, v4 offset:8192
    ds_read_b32 v137, v4 offset:8704
    ds_read_b32 v138, v4 offset:8320
    ds_read_b32 v139, v4 offset:8832
    s_waitcnt lgkmcnt(0)
    v_pk_mul_f32 v[40:41], v[40:41], v[136:137] op_sel:[0,1] op_sel_hi:[1,1]
    v_pk_mul_f32 v[42:43], v[42:43], v[136:137] op_sel:[0,1] op_sel_hi:[1,1]
    v_pk_mul_f32 v[44:45], v[44:45], v[136:137] op_sel:[0,1] op_sel_hi:[1,1]
    v_pk_mul_f32 v[46:47], v[46:47], v[136:137] op_sel:[0,1] op_sel_hi:[1,1]
    v_pk_mul_f32 v[48:49], v[48:49], v[136:137] op_sel:[0,1] op_sel_hi:[1,1]
    v_pk_mul_f32 v[50:51], v[50:51], v[136:137] op_sel:[0,1] op_sel_hi:[1,1]
    v_pk_mul_f32 v[52:53], v[52:53], v[136:137] op_sel:[0,1] op_sel_hi:[1,1]
    v_pk_mul_f32 v[54:55], v[54:55], v[136:137] op_sel:[0,1] op_sel_hi:[1,1]
    v_pk_fma_f32 v[40:41], v[136:137], v[104:105], v[40:41] op_sel:[0,0,0] op_sel_hi:[0,1,1]
    v_pk_fma_f32 v[42:43], v[136:137], v[106:107], v[42:43] op_sel:[0,0,0] op_sel_hi:[0,1,1]
    v_pk_fma_f32 v[44:45], v[136:137], v[108:109], v[44:45] op_sel:[0,0,0] op_sel_hi:[0,1,1]
    v_pk_fma_f32 v[46:47], v[136:137], v[110:111], v[46:47] op_sel:[0,0,0] op_sel_hi:[0,1,1]
    v_pk_fma_f32 v[48:49], v[136:137], v[112:113], v[48:49] op_sel:[0,0,0] op_sel_hi:[0,1,1]
    v_pk_fma_f32 v[50:51], v[136:137], v[114:115], v[50:51] op_sel:[0,0,0] op_sel_hi:[0,1,1]
    v_pk_fma_f32 v[52:53], v[136:137], v[116:117], v[52:53] op_sel:[0,0,0] op_sel_hi:[0,1,1]
    v_pk_fma_f32 v[54:55], v[136:137], v[118:119], v[54:55] op_sel:[0,0,0] op_sel_hi:[0,1,1]
    v_pk_mul_f32 v[16:17], v[40:41], v[40:41]
    v_pk_mul_f32 v[18:19], v[42:43], v[42:43]
    v_pk_mul_f32 v[20:21], v[44:45], v[44:45]
    v_pk_mul_f32 v[22:23], v[46:47], v[46:47]
    v_pk_mul_f32 v[24:25], v[48:49], v[48:49]
    v_pk_mul_f32 v[26:27], v[50:51], v[50:51]
    v_pk_mul_f32 v[28:29], v[52:53], v[52:53]
    v_pk_mul_f32 v[30:31], v[54:55], v[54:55]
    v_pk_fma_f32 v[16:17], v[16:17], v[158:159], v[160:161]
    v_pk_fma_f32 v[18:19], v[18:19], v[158:159], v[160:161]
    v_pk_fma_f32 v[20:21], v[20:21], v[158:159], v[160:161]
    v_pk_fma_f32 v[22:23], v[22:23], v[158:159], v[160:161]
    v_pk_fma_f32 v[24:25], v[24:25], v[158:159], v[160:161]
    v_pk_fma_f32 v[26:27], v[26:27], v[158:159], v[160:161]
    v_pk_fma_f32 v[28:29], v[28:29], v[158:159], v[160:161]
    v_pk_fma_f32 v[30:31], v[30:31], v[158:159], v[160:161]
    v_pk_mul_f32 v[16:17], v[16:17], v[40:41]
    v_pk_mul_f32 v[18:19], v[18:19], v[42:43]
    v_pk_mul_f32 v[20:21], v[20:21], v[44:45]
    v_pk_mul_f32 v[22:23], v[22:23], v[46:47]
    v_pk_mul_f32 v[24:25], v[24:25], v[48:49]
    v_pk_mul_f32 v[26:27], v[26:27], v[50:51]
    v_pk_mul_f32 v[28:29], v[28:29], v[52:53]
    v_pk_mul_f32 v[30:31], v[30:31], v[54:55]
    v_exp_f32 v16, v16
    v_exp_f32 v17, v17
    v_exp_f32 v18, v18
    v_exp_f32 v19, v19
    v_exp_f32 v20, v20
    v_exp_f32 v21, v21
    v_exp_f32 v22, v22
    v_exp_f32 v23, v23
    v_exp_f32 v24, v24
    v_exp_f32 v25, v25
    v_exp_f32 v26, v26
    v_exp_f32 v27, v27
    v_exp_f32 v28, v28
    v_exp_f32 v29, v29
    v_exp_f32 v30, v30
    v_exp_f32 v31, v31
    s_nop 0
    v_pk_add_f32 v[16:17], v[16:17], 1.0 op_sel_hi:[1,0]
    v_pk_add_f32 v[18:19], v[18:19], 1.0 op_sel_hi:[1,0]
    v_pk_add_f32 v[20:21], v[20:21], 1.0 op_sel_hi:[1,0]
    v_pk_add_f32 v[22:23], v[22:23], 1.0 op_sel_hi:[1,0]
    v_pk_add_f32 v[24:25], v[24:25], 1.0 op_sel_hi:[1,0]
    v_pk_add_f32 v[26:27], v[26:27], 1.0 op_sel_hi:[1,0]
    v_pk_add_f32 v[28:29], v[28:29], 1.0 op_sel_hi:[1,0]
    v_pk_add_f32 v[30:31], v[30:31], 1.0 op_sel_hi:[1,0]
    v_rcp_f32 v16, v16
    v_rcp_f32 v17, v17
    v_rcp_f32 v18, v18
    v_rcp_f32 v19, v19
    v_rcp_f32 v20, v20
    v_rcp_f32 v21, v21
    v_rcp_f32 v22, v22
    v_rcp_f32 v23, v23
    v_rcp_f32 v24, v24
    v_rcp_f32 v25, v25
    v_rcp_f32 v26, v26
    v_rcp_f32 v27, v27
    v_rcp_f32 v28, v28
    v_rcp_f32 v29, v29
    v_rcp_f32 v30, v30
    v_rcp_f32 v31, v31
    s_nop 0
    v_pk_mul_f32 v[40:41], v[40:41], v[16:17]
    v_pk_mul_f32 v[42:43], v[42:43], v[18:19]
    v_pk_mul_f32 v[44:45], v[44:45], v[20:21]
    v_pk_mul_f32 v[46:47], v[46:47], v[22:23]
    v_pk_mul_f32 v[48:49], v[48:49], v[24:25]
    v_pk_mul_f32 v[50:51], v[50:51], v[26:27]
    v_pk_mul_f32 v[52:53], v[52:53], v[28:29]
    v_pk_mul_f32 v[54:55], v[54:55], v[30:31]
    v_cvt_pk_bf16_f32 v140, v40, v41
    v_cvt_pk_bf16_f32 v141, v42, v43
    v_cvt_pk_bf16_f32 v142, v44, v45
    v_cvt_pk_bf16_f32 v143, v46, v47
    v_cvt_pk_bf16_f32 v144, v48, v49
    v_cvt_pk_bf16_f32 v145, v50, v51
    v_cvt_pk_bf16_f32 v146, v52, v53
    v_cvt_pk_bf16_f32 v147, v54, v55
    s_add_u32 s44, s43, 0
    s_nop 0
    v_permlane32_swap_b32 v140, v142
    v_permlane32_swap_b32 v141, v143
    v_permlane32_swap_b32 v144, v146
    v_permlane32_swap_b32 v145, v147
    s_nop 1
    buffer_store_dwordx4 v[140:143], v156, s[12:15], s44 offen offset:0 sc1
    buffer_store_dwordx4 v[144:147], v156, s[12:15], s44 offen offset:1024 sc1
    v_pk_mul_f32 v[56:57], v[56:57], v[136:137] op_sel:[0,1] op_sel_hi:[1,1]
    v_pk_mul_f32 v[58:59], v[58:59], v[136:137] op_sel:[0,1] op_sel_hi:[1,1]
    v_pk_mul_f32 v[60:61], v[60:61], v[136:137] op_sel:[0,1] op_sel_hi:[1,1]
    v_pk_mul_f32 v[62:63], v[62:63], v[136:137] op_sel:[0,1] op_sel_hi:[1,1]
    v_pk_mul_f32 v[64:65], v[64:65], v[136:137] op_sel:[0,1] op_sel_hi:[1,1]
    v_pk_mul_f32 v[66:67], v[66:67], v[136:137] op_sel:[0,1] op_sel_hi:[1,1]
    v_pk_mul_f32 v[68:69], v[68:69], v[136:137] op_sel:[0,1] op_sel_hi:[1,1]
    v_pk_mul_f32 v[70:71], v[70:71], v[136:137] op_sel:[0,1] op_sel_hi:[1,1]
    v_pk_fma_f32 v[56:57], v[136:137], v[120:121], v[56:57] op_sel:[0,0,0] op_sel_hi:[0,1,1]
    v_pk_fma_f32 v[58:59], v[136:137], v[122:123], v[58:59] op_sel:[0,0,0] op_sel_hi:[0,1,1]
    v_pk_fma_f32 v[60:61], v[136:137], v[124:125], v[60:61] op_sel:[0,0,0] op_sel_hi:[0,1,1]
    v_pk_fma_f32 v[62:63], v[136:137], v[126:127], v[62:63] op_sel:[0,0,0] op_sel_hi:[0,1,1]
    v_pk_fma_f32 v[64:65], v[136:137], v[128:129], v[64:65] op_sel:[0,0,0] op_sel_hi:[0,1,1]
    v_pk_fma_f32 v[66:67], v[136:137], v[130:131], v[66:67] op_sel:[0,0,0] op_sel_hi:[0,1,1]
    v_pk_fma_f32 v[68:69], v[136:137], v[132:133], v[68:69] op_sel:[0,0,0] op_sel_hi:[0,1,1]
    v_pk_fma_f32 v[70:71], v[136:137], v[134:135], v[70:71] op_sel:[0,0,0] op_sel_hi:[0,1,1]
    v_pk_mul_f32 v[16:17], v[56:57], v[56:57]
    v_pk_mul_f32 v[18:19], v[58:59], v[58:59]
    v_pk_mul_f32 v[20:21], v[60:61], v[60:61]
    v_pk_mul_f32 v[22:23], v[62:63], v[62:63]
    v_pk_mul_f32 v[24:25], v[64:65], v[64:65]
    v_pk_mul_f32 v[26:27], v[66:67], v[66:67]
    v_pk_mul_f32 v[28:29], v[68:69], v[68:69]
    v_pk_mul_f32 v[30:31], v[70:71], v[70:71]
    v_pk_fma_f32 v[16:17], v[16:17], v[158:159], v[160:161]
    v_pk_fma_f32 v[18:19], v[18:19], v[158:159], v[160:161]
    v_pk_fma_f32 v[20:21], v[20:21], v[158:159], v[160:161]
    v_pk_fma_f32 v[22:23], v[22:23], v[158:159], v[160:161]
    v_pk_fma_f32 v[24:25], v[24:25], v[158:159], v[160:161]
    v_pk_fma_f32 v[26:27], v[26:27], v[158:159], v[160:161]
    v_pk_fma_f32 v[28:29], v[28:29], v[158:159], v[160:161]
    v_pk_fma_f32 v[30:31], v[30:31], v[158:159], v[160:161]
    v_pk_mul_f32 v[16:17], v[16:17], v[56:57]
    v_pk_mul_f32 v[18:19], v[18:19], v[58:59]
    v_pk_mul_f32 v[20:21], v[20:21], v[60:61]
    v_pk_mul_f32 v[22:23], v[22:23], v[62:63]
    v_pk_mul_f32 v[24:25], v[24:25], v[64:65]
    v_pk_mul_f32 v[26:27], v[26:27], v[66:67]
    v_pk_mul_f32 v[28:29], v[28:29], v[68:69]
    v_pk_mul_f32 v[30:31], v[30:31], v[70:71]
    v_exp_f32 v16, v16
    v_exp_f32 v17, v17
    v_exp_f32 v18, v18
    v_exp_f32 v19, v19
    v_exp_f32 v20, v20
    v_exp_f32 v21, v21
    v_exp_f32 v22, v22
    v_exp_f32 v23, v23
    v_exp_f32 v24, v24
    v_exp_f32 v25, v25
    v_exp_f32 v26, v26
    v_exp_f32 v27, v27
    v_exp_f32 v28, v28
    v_exp_f32 v29, v29
    v_exp_f32 v30, v30
    v_exp_f32 v31, v31
    s_nop 0
    v_pk_add_f32 v[16:17], v[16:17], 1.0 op_sel_hi:[1,0]
    v_pk_add_f32 v[18:19], v[18:19], 1.0 op_sel_hi:[1,0]
    v_pk_add_f32 v[20:21], v[20:21], 1.0 op_sel_hi:[1,0]
    v_pk_add_f32 v[22:23], v[22:23], 1.0 op_sel_hi:[1,0]
    v_pk_add_f32 v[24:25], v[24:25], 1.0 op_sel_hi:[1,0]
    v_pk_add_f32 v[26:27], v[26:27], 1.0 op_sel_hi:[1,0]
    v_pk_add_f32 v[28:29], v[28:29], 1.0 op_sel_hi:[1,0]
    v_pk_add_f32 v[30:31], v[30:31], 1.0 op_sel_hi:[1,0]
    v_rcp_f32 v16, v16
    v_rcp_f32 v17, v17
    v_rcp_f32 v18, v18
    v_rcp_f32 v19, v19
    v_rcp_f32 v20, v20
    v_rcp_f32 v21, v21
    v_rcp_f32 v22, v22
    v_rcp_f32 v23, v23
    v_rcp_f32 v24, v24
    v_rcp_f32 v25, v25
    v_rcp_f32 v26, v26
    v_rcp_f32 v27, v27
    v_rcp_f32 v28, v28
    v_rcp_f32 v29, v29
    v_rcp_f32 v30, v30
    v_rcp_f32 v31, v31
    s_nop 0
    v_pk_mul_f32 v[56:57], v[56:57], v[16:17]
    v_pk_mul_f32 v[58:59], v[58:59], v[18:19]
    v_pk_mul_f32 v[60:61], v[60:61], v[20:21]
    v_pk_mul_f32 v[62:63], v[62:63], v[22:23]
    v_pk_mul_f32 v[64:65], v[64:65], v[24:25]
    v_pk_mul_f32 v[66:67], v[66:67], v[26:27]
    v_pk_mul_f32 v[68:69], v[68:69], v[28:29]
    v_pk_mul_f32 v[70:71], v[70:71], v[30:31]
    v_cvt_pk_bf16_f32 v148, v56, v57
    v_cvt_pk_bf16_f32 v149, v58, v59
    v_cvt_pk_bf16_f32 v150, v60, v61
    v_cvt_pk_bf16_f32 v151, v62, v63
    v_cvt_pk_bf16_f32 v152, v64, v65
    v_cvt_pk_bf16_f32 v153, v66, v67
    v_cvt_pk_bf16_f32 v154, v68, v69
    v_cvt_pk_bf16_f32 v155, v70, v71
    s_add_u32 s44, s43, 2048
    s_nop 0
    v_permlane32_swap_b32 v148, v150
    v_permlane32_swap_b32 v149, v151
    v_permlane32_swap_b32 v152, v154
    v_permlane32_swap_b32 v153, v155
    s_nop 1
    buffer_store_dwordx4 v[148:151], v156, s[12:15], s44 offen offset:0 sc1
    buffer_store_dwordx4 v[152:155], v156, s[12:15], s44 offen offset:1024 sc1
    v_pk_mul_f32 v[72:73], v[72:73], v[138:139] op_sel:[0,1] op_sel_hi:[1,1]
    v_pk_mul_f32 v[74:75], v[74:75], v[138:139] op_sel:[0,1] op_sel_hi:[1,1]
    v_pk_mul_f32 v[76:77], v[76:77], v[138:139] op_sel:[0,1] op_sel_hi:[1,1]
    v_pk_mul_f32 v[78:79], v[78:79], v[138:139] op_sel:[0,1] op_sel_hi:[1,1]
    v_pk_mul_f32 v[80:81], v[80:81], v[138:139] op_sel:[0,1] op_sel_hi:[1,1]
    v_pk_mul_f32 v[82:83], v[82:83], v[138:139] op_sel:[0,1] op_sel_hi:[1,1]
    v_pk_mul_f32 v[84:85], v[84:85], v[138:139] op_sel:[0,1] op_sel_hi:[1,1]
    v_pk_mul_f32 v[86:87], v[86:87], v[138:139] op_sel:[0,1] op_sel_hi:[1,1]
    v_pk_fma_f32 v[72:73], v[138:139], v[104:105], v[72:73] op_sel:[0,0,0] op_sel_hi:[0,1,1]
    v_pk_fma_f32 v[74:75], v[138:139], v[106:107], v[74:75] op_sel:[0,0,0] op_sel_hi:[0,1,1]
    v_pk_fma_f32 v[76:77], v[138:139], v[108:109], v[76:77] op_sel:[0,0,0] op_sel_hi:[0,1,1]
    v_pk_fma_f32 v[78:79], v[138:139], v[110:111], v[78:79] op_sel:[0,0,0] op_sel_hi:[0,1,1]
    v_pk_fma_f32 v[80:81], v[138:139], v[112:113], v[80:81] op_sel:[0,0,0] op_sel_hi:[0,1,1]
    v_pk_fma_f32 v[82:83], v[138:139], v[114:115], v[82:83] op_sel:[0,0,0] op_sel_hi:[0,1,1]
    v_pk_fma_f32 v[84:85], v[138:139], v[116:117], v[84:85] op_sel:[0,0,0] op_sel_hi:[0,1,1]
    v_pk_fma_f32 v[86:87], v[138:139], v[118:119], v[86:87] op_sel:[0,0,0] op_sel_hi:[0,1,1]
    v_pk_mul_f32 v[16:17], v[72:73], v[72:73]
    v_pk_mul_f32 v[18:19], v[74:75], v[74:75]
    v_pk_mul_f32 v[20:21], v[76:77], v[76:77]
    v_pk_mul_f32 v[22:23], v[78:79], v[78:79]
    v_pk_mul_f32 v[24:25], v[80:81], v[80:81]
    v_pk_mul_f32 v[26:27], v[82:83], v[82:83]
    v_pk_mul_f32 v[28:29], v[84:85], v[84:85]
    v_pk_mul_f32 v[30:31], v[86:87], v[86:87]
    v_pk_fma_f32 v[16:17], v[16:17], v[158:159], v[160:161]
    v_pk_fma_f32 v[18:19], v[18:19], v[158:159], v[160:161]
    v_pk_fma_f32 v[20:21], v[20:21], v[158:159], v[160:161]
    v_pk_fma_f32 v[22:23], v[22:23], v[158:159], v[160:161]
    v_pk_fma_f32 v[24:25], v[24:25], v[158:159], v[160:161]
    v_pk_fma_f32 v[26:27], v[26:27], v[158:159], v[160:161]
    v_pk_fma_f32 v[28:29], v[28:29], v[158:159], v[160:161]
    v_pk_fma_f32 v[30:31], v[30:31], v[158:159], v[160:161]
    v_pk_mul_f32 v[16:17], v[16:17], v[72:73]
    v_pk_mul_f32 v[18:19], v[18:19], v[74:75]
    v_pk_mul_f32 v[20:21], v[20:21], v[76:77]
    v_pk_mul_f32 v[22:23], v[22:23], v[78:79]
    v_pk_mul_f32 v[24:25], v[24:25], v[80:81]
    v_pk_mul_f32 v[26:27], v[26:27], v[82:83]
    v_pk_mul_f32 v[28:29], v[28:29], v[84:85]
    v_pk_mul_f32 v[30:31], v[30:31], v[86:87]
    v_exp_f32 v16, v16
    v_exp_f32 v17, v17
    v_exp_f32 v18, v18
    v_exp_f32 v19, v19
    v_exp_f32 v20, v20
    v_exp_f32 v21, v21
    v_exp_f32 v22, v22
    v_exp_f32 v23, v23
    v_exp_f32 v24, v24
    v_exp_f32 v25, v25
    v_exp_f32 v26, v26
    v_exp_f32 v27, v27
    v_exp_f32 v28, v28
    v_exp_f32 v29, v29
    v_exp_f32 v30, v30
    v_exp_f32 v31, v31
    s_nop 0
    v_pk_add_f32 v[16:17], v[16:17], 1.0 op_sel_hi:[1,0]
    v_pk_add_f32 v[18:19], v[18:19], 1.0 op_sel_hi:[1,0]
    v_pk_add_f32 v[20:21], v[20:21], 1.0 op_sel_hi:[1,0]
    v_pk_add_f32 v[22:23], v[22:23], 1.0 op_sel_hi:[1,0]
    v_pk_add_f32 v[24:25], v[24:25], 1.0 op_sel_hi:[1,0]
    v_pk_add_f32 v[26:27], v[26:27], 1.0 op_sel_hi:[1,0]
    v_pk_add_f32 v[28:29], v[28:29], 1.0 op_sel_hi:[1,0]
    v_pk_add_f32 v[30:31], v[30:31], 1.0 op_sel_hi:[1,0]
    v_rcp_f32 v16, v16
    v_rcp_f32 v17, v17
    v_rcp_f32 v18, v18
    v_rcp_f32 v19, v19
    v_rcp_f32 v20, v20
    v_rcp_f32 v21, v21
    v_rcp_f32 v22, v22
    v_rcp_f32 v23, v23
    v_rcp_f32 v24, v24
    v_rcp_f32 v25, v25
    v_rcp_f32 v26, v26
    v_rcp_f32 v27, v27
    v_rcp_f32 v28, v28
    v_rcp_f32 v29, v29
    v_rcp_f32 v30, v30
    v_rcp_f32 v31, v31
    s_nop 0
    v_pk_mul_f32 v[72:73], v[72:73], v[16:17]
    v_pk_mul_f32 v[74:75], v[74:75], v[18:19]
    v_pk_mul_f32 v[76:77], v[76:77], v[20:21]
    v_pk_mul_f32 v[78:79], v[78:79], v[22:23]
    v_pk_mul_f32 v[80:81], v[80:81], v[24:25]
    v_pk_mul_f32 v[82:83], v[82:83], v[26:27]
    v_pk_mul_f32 v[84:85], v[84:85], v[28:29]
    v_pk_mul_f32 v[86:87], v[86:87], v[30:31]
    v_cvt_pk_bf16_f32 v140, v72, v73
    v_cvt_pk_bf16_f32 v141, v74, v75
    v_cvt_pk_bf16_f32 v142, v76, v77
    v_cvt_pk_bf16_f32 v143, v78, v79
    v_cvt_pk_bf16_f32 v144, v80, v81
    v_cvt_pk_bf16_f32 v145, v82, v83
    v_cvt_pk_bf16_f32 v146, v84, v85
    v_cvt_pk_bf16_f32 v147, v86, v87
    s_add_u32 s44, s43, 0
    s_nop 0
    v_permlane32_swap_b32 v140, v142
    v_permlane32_swap_b32 v141, v143
    v_permlane32_swap_b32 v144, v146
    v_permlane32_swap_b32 v145, v147
    s_nop 1
    buffer_store_dwordx4 v[140:143], v162, s[12:15], s44 offen offset:0 sc1
    buffer_store_dwordx4 v[144:147], v162, s[12:15], s44 offen offset:1024 sc1
    v_pk_mul_f32 v[88:89], v[88:89], v[138:139] op_sel:[0,1] op_sel_hi:[1,1]
    v_pk_mul_f32 v[90:91], v[90:91], v[138:139] op_sel:[0,1] op_sel_hi:[1,1]
    v_pk_mul_f32 v[92:93], v[92:93], v[138:139] op_sel:[0,1] op_sel_hi:[1,1]
    v_pk_mul_f32 v[94:95], v[94:95], v[138:139] op_sel:[0,1] op_sel_hi:[1,1]
    v_pk_mul_f32 v[96:97], v[96:97], v[138:139] op_sel:[0,1] op_sel_hi:[1,1]
    v_pk_mul_f32 v[98:99], v[98:99], v[138:139] op_sel:[0,1] op_sel_hi:[1,1]
    v_pk_mul_f32 v[100:101], v[100:101], v[138:139] op_sel:[0,1] op_sel_hi:[1,1]
    v_pk_mul_f32 v[102:103], v[102:103], v[138:139] op_sel:[0,1] op_sel_hi:[1,1]
    v_pk_fma_f32 v[88:89], v[138:139], v[120:121], v[88:89] op_sel:[0,0,0] op_sel_hi:[0,1,1]
    v_pk_fma_f32 v[90:91], v[138:139], v[122:123], v[90:91] op_sel:[0,0,0] op_sel_hi:[0,1,1]
    v_pk_fma_f32 v[92:93], v[138:139], v[124:125], v[92:93] op_sel:[0,0,0] op_sel_hi:[0,1,1]
    v_pk_fma_f32 v[94:95], v[138:139], v[126:127], v[94:95] op_sel:[0,0,0] op_sel_hi:[0,1,1]
    v_pk_fma_f32 v[96:97], v[138:139], v[128:129], v[96:97] op_sel:[0,0,0] op_sel_hi:[0,1,1]
    v_pk_fma_f32 v[98:99], v[138:139], v[130:131], v[98:99] op_sel:[0,0,0] op_sel_hi:[0,1,1]
    v_pk_fma_f32 v[100:101], v[138:139], v[132:133], v[100:101] op_sel:[0,0,0] op_sel_hi:[0,1,1]
    v_pk_fma_f32 v[102:103], v[138:139], v[134:135], v[102:103] op_sel:[0,0,0] op_sel_hi:[0,1,1]
    v_pk_mul_f32 v[16:17], v[88:89], v[88:89]
    v_pk_mul_f32 v[18:19], v[90:91], v[90:91]
    v_pk_mul_f32 v[20:21], v[92:93], v[92:93]
    v_pk_mul_f32 v[22:23], v[94:95], v[94:95]
    v_pk_mul_f32 v[24:25], v[96:97], v[96:97]
    v_pk_mul_f32 v[26:27], v[98:99], v[98:99]
    v_pk_mul_f32 v[28:29], v[100:101], v[100:101]
    v_pk_mul_f32 v[30:31], v[102:103], v[102:103]
    v_pk_fma_f32 v[16:17], v[16:17], v[158:159], v[160:161]
    v_pk_fma_f32 v[18:19], v[18:19], v[158:159], v[160:161]
    v_pk_fma_f32 v[20:21], v[20:21], v[158:159], v[160:161]
    v_pk_fma_f32 v[22:23], v[22:23], v[158:159], v[160:161]
    v_pk_fma_f32 v[24:25], v[24:25], v[158:159], v[160:161]
    v_pk_fma_f32 v[26:27], v[26:27], v[158:159], v[160:161]
    v_pk_fma_f32 v[28:29], v[28:29], v[158:159], v[160:161]
    v_pk_fma_f32 v[30:31], v[30:31], v[158:159], v[160:161]
    v_pk_mul_f32 v[16:17], v[16:17], v[88:89]
    v_pk_mul_f32 v[18:19], v[18:19], v[90:91]
    v_pk_mul_f32 v[20:21], v[20:21], v[92:93]
    v_pk_mul_f32 v[22:23], v[22:23], v[94:95]
    v_pk_mul_f32 v[24:25], v[24:25], v[96:97]
    v_pk_mul_f32 v[26:27], v[26:27], v[98:99]
    v_pk_mul_f32 v[28:29], v[28:29], v[100:101]
    v_pk_mul_f32 v[30:31], v[30:31], v[102:103]
    v_exp_f32 v16, v16
    v_exp_f32 v17, v17
    v_exp_f32 v18, v18
    v_exp_f32 v19, v19
    v_exp_f32 v20, v20
    v_exp_f32 v21, v21
    v_exp_f32 v22, v22
    v_exp_f32 v23, v23
    v_exp_f32 v24, v24
    v_exp_f32 v25, v25
    v_exp_f32 v26, v26
    v_exp_f32 v27, v27
    v_exp_f32 v28, v28
    v_exp_f32 v29, v29
    v_exp_f32 v30, v30
    v_exp_f32 v31, v31
    s_nop 0
    v_pk_add_f32 v[16:17], v[16:17], 1.0 op_sel_hi:[1,0]
    v_pk_add_f32 v[18:19], v[18:19], 1.0 op_sel_hi:[1,0]
    v_pk_add_f32 v[20:21], v[20:21], 1.0 op_sel_hi:[1,0]
    v_pk_add_f32 v[22:23], v[22:23], 1.0 op_sel_hi:[1,0]
    v_pk_add_f32 v[24:25], v[24:25], 1.0 op_sel_hi:[1,0]
    v_pk_add_f32 v[26:27], v[26:27], 1.0 op_sel_hi:[1,0]
    v_pk_add_f32 v[28:29], v[28:29], 1.0 op_sel_hi:[1,0]
    v_pk_add_f32 v[30:31], v[30:31], 1.0 op_sel_hi:[1,0]
    v_rcp_f32 v16, v16
    v_rcp_f32 v17, v17
    v_rcp_f32 v18, v18
    v_rcp_f32 v19, v19
    v_rcp_f32 v20, v20
    v_rcp_f32 v21, v21
    v_rcp_f32 v22, v22
    v_rcp_f32 v23, v23
    v_rcp_f32 v24, v24
    v_rcp_f32 v25, v25
    v_rcp_f32 v26, v26
    v_rcp_f32 v27, v27
    v_rcp_f32 v28, v28
    v_rcp_f32 v29, v29
    v_rcp_f32 v30, v30
    v_rcp_f32 v31, v31
    s_nop 0
    v_pk_mul_f32 v[88:89], v[88:89], v[16:17]
    v_pk_mul_f32 v[90:91], v[90:91], v[18:19]
    v_pk_mul_f32 v[92:93], v[92:93], v[20:21]
    v_pk_mul_f32 v[94:95], v[94:95], v[22:23]
    v_pk_mul_f32 v[96:97], v[96:97], v[24:25]
    v_pk_mul_f32 v[98:99], v[98:99], v[26:27]
    v_pk_mul_f32 v[100:101], v[100:101], v[28:29]
    v_pk_mul_f32 v[102:103], v[102:103], v[30:31]
    v_cvt_pk_bf16_f32 v148, v88, v89
    v_cvt_pk_bf16_f32 v149, v90, v91
    v_cvt_pk_bf16_f32 v150, v92, v93
    v_cvt_pk_bf16_f32 v151, v94, v95
    v_cvt_pk_bf16_f32 v152, v96, v97
    v_cvt_pk_bf16_f32 v153, v98, v99
    v_cvt_pk_bf16_f32 v154, v100, v101
    v_cvt_pk_bf16_f32 v155, v102, v103
    s_add_u32 s44, s43, 2048
    s_nop 0
    v_permlane32_swap_b32 v148, v150
    v_permlane32_swap_b32 v149, v151
    v_permlane32_swap_b32 v152, v154
    v_permlane32_swap_b32 v153, v155
    s_nop 1
    buffer_store_dwordx4 v[148:151], v162, s[12:15], s44 offen offset:0 sc1
    buffer_store_dwordx4 v[152:155], v162, s[12:15], s44 offen offset:1024 sc1
    s_lshl_b32 s44, s37, 1
    s_sub_u32 s44, s44, 1
    s_waitcnt vmcnt(0)
    s_barrier
    s_cmp_lg_u32 s36, 0
    s_cbranch_scc1 Lsig_201
    v_lshrrev_b32 v2, 3, v1
    v_add_u32 v2, s44, v2
    v_cmp_gt_u32 vcc, 32, v2
    v_and_b32 v3, 3, v2
    v_lshrrev_b32 v2, 2, v2
    v_lshl_add_u32 v2, v3, 3, v2
    v_and_b32 v3, 7, v1
    v_lshl_add_u32 v2, v3, 5, v2
    v_lshlrev_b32 v2, 7, v2
    v_mov_b32 v3, 1
    s_mov_b32 s43, 0x1680004
    s_mov_b32 exec_lo, 0xffffffff
    s_mov_b32 exec_hi, 0x0
    s_and_b64 exec, exec, vcc
    buffer_atomic_add v3, v2, s[12:15], s43 offen sc1
    s_mov_b64 exec, -1
Lsig_201:
g1_done:
    v_mov_b32 v2, 163584
    v_mov_b32 v3, 1
    ds_write_b32 v2, v3 offset:16
    s_and_b32 s43, s2, 7
    s_lshl_b32 s37, s43, 2
    s_lshr_b32 s43, s2, 3
    s_and_b32 s43, s43, 3
    s_add_u32 s37, s37, s43
    s_lshr_b32 s38, s2, 5
    s_lshl_b32 s38, s38, 3
    s_lshl_b32 s43, s36, 1
    s_add_u32 s38, s38, s43
    s_mov_b32 s50, 0x0000ffff
    s_mov_b32 s51, 0x0000ffff
    v_lshlrev_b32 v4, 4, v1
    s_mov_b32 s47, 16640
    v_and_b32 v5, 15, v1
    v_lshlrev_b32 v5, 4, v5
    v_lshrrev_b32 v6, 5, v1
    v_lshl_add_u32 v5, v6, 8, v5
    v_and_b32 v6, 31, v1
    v_cmp_eq_u32 vcc, 16, v6
    v_mov_b32 v7, 9232
    v_mov_b32 v14, 9216
    v_cndmask_b32 v7, v7, v14, vcc
    v_cmp_gt_u32 vcc, 16, v6
    v_add_u32 v14, 8192, v5
    v_add_u32 v15, 8704, v5
    v_cndmask_b32 v14, v7, v14, vcc
    v_cndmask_b32 v15, v7, v15, vcc
    v_and_b32 v6, 1, v1
    v_cmp_eq_u32 vcc, 0, v6
    v_mov_b32 v7, 0x3f803f80
    v_lshlrev_b32 v6, 4, v6
    v_cndmask_b32 v116, 0, v7, vcc
    v_cndmask_b32 v117, 0, v7, vcc
    v_cndmask_b32 v118, 0, v7, vcc
    v_cndmask_b32 v119, 0, v7, vcc
    v_lshrrev_b32 v7, 4, v1
    s_mov_b32 s43, 16640
    v_mul_lo_u32 v7, v7, s43
    v_add_u32 v6, v6, v7
    v_bfe_u32 v7, v1, 1, 3
    s_mov_b32 s43, 1056
    v_mul_lo_u32 v7, v7, s43
    v_add_u32 v6, v6, v7
    ds_write_b128 v6, v[116:119] offset:9216
    v_mov_b32 v84, 0
    v_mov_b32 v100, 0
    v_mov_b32 v85, 0
    v_mov_b32 v101, 0
    v_mov_b32 v86, 0
    v_mov_b32 v102, 0
    v_mov_b32 v87, 0
    v_mov_b32 v103, 0
    v_mov_b32 v88, 0
    v_mov_b32 v104, 0
    v_mov_b32 v89, 0
    v_mov_b32 v105, 0
    v_mov_b32 v90, 0
    v_mov_b32 v106, 0
    v_mov_b32 v91, 0
    v_mov_b32 v107, 0
    v_mov_b32 v92, 0
    v_mov_b32 v108, 0
    v_mov_b32 v93, 0
    v_mov_b32 v109, 0
    v_mov_b32 v94, 0
    v_mov_b32 v110, 0
    v_mov_b32 v95, 0
    v_mov_b32 v111, 0
    v_mov_b32 v96, 0
    v_mov_b32 v112, 0
    v_mov_b32 v97, 0
    v_mov_b32 v113, 0
    v_mov_b32 v98, 0
    v_mov_b32 v114, 0
    v_mov_b32 v99, 0
    v_mov_b32 v115, 0
    v_mov_b32 v120, 0
    v_mov_b32 v152, 0
    v_mov_b32 v121, 0
    v_mov_b32 v153, 0
    v_mov_b32 v122, 0
    v_mov_b32 v154, 0
    v_mov_b32 v123, 0
    v_mov_b32 v155, 0
    v_mov_b32 v8, v4
    v_mov_b32 v10, v14
    v_mov_b32 v12, v15
    v_add_u32 v9, 16640, v4
    v_add_u32 v11, 16640, v14
    v_add_u32 v13, 16640, v15
    s_mov_b32 s39, 0
    v_mov_b32 v16, 163584
    s_lshl_b32 s43, s36, 2
    s_add_u32 s43, s43, 163616
    v_mov_b32 v17, s43
    v_mov_b32 v19, 0
    v_mov_b32 v2, 163584
    v_mov_b32 v3, 0x1
    s_mov_b64 exec, 1
    ds_or_b32 v2, v3 offset:12
    s_mov_b64 exec, -1
    s_lshr_b32 s44, s38, 2
Lqm_202:
    ds_read_b32 v18, v16 offset:52
    s_waitcnt lgkmcnt(0)
    v_readfirstlane_b32 s43, v18
    s_bitcmp1_b32 s43, s44
    s_cbranch_scc1 Lqmd_203
    s_sleep 1
    s_add_u32 s92, s92, 1
    s_cmp_gt_u32 s92, 0x400000
    s_cbranch_scc1 k_end
    s_branch Lqm_202
Lqmd_203:
    s_lshl_b32 s43, s38, 5
    s_add_u32 s43, s43, s37
    s_lshl_b32 s43, s43, 10
    buffer_load_dwordx4 v[124:127], v4, s[12:15], s43 offen sc1
    s_add_u32 s43, s43, 32768
    buffer_load_dwordx4 v[128:131], v4, s[12:15], s43 offen sc1
at_sp_204:
    ds_read_b32 v18, v16 offset:8
    s_waitcnt lgkmcnt(0)
    v_readfirstlane_b32 s43, v18
    s_cmp_gt_u32 s43, 0
    s_cbranch_scc1 at_ok_205
    s_sleep 1
    s_add_u32 s92, s92, 1
    s_cmp_gt_u32 s92, 0x400000
    s_cbranch_scc1 k_end
    s_branch at_sp_204
at_ok_205:
    s_waitcnt vmcnt(0)
    ds_read_b128 v[132:135], v8
    ds_read_b128 v[136:139], v8 offset:1024
    ds_read_b128 v[140:143], v10
    ds_read_b128 v[144:147], v12
    s_waitcnt lgkmcnt(3)
    v_mfma_f32_32x32x16_bf16 v[20:35], v[132:135], v[124:127], 0
    v_mfma_f32_32x32x16_bf16 v[36:51], v[132:135], v[128:131], 0
    s_nop 10
    v_max3_f32 v6, v20, v21, v22
    v_max3_f32 v6, v6, v23, v24
    v_max3_f32 v6, v6, v25, v26
    v_max3_f32 v6, v6, v27, v28
    v_max3_f32 v6, v6, v29, v30
    v_max3_f32 v6, v6, v31, v32
    v_max3_f32 v6, v6, v33, v34
    v_max_f32 v6, v6, v35
    v_mov_b32 v7, v6
    s_nop 1
    v_permlane32_swap_b32 v6, v7
    s_nop 1
    v_max_f32 v6, v6, v7
    v_sub_f32 v52, 0, v6
    v_sub_f32 v53, 0, v6
    v_sub_f32 v54, 0, v6
    v_sub_f32 v55, 0, v6
    v_sub_f32 v56, 0, v6
    v_sub_f32 v57, 0, v6
    v_sub_f32 v58, 0, v6
    v_sub_f32 v59, 0, v6
    v_sub_f32 v60, 0, v6
    v_sub_f32 v61, 0, v6
    v_sub_f32 v62, 0, v6
    v_sub_f32 v63, 0, v6
    v_sub_f32 v64, 0, v6
    v_sub_f32 v65, 0, v6
    v_sub_f32 v66, 0, v6
    v_sub_f32 v67, 0, v6
    v_max3_f32 v6, v36, v37, v38
    v_max3_f32 v6, v6, v39, v40
    v_max3_f32 v6, v6, v41, v42
    v_max3_f32 v6, v6, v43, v44
    v_max3_f32 v6, v6, v45, v46
    v_max3_f32 v6, v6, v47, v48
    v_max3_f32 v6, v6, v49, v50
    v_max_f32 v6, v6, v51
    v_mov_b32 v7, v6
    s_nop 1
    v_permlane32_swap_b32 v6, v7
    s_nop 1
    v_max_f32 v6, v6, v7
    v_sub_f32 v68, 0, v6
    v_sub_f32 v69, 0, v6
    v_sub_f32 v70, 0, v6
    v_sub_f32 v71, 0, v6
    v_sub_f32 v72, 0, v6
    v_sub_f32 v73, 0, v6
    v_sub_f32 v74, 0, v6
    v_sub_f32 v75, 0, v6
    v_sub_f32 v76, 0, v6
    v_sub_f32 v77, 0, v6
    v_sub_f32 v78, 0, v6
    v_sub_f32 v79, 0, v6
    v_sub_f32 v80, 0, v6
    v_sub_f32 v81, 0, v6
    v_sub_f32 v82, 0, v6
    v_sub_f32 v83, 0, v6
    s_nop 1
    v_mfma_f32_32x32x16_bf16 v[20:35], v[132:135], v[124:127], v[52:67]
    s_mov_b32 s42, 0
    s_waitcnt lgkmcnt(0)
    s_nop 8
    s_setprio 0
att_loop:
    v_mfma_f32_32x32x16_bf16 v[36:51], v[132:135], v[128:131], v[68:83]
    v_exp_f32 v20, v20
    v_exp_f32 v21, v21
    v_exp_f32 v22, v22
    v_exp_f32 v23, v23
    v_exp_f32 v24, v24
    v_exp_f32 v25, v25
    v_mfma_f32_32x32x16_bf16 v[100:115], v[152:155], v[120:123], v[100:115]
    s_waitcnt lgkmcnt(0)
    ds_read_b128 v[132:135], v8 offset:2048
    ds_read_b128 v[148:151], v10 offset:1056
    ds_read_b128 v[152:155], v12 offset:1056
    v_exp_f32 v26, v26
    v_exp_f32 v27, v27
    v_cvt_pk_bf16_f32 v116, v20, v21
    v_cvt_pk_bf16_f32 v117, v22, v23
    v_cvt_pk_bf16_f32 v118, v24, v25
    v_cvt_pk_bf16_f32 v119, v26, v27
    v_exp_f32 v28, v28
    v_exp_f32 v29, v29
    v_mfma_f32_32x32x16_bf16 v[84:99], v[140:143], v[116:119], v[84:99]
    v_exp_f32 v30, v30
    v_exp_f32 v31, v31
    v_exp_f32 v32, v32
    v_exp_f32 v33, v33
    v_exp_f32 v34, v34
    v_exp_f32 v35, v35
    v_cvt_pk_bf16_f32 v120, v28, v29
    v_cvt_pk_bf16_f32 v121, v30, v31
    v_cvt_pk_bf16_f32 v122, v32, v33
    v_cvt_pk_bf16_f32 v123, v34, v35
    v_mfma_f32_32x32x16_bf16 v[20:35], v[136:139], v[124:127], v[52:67]
    v_exp_f32 v36, v36
    v_exp_f32 v37, v37
    v_exp_f32 v38, v38
    v_exp_f32 v39, v39
    v_exp_f32 v40, v40
    v_exp_f32 v41, v41
    v_mfma_f32_32x32x16_bf16 v[84:99], v[144:147], v[120:123], v[84:99]
    v_exp_f32 v42, v42
    v_exp_f32 v43, v43
    v_cvt_pk_bf16_f32 v116, v36, v37
    v_cvt_pk_bf16_f32 v117, v38, v39
    v_cvt_pk_bf16_f32 v118, v40, v41
    v_cvt_pk_bf16_f32 v119, v42, v43
    v_exp_f32 v44, v44
    v_exp_f32 v45, v45
    v_mfma_f32_32x32x16_bf16 v[100:115], v[140:143], v[116:119], v[100:115]
    v_exp_f32 v46, v46
    v_exp_f32 v47, v47
    v_exp_f32 v48, v48
    v_exp_f32 v49, v49
    v_exp_f32 v50, v50
    v_exp_f32 v51, v51
    v_cvt_pk_bf16_f32 v120, v44, v45
    v_cvt_pk_bf16_f32 v121, v46, v47
    v_cvt_pk_bf16_f32 v122, v48, v49
    v_cvt_pk_bf16_f32 v123, v50, v51
    v_mfma_f32_32x32x16_bf16 v[36:51], v[136:139], v[128:131], v[68:83]
    v_exp_f32 v20, v20
    v_exp_f32 v21, v21
    v_exp_f32 v22, v22
    v_exp_f32 v23, v23
    v_exp_f32 v24, v24
    v_exp_f32 v25, v25
    v_mfma_f32_32x32x16_bf16 v[100:115], v[144:147], v[120:123], v[100:115]
    s_waitcnt lgkmcnt(0)
    ds_read_b128 v[136:139], v8 offset:3072
    ds_read_b128 v[140:143], v10 offset:2112
    ds_read_b128 v[144:147], v12 offset:2112
    v_exp_f32 v26, v26
    v_exp_f32 v27, v27
    v_cvt_pk_bf16_f32 v116, v20, v21
    v_cvt_pk_bf16_f32 v117, v22, v23
    v_cvt_pk_bf16_f32 v118, v24, v25
    v_cvt_pk_bf16_f32 v119, v26, v27
    v_exp_f32 v28, v28
    v_exp_f32 v29, v29
    v_mfma_f32_32x32x16_bf16 v[84:99], v[148:151], v[116:119], v[84:99]
    v_exp_f32 v30, v30
    v_exp_f32 v31, v31
    v_exp_f32 v32, v32
    v_exp_f32 v33, v33
    v_exp_f32 v34, v34
    v_exp_f32 v35, v35
    v_cvt_pk_bf16_f32 v120, v28, v29
    v_cvt_pk_bf16_f32 v121, v30, v31
    v_cvt_pk_bf16_f32 v122, v32, v33
    v_cvt_pk_bf16_f32 v123, v34, v35
    v_mfma_f32_32x32x16_bf16 v[20:35], v[132:135], v[124:127], v[52:67]
    v_exp_f32 v36, v36
    v_exp_f32 v37, v37
    v_exp_f32 v38, v38
    v_exp_f32 v39, v39
    v_exp_f32 v40, v40
    v_exp_f32 v41, v41
    v_mfma_f32_32x32x16_bf16 v[84:99], v[152:155], v[120:123], v[84:99]
    v_exp_f32 v42, v42
    v_exp_f32 v43, v43
    v_cvt_pk_bf16_f32 v116, v36, v37
    v_cvt_pk_bf16_f32 v117, v38, v39
    v_cvt_pk_bf16_f32 v118, v40, v41
    v_cvt_pk_bf16_f32 v119, v42, v43
    v_exp_f32 v44, v44
    v_exp_f32 v45, v45
    v_mfma_f32_32x32x16_bf16 v[100:115], v[148:151], v[116:119], v[100:115]
    v_exp_f32 v46, v46
    v_exp_f32 v47, v47
    v_exp_f32 v48, v48
    v_exp_f32 v49, v49
    v_exp_f32 v50, v50
    v_exp_f32 v51, v51
    v_cvt_pk_bf16_f32 v120, v44, v45
    v_cvt_pk_bf16_f32 v121, v46, v47
    v_cvt_pk_bf16_f32 v122, v48, v49
    v_cvt_pk_bf16_f32 v123, v50, v51
    v_mfma_f32_32x32x16_bf16 v[36:51], v[132:135], v[128:131], v[68:83]
    v_exp_f32 v20, v20
    v_exp_f32 v21, v21
    v_exp_f32 v22, v22
    v_exp_f32 v23, v23
    v_exp_f32 v24, v24
    v_exp_f32 v25, v25
    v_mfma_f32_32x32x16_bf16 v[100:115], v[152:155], v[120:123], v[100:115]
    s_waitcnt lgkmcnt(0)
    ds_read_b128 v[132:135], v8 offset:4096
    ds_read_b128 v[148:151], v10 offset:3168
    ds_read_b128 v[152:155], v12 offset:3168
    v_exp_f32 v26, v26
    v_exp_f32 v27, v27
    v_cvt_pk_bf16_f32 v116, v20, v21
    v_cvt_pk_bf16_f32 v117, v22, v23
    v_cvt_pk_bf16_f32 v118, v24, v25
    v_cvt_pk_bf16_f32 v119, v26, v27
    v_exp_f32 v28, v28
    v_exp_f32 v29, v29
    v_mfma_f32_32x32x16_bf16 v[84:99], v[140:143], v[116:119], v[84:99]
    v_exp_f32 v30, v30
    v_exp_f32 v31, v31
    v_exp_f32 v32, v32
    v_exp_f32 v33, v33
    v_exp_f32 v34, v34
    v_exp_f32 v35, v35
    v_cvt_pk_bf16_f32 v120, v28, v29
    v_cvt_pk_bf16_f32 v121, v30, v31
    v_cvt_pk_bf16_f32 v122, v32, v33
    v_cvt_pk_bf16_f32 v123, v34, v35
    v_mfma_f32_32x32x16_bf16 v[20:35], v[136:139], v[124:127], v[52:67]
    v_exp_f32 v36, v36
    v_exp_f32 v37, v37
    v_exp_f32 v38, v38
    v_exp_f32 v39, v39
    v_exp_f32 v40, v40
    v_exp_f32 v41, v41
    v_mfma_f32_32x32x16_bf16 v[84:99], v[144:147], v[120:123], v[84:99]
    v_exp_f32 v42, v42
    v_exp_f32 v43, v43
    v_cvt_pk_bf16_f32 v116, v36, v37
    v_cvt_pk_bf16_f32 v117, v38, v39
    v_cvt_pk_bf16_f32 v118, v40, v41
    v_cvt_pk_bf16_f32 v119, v42, v43
    v_exp_f32 v44, v44
    v_exp_f32 v45, v45
    v_mfma_f32_32x32x16_bf16 v[100:115], v[140:143], v[116:119], v[100:115]
    v_exp_f32 v46, v46
    v_exp_f32 v47, v47
    v_exp_f32 v48, v48
    v_exp_f32 v49, v49
    v_exp_f32 v50, v50
    v_exp_f32 v51, v51
    v_cvt_pk_bf16_f32 v120, v44, v45
    v_cvt_pk_bf16_f32 v121, v46, v47
    v_cvt_pk_bf16_f32 v122, v48, v49
    v_cvt_pk_bf16_f32 v123, v50, v51
    v_mfma_f32_32x32x16_bf16 v[36:51], v[136:139], v[128:131], v[68:83]
    v_exp_f32 v20, v20
    v_exp_f32 v21, v21
    v_exp_f32 v22, v22
    v_exp_f32 v23, v23
    v_exp_f32 v24, v24
    v_exp_f32 v25, v25
    v_mfma_f32_32x32x16_bf16 v[100:115], v[144:147], v[120:123], v[100:115]
    s_waitcnt lgkmcnt(0)
    ds_read_b128 v[136:139], v8 offset:5120
    ds_read_b128 v[140:143], v10 offset:4224
    ds_read_b128 v[144:147], v12 offset:4224
    v_exp_f32 v26, v26
    v_exp_f32 v27, v27
    v_cvt_pk_bf16_f32 v116, v20, v21
    v_cvt_pk_bf16_f32 v117, v22, v23
    v_cvt_pk_bf16_f32 v118, v24, v25
    v_cvt_pk_bf16_f32 v119, v26, v27
    v_exp_f32 v28, v28
    v_exp_f32 v29, v29
    v_mfma_f32_32x32x16_bf16 v[84:99], v[148:151], v[116:119], v[84:99]
    v_exp_f32 v30, v30
    v_exp_f32 v31, v31
    v_exp_f32 v32, v32
    v_exp_f32 v33, v33
    v_exp_f32 v34, v34
    v_exp_f32 v35, v35
    v_cvt_pk_bf16_f32 v120, v28, v29
    v_cvt_pk_bf16_f32 v121, v30, v31
    v_cvt_pk_bf16_f32 v122, v32, v33
    v_cvt_pk_bf16_f32 v123, v34, v35
    v_mfma_f32_32x32x16_bf16 v[20:35], v[132:135], v[124:127], v[52:67]
    v_exp_f32 v36, v36
    v_exp_f32 v37, v37
    v_exp_f32 v38, v38
    v_exp_f32 v39, v39
    v_exp_f32 v40, v40
    v_exp_f32 v41, v41
    v_mfma_f32_32x32x16_bf16 v[84:99], v[152:155], v[120:123], v[84:99]
    v_exp_f32 v42, v42
    v_exp_f32 v43, v43
    v_cvt_pk_bf16_f32 v116, v36, v37
    v_cvt_pk_bf16_f32 v117, v38, v39
    v_cvt_pk_bf16_f32 v118, v40, v41
    v_cvt_pk_bf16_f32 v119, v42, v43
    v_exp_f32 v44, v44
    v_exp_f32 v45, v45
    v_mfma_f32_32x32x16_bf16 v[100:115], v[148:151], v[116:119], v[100:115]
    v_exp_f32 v46, v46
    v_exp_f32 v47, v47
    v_exp_f32 v48, v48
    v_exp_f32 v49, v49
    v_exp_f32 v50, v50
    v_exp_f32 v51, v51
    v_cvt_pk_bf16_f32 v120, v44, v45
    v_cvt_pk_bf16_f32 v121, v46, v47
    v_cvt_pk_bf16_f32 v122, v48, v49
    v_cvt_pk_bf16_f32 v123, v50, v51
    v_mfma_f32_32x32x16_bf16 v[36:51], v[132:135], v[128:131], v[68:83]
    v_exp_f32 v20, v20
    v_exp_f32 v21, v21
    v_exp_f32 v22, v22
    v_exp_f32 v23, v23
    v_exp_f32 v24, v24
    v_exp_f32 v25, v25
    v_mfma_f32_32x32x16_bf16 v[100:115], v[152:155], v[120:123], v[100:115]
    s_waitcnt lgkmcnt(0)
    ds_read_b128 v[132:135], v8 offset:6144
    ds_read_b128 v[148:151], v10 offset:5280
    ds_read_b128 v[152:155], v12 offset:5280
    v_exp_f32 v26, v26
    v_exp_f32 v27, v27
    v_cvt_pk_bf16_f32 v116, v20, v21
    v_cvt_pk_bf16_f32 v117, v22, v23
    v_cvt_pk_bf16_f32 v118, v24, v25
    v_cvt_pk_bf16_f32 v119, v26, v27
    v_exp_f32 v28, v28
    v_exp_f32 v29, v29
    v_mfma_f32_32x32x16_bf16 v[84:99], v[140:143], v[116:119], v[84:99]
    v_exp_f32 v30, v30
    v_exp_f32 v31, v31
    v_exp_f32 v32, v32
    v_exp_f32 v33, v33
    v_exp_f32 v34, v34
    v_exp_f32 v35, v35
    v_cvt_pk_bf16_f32 v120, v28, v29
    v_cvt_pk_bf16_f32 v121, v30, v31
    v_cvt_pk_bf16_f32 v122, v32, v33
    v_cvt_pk_bf16_f32 v123, v34, v35
    v_mfma_f32_32x32x16_bf16 v[20:35], v[136:139], v[124:127], v[52:67]
    v_exp_f32 v36, v36
    v_exp_f32 v37, v37
    v_exp_f32 v38, v38
    v_exp_f32 v39, v39
    v_exp_f32 v40, v40
    v_exp_f32 v41, v41
    v_mfma_f32_32x32x16_bf16 v[84:99], v[144:147], v[120:123], v[84:99]
    v_exp_f32 v42, v42
    v_exp_f32 v43, v43
    v_cvt_pk_bf16_f32 v116, v36, v37
    v_cvt_pk_bf16_f32 v117, v38, v39
    v_cvt_pk_bf16_f32 v118, v40, v41
    v_cvt_pk_bf16_f32 v119, v42, v43
    v_exp_f32 v44, v44
    v_exp_f32 v45, v45
    v_mfma_f32_32x32x16_bf16 v[100:115], v[140:143], v[116:119], v[100:115]
    v_exp_f32 v46, v46
    v_exp_f32 v47, v47
    v_exp_f32 v48, v48
    v_exp_f32 v49, v49
    v_exp_f32 v50, v50
    v_exp_f32 v51, v51
    v_cvt_pk_bf16_f32 v120, v44, v45
    v_cvt_pk_bf16_f32 v121, v46, v47
    v_cvt_pk_bf16_f32 v122, v48, v49
    v_cvt_pk_bf16_f32 v123, v50, v51
    v_mfma_f32_32x32x16_bf16 v[36:51], v[136:139], v[128:131], v[68:83]
    v_exp_f32 v20, v20
    v_exp_f32 v21, v21
    v_exp_f32 v22, v22
    v_exp_f32 v23, v23
    v_exp_f32 v24, v24
    v_exp_f32 v25, v25
    v_mfma_f32_32x32x16_bf16 v[100:115], v[144:147], v[120:123], v[100:115]
    s_waitcnt lgkmcnt(0)
    ds_read_b32 v18, v16 offset:8
    ds_read_b128 v[136:139], v8 offset:7168
    ds_read_b128 v[140:143], v10 offset:6336
    ds_read_b128 v[144:147], v12 offset:6336
    v_exp_f32 v26, v26
    v_exp_f32 v27, v27
    v_cvt_pk_bf16_f32 v116, v20, v21
    v_cvt_pk_bf16_f32 v117, v22, v23
    v_cvt_pk_bf16_f32 v118, v24, v25
    v_cvt_pk_bf16_f32 v119, v26, v27
    v_exp_f32 v28, v28
    v_exp_f32 v29, v29
    v_mfma_f32_32x32x16_bf16 v[84:99], v[148:151], v[116:119], v[84:99]
    v_exp_f32 v30, v30
    v_exp_f32 v31, v31
    v_exp_f32 v32, v32
    v_exp_f32 v33, v33
    v_exp_f32 v34, v34
    v_exp_f32 v35, v35
    v_cvt_pk_bf16_f32 v120, v28, v29
    v_cvt_pk_bf16_f32 v121, v30, v31
    v_cvt_pk_bf16_f32 v122, v32, v33
    v_cvt_pk_bf16_f32 v123, v34, v35
    v_mfma_f32_32x32x16_bf16 v[20:35], v[132:135], v[124:127], v[52:67]
    v_exp_f32 v36, v36
    v_exp_f32 v37, v37
    v_exp_f32 v38, v38
    v_exp_f32 v39, v39
    v_exp_f32 v40, v40
    v_exp_f32 v41, v41
    v_mfma_f32_32x32x16_bf16 v[84:99], v[152:155], v[120:123], v[84:99]
    v_exp_f32 v42, v42
    v_exp_f32 v43, v43
    v_cvt_pk_bf16_f32 v116, v36, v37
    v_cvt_pk_bf16_f32 v117, v38, v39
    v_cvt_pk_bf16_f32 v118, v40, v41
    v_cvt_pk_bf16_f32 v119, v42, v43
    v_exp_f32 v44, v44
    v_exp_f32 v45, v45
    v_mfma_f32_32x32x16_bf16 v[100:115], v[148:151], v[116:119], v[100:115]
    v_exp_f32 v46, v46
    v_exp_f32 v47, v47
    v_exp_f32 v48, v48
    v_exp_f32 v49, v49
    v_exp_f32 v50, v50
    v_exp_f32 v51, v51
    v_cvt_pk_bf16_f32 v120, v44, v45
    v_cvt_pk_bf16_f32 v121, v46, v47
    v_cvt_pk_bf16_f32 v122, v48, v49
    v_cvt_pk_bf16_f32 v123, v50, v51
    v_mfma_f32_32x32x16_bf16 v[36:51], v[132:135], v[128:131], v[68:83]
    v_exp_f32 v20, v20
    v_exp_f32 v21, v21
    v_exp_f32 v22, v22
    v_exp_f32 v23, v23
    v_exp_f32 v24, v24
    v_exp_f32 v25, v25
    v_mfma_f32_32x32x16_bf16 v[100:115], v[152:155], v[120:123], v[100:115]
    s_waitcnt lgkmcnt(0)
    v_readfirstlane_b32 s43, v18
    s_min_u32 s44, s42, 6
    s_add_u32 s44, s44, 1
    s_cmp_gt_u32 s43, s44
    s_cbranch_scc1 att_rdy_206
at_sp_207:
    ds_read_b32 v18, v16 offset:8
    s_waitcnt lgkmcnt(0)
    v_readfirstlane_b32 s43, v18
    s_cmp_gt_u32 s43, s44
    s_cbranch_scc1 at_ok_208
    s_sleep 1
    s_add_u32 s92, s92, 1
    s_cmp_gt_u32 s92, 0x400000
    s_cbranch_scc1 k_end
    s_branch at_sp_207
at_ok_208:
att_rdy_206:
    ds_read_b128 v[132:135], v9 offset:0
    ds_read_b128 v[148:151], v10 offset:7392
    ds_read_b128 v[152:155], v12 offset:7392
    v_exp_f32 v26, v26
    v_exp_f32 v27, v27
    v_cvt_pk_bf16_f32 v116, v20, v21
    v_cvt_pk_bf16_f32 v117, v22, v23
    v_cvt_pk_bf16_f32 v118, v24, v25
    v_cvt_pk_bf16_f32 v119, v26, v27
    v_exp_f32 v28, v28
    v_exp_f32 v29, v29
    v_mfma_f32_32x32x16_bf16 v[84:99], v[140:143], v[116:119], v[84:99]
    v_exp_f32 v30, v30
    v_exp_f32 v31, v31
    v_exp_f32 v32, v32
    v_exp_f32 v33, v33
    v_exp_f32 v34, v34
    v_exp_f32 v35, v35
    v_cvt_pk_bf16_f32 v120, v28, v29
    v_cvt_pk_bf16_f32 v121, v30, v31
    v_cvt_pk_bf16_f32 v122, v32, v33
    v_cvt_pk_bf16_f32 v123, v34, v35
    v_mfma_f32_32x32x16_bf16 v[20:35], v[136:139], v[124:127], v[52:67]
    v_exp_f32 v36, v36
    v_exp_f32 v37, v37
    v_exp_f32 v38, v38
    v_exp_f32 v39, v39
    v_exp_f32 v40, v40
    v_exp_f32 v41, v41
    v_mfma_f32_32x32x16_bf16 v[84:99], v[144:147], v[120:123], v[84:99]
    v_exp_f32 v42, v42
    v_exp_f32 v43, v43
    v_cvt_pk_bf16_f32 v116, v36, v37
    v_cvt_pk_bf16_f32 v117, v38, v39
    v_cvt_pk_bf16_f32 v118, v40, v41
    v_cvt_pk_bf16_f32 v119, v42, v43
    v_exp_f32 v44, v44
    v_exp_f32 v45, v45
    v_mfma_f32_32x32x16_bf16 v[100:115], v[140:143], v[116:119], v[100:115]
    v_exp_f32 v46, v46
    v_exp_f32 v47, v47
    v_exp_f32 v48, v48
    v_exp_f32 v49, v49
    v_exp_f32 v50, v50
    v_exp_f32 v51, v51
    v_cvt_pk_bf16_f32 v120, v44, v45
    v_cvt_pk_bf16_f32 v121, v46, v47
    v_cvt_pk_bf16_f32 v122, v48, v49
    v_cvt_pk_bf16_f32 v123, v50, v51
    v_mfma_f32_32x32x16_bf16 v[36:51], v[136:139], v[128:131], v[68:83]
    v_exp_f32 v20, v20
    v_exp_f32 v21, v21
    v_exp_f32 v22, v22
    v_exp_f32 v23, v23
    v_exp_f32 v24, v24
    v_exp_f32 v25, v25
    v_mfma_f32_32x32x16_bf16 v[100:115], v[144:147], v[120:123], v[100:115]
    s_waitcnt lgkmcnt(0)
    v_add_u32 v19, 1, v19
    ds_write_b32 v17, v19
    ds_read_b128 v[136:139], v9 offset:1024
    ds_read_b128 v[140:143], v11 offset:0
    ds_read_b128 v[144:147], v13 offset:0
    v_exp_f32 v26, v26
    v_exp_f32 v27, v27
    v_cvt_pk_bf16_f32 v116, v20, v21
    v_cvt_pk_bf16_f32 v117, v22, v23
    v_cvt_pk_bf16_f32 v118, v24, v25
    v_cvt_pk_bf16_f32 v119, v26, v27
    v_exp_f32 v28, v28
    v_exp_f32 v29, v29
    v_mfma_f32_32x32x16_bf16 v[84:99], v[148:151], v[116:119], v[84:99]
    v_exp_f32 v30, v30
    v_exp_f32 v31, v31
    v_exp_f32 v32, v32
    v_exp_f32 v33, v33
    v_exp_f32 v34, v34
    v_exp_f32 v35, v35
    v_cvt_pk_bf16_f32 v120, v28, v29
    v_cvt_pk_bf16_f32 v121, v30, v31
    v_cvt_pk_bf16_f32 v122, v32, v33
    v_cvt_pk_bf16_f32 v123, v34, v35
    v_mfma_f32_32x32x16_bf16 v[20:35], v[132:135], v[124:127], v[52:67]
    v_exp_f32 v36, v36
    v_exp_f32 v37, v37
    v_exp_f32 v38, v38
    v_exp_f32 v39, v39
    v_exp_f32 v40, v40
    v_exp_f32 v41, v41
    v_mfma_f32_32x32x16_bf16 v[84:99], v[152:155], v[120:123], v[84:99]
    v_exp_f32 v42, v42
    v_exp_f32 v43, v43
    v_cvt_pk_bf16_f32 v116, v36, v37
    v_cvt_pk_bf16_f32 v117, v38, v39
    v_cvt_pk_bf16_f32 v118, v40, v41
    v_cvt_pk_bf16_f32 v119, v42, v43
    v_exp_f32 v44, v44
    v_exp_f32 v45, v45
    v_mfma_f32_32x32x16_bf16 v[100:115], v[148:151], v[116:119], v[100:115]
    v_exp_f32 v46, v46
    v_exp_f32 v47, v47
    v_exp_f32 v48, v48
    v_exp_f32 v49, v49
    v_exp_f32 v50, v50
    v_exp_f32 v51, v51
    v_cvt_pk_bf16_f32 v120, v44, v45
    v_cvt_pk_bf16_f32 v121, v46, v47
    v_cvt_pk_bf16_f32 v122, v48, v49
    v_cvt_pk_bf16_f32 v123, v50, v51
    v_mov_b32 v8, v9
    v_mov_b32 v10, v11
    v_mov_b32 v12, v13
    s_add_u32 s47, s47, 16640
    s_cmp_eq_u32 s47, 66560
    s_cselect_b32 s47, 0, s47
    v_add_u32 v9, s47, v4
    v_add_u32 v11, s47, v14
    v_add_u32 v13, s47, v15
    s_add_u32 s42, s42, 1
    s_cmp_lt_u32 s42, 8
    s_cbranch_scc1 att_loop
    v_mfma_f32_32x32x16_bf16 v[100:115], v[152:155], v[120:123], v[100:115]
    s_setprio 3
    s_waitcnt lgkmcnt(0)
att_fin:
    s_nop 12
    v_mov_b32 v20, v92
    v_mov_b32 v21, v92
    v_mov_b32 v22, v108
    v_mov_b32 v23, v108
    s_nop 1
    v_permlane32_swap_b32 v20, v21
    v_permlane32_swap_b32 v22, v23
    s_cmp_lg_u32 s39, 0
    s_cbranch_scc1 att_ok_209
    s_mov_b32 s43, 0x21800000
    s_mov_b32 s44, 0x5d800000
    v_cmp_nle_f32 vcc, s43, v20
    v_cmp_nge_f32 s[54:55], s44, v20
    s_or_b64 s[52:53], vcc, s[54:55]
    v_cmp_nle_f32 vcc, s43, v22
    v_cmp_nge_f32 s[54:55], s44, v22
    s_or_b64 vcc, vcc, s[54:55]
    s_or_b64 vcc, vcc, s[52:53]
    s_cbranch_scc1 att_fallback
att_ok_209:
    v_rcp_f32 v20, v20
    v_rcp_f32 v22, v22
    s_lshl_b32 s43, s38, 5
    s_add_u32 s43, s43, s37
    s_lshl_b32 s43, s43, 10
    s_add_u32 s43, s43, 0xa00000
    v_mul_f32 v84, v84, v20
    v_mul_f32 v85, v85, v20
    v_mul_f32 v86, v86, v20
    v_mul_f32 v87, v87, v20
    v_mul_f32 v88, v88, v20
    v_mul_f32 v89, v89, v20
    v_mul_f32 v90, v90, v20
    v_mul_f32 v91, v91, v20
    v_cvt_pk_bf16_f32 v116, v84, v85
    v_cvt_pk_bf16_f32 v117, v86, v87
    v_cvt_pk_bf16_f32 v118, v88, v89
    v_cvt_pk_bf16_f32 v119, v90, v91
    s_nop 1
    v_permlane32_swap_b32 v116, v118
    v_permlane32_swap_b32 v117, v119
    s_nop 1
    buffer_store_dwordx4 v[116:119], v4, s[12:15], s43 offen sc1
    v_mul_f32 v100, v100, v22
    v_mul_f32 v101, v101, v22
    v_mul_f32 v102, v102, v22
    v_mul_f32 v103, v103, v22
    v_mul_f32 v104, v104, v22
    v_mul_f32 v105, v105, v22
    v_mul_f32 v106, v106, v22
    v_mul_f32 v107, v107, v22
    v_cvt_pk_bf16_f32 v120, v100, v101
    v_cvt_pk_bf16_f32 v121, v102, v103
    v_cvt_pk_bf16_f32 v122, v104, v105
    v_cvt_pk_bf16_f32 v123, v106, v107
    s_add_u32 s43, s43, 32768
    s_nop 1
    v_permlane32_swap_b32 v120, v122
    v_permlane32_swap_b32 v121, v123
    s_nop 1
    buffer_store_dwordx4 v[120:123], v4, s[12:15], s43 offen sc1
    s_lshr_b32 s44, s38, 1
    s_waitcnt vmcnt(0)
    v_lshrrev_b32 v2, 3, v1
    v_add_u32 v2, s44, v2
    v_and_b32 v3, 3, v2
    v_lshrrev_b32 v2, 2, v2
    v_lshl_add_u32 v2, v3, 3, v2
    v_and_b32 v3, 7, v1
    v_lshl_add_u32 v2, v3, 5, v2
    v_lshlrev_b32 v2, 7, v2
    v_mov_b32 v3, 1
    s_mov_b32 s43, 0x1680010
    s_mov_b32 exec_lo, 0xff
    s_mov_b32 exec_hi, 0x0
    buffer_atomic_add v3, v2, s[12:15], s43 offen sc1
    s_mov_b64 exec, -1
Lsig_210:
    s_endpgm
att_fallback:
    s_mov_b32 s39, 1
    s_lshl_b32 s40, s37, 10
    s_add_u32 s41, s40, 0x400000
    s_add_u32 s40, s40, 0x200000
    v_mov_b32 v52, 0xff800000
    v_mov_b32 v68, 0xff800000
    v_mov_b32 v53, 0xff800000
    v_mov_b32 v69, 0xff800000
    v_mov_b32 v54, 0xff800000
    v_mov_b32 v70, 0xff800000
    v_mov_b32 v55, 0xff800000
    v_mov_b32 v71, 0xff800000
    v_mov_b32 v56, 0xff800000
    v_mov_b32 v72, 0xff800000
    v_mov_b32 v57, 0xff800000
    v_mov_b32 v73, 0xff800000
    v_mov_b32 v58, 0xff800000
    v_mov_b32 v74, 0xff800000
    v_mov_b32 v59, 0xff800000
    v_mov_b32 v75, 0xff800000
    v_mov_b32 v60, 0xff800000
    v_mov_b32 v76, 0xff800000
    v_mov_b32 v61, 0xff800000
    v_mov_b32 v77, 0xff800000
    v_mov_b32 v62, 0xff800000
    v_mov_b32 v78, 0xff800000
    v_mov_b32 v63, 0xff800000
    v_mov_b32 v79, 0xff800000
    v_mov_b32 v64, 0xff800000
    v_mov_b32 v80, 0xff800000
    v_mov_b32 v65, 0xff800000
    v_mov_b32 v81, 0xff800000
    v_mov_b32 v66, 0xff800000
    v_mov_b32 v82, 0xff800000
    v_mov_b32 v67, 0xff800000
    v_mov_b32 v83, 0xff800000
    s_mov_b32 s42, 0
    s_mov_b32 s43, s40
att_fb1:
    buffer_load_dwordx4 v[132:135], v4, s[12:15], s43 offen sc1
    s_waitcnt vmcnt(0)
    v_mfma_f32_32x32x16_bf16 v[20:35], v[132:135], v[124:127], 0
    v_mfma_f32_32x32x16_bf16 v[36:51], v[132:135], v[128:131], 0
    s_nop 12
    v_max_f32 v52, v52, v20
    v_max_f32 v53, v53, v21
    v_max_f32 v54, v54, v22
    v_max_f32 v55, v55, v23
    v_max_f32 v56, v56, v24
    v_max_f32 v57, v57, v25
    v_max_f32 v58, v58, v26
    v_max_f32 v59, v59, v27
    v_max_f32 v60, v60, v28
    v_max_f32 v61, v61, v29
    v_max_f32 v62, v62, v30
    v_max_f32 v63, v63, v31
    v_max_f32 v64, v64, v32
    v_max_f32 v65, v65, v33
    v_max_f32 v66, v66, v34
    v_max_f32 v67, v67, v35
    v_max_f32 v68, v68, v36
    v_max_f32 v69, v69, v37
    v_max_f32 v70, v70, v38
    v_max_f32 v71, v71, v39
    v_max_f32 v72, v72, v40
    v_max_f32 v73, v73, v41
    v_max_f32 v74, v74, v42
    v_max_f32 v75, v75, v43
    v_max_f32 v76, v76, v44
    v_max_f32 v77, v77, v45
    v_max_f32 v78, v78, v46
    v_max_f32 v79, v79, v47
    v_max_f32 v80, v80, v48
    v_max_f32 v81, v81, v49
    v_max_f32 v82, v82, v50
    v_max_f32 v83, v83, v51
    s_add_u32 s43, s43, 32768
    s_add_u32 s42, s42, 1
    s_cmp_lt_u32 s42, 64
    s_cbranch_scc1 att_fb1
    v_mov_b32 v20, v52
    v_mov_b32 v36, v68
    v_mov_b32 v21, v53
    v_mov_b32 v37, v69
    v_mov_b32 v22, v54
    v_mov_b32 v38, v70
    v_mov_b32 v23, v55
    v_mov_b32 v39, v71
    v_mov_b32 v24, v56
    v_mov_b32 v40, v72
    v_mov_b32 v25, v57
    v_mov_b32 v41, v73
    v_mov_b32 v26, v58
    v_mov_b32 v42, v74
    v_mov_b32 v27, v59
    v_mov_b32 v43, v75
    v_mov_b32 v28, v60
    v_mov_b32 v44, v76
    v_mov_b32 v29, v61
    v_mov_b32 v45, v77
    v_mov_b32 v30, v62
    v_mov_b32 v46, v78
    v_mov_b32 v31, v63
    v_mov_b32 v47, v79
    v_mov_b32 v32, v64
    v_mov_b32 v48, v80
    v_mov_b32 v33, v65
    v_mov_b32 v49, v81
    v_mov_b32 v34, v66
    v_mov_b32 v50, v82
    v_mov_b32 v35, v67
    v_mov_b32 v51, v83
    v_max3_f32 v6, v20, v21, v22
    v_max3_f32 v6, v6, v23, v24
    v_max3_f32 v6, v6, v25, v26
    v_max3_f32 v6, v6, v27, v28
    v_max3_f32 v6, v6, v29, v30
    v_max3_f32 v6, v6, v31, v32
    v_max3_f32 v6, v6, v33, v34
    v_max_f32 v6, v6, v35
    v_mov_b32 v7, v6
    s_nop 1
    v_permlane32_swap_b32 v6, v7
    s_nop 1
    v_max_f32 v6, v6, v7
    v_sub_f32 v52, 0, v6
    v_sub_f32 v53, 0, v6
    v_sub_f32 v54, 0, v6
    v_sub_f32 v55, 0, v6
    v_sub_f32 v56, 0, v6
    v_sub_f32 v57, 0, v6
    v_sub_f32 v58, 0, v6
    v_sub_f32 v59, 0, v6
    v_sub_f32 v60, 0, v6
    v_sub_f32 v61, 0, v6
    v_sub_f32 v62, 0, v6
    v_sub_f32 v63, 0, v6
    v_sub_f32 v64, 0, v6
    v_sub_f32 v65, 0, v6
    v_sub_f32 v66, 0, v6
    v_sub_f32 v67, 0, v6
    v_max3_f32 v6, v36, v37, v38
    v_max3_f32 v6, v6, v39, v40
    v_max3_f32 v6, v6, v41, v42
    v_max3_f32 v6, v6, v43, v44
    v_max3_f32 v6, v6, v45, v46
    v_max3_f32 v6, v6, v47, v48
    v_max3_f32 v6, v6, v49, v50
    v_max_f32 v6, v6, v51
    v_mov_b32 v7, v6
    s_nop 1
    v_permlane32_swap_b32 v6, v7
    s_nop 1
    v_max_f32 v6, v6, v7
    v_sub_f32 v68, 0, v6
    v_sub_f32 v69, 0, v6
    v_sub_f32 v70, 0, v6
    v_sub_f32 v71, 0, v6
    v_sub_f32 v72, 0, v6
    v_sub_f32 v73, 0, v6
    v_sub_f32 v74, 0, v6
    v_sub_f32 v75, 0, v6
    v_sub_f32 v76, 0, v6
    v_sub_f32 v77, 0, v6
    v_sub_f32 v78, 0, v6
    v_sub_f32 v79, 0, v6
    v_sub_f32 v80, 0, v6
    v_sub_f32 v81, 0, v6
    v_sub_f32 v82, 0, v6
    v_sub_f32 v83, 0, v6
    v_mov_b32 v84, 0
    v_mov_b32 v100, 0
    v_mov_b32 v85, 0
    v_mov_b32 v101, 0
    v_mov_b32 v86, 0
    v_mov_b32 v102, 0
    v_mov_b32 v87, 0
    v_mov_b32 v103, 0
    v_mov_b32 v88, 0
    v_mov_b32 v104, 0
    v_mov_b32 v89, 0
    v_mov_b32 v105, 0
    v_mov_b32 v90, 0
    v_mov_b32 v106, 0
    v_mov_b32 v91, 0
    v_mov_b32 v107, 0
    v_mov_b32 v92, 0
    v_mov_b32 v108, 0
    v_mov_b32 v93, 0
    v_mov_b32 v109, 0
    v_mov_b32 v94, 0
    v_mov_b32 v110, 0
    v_mov_b32 v95, 0
    v_mov_b32 v111, 0
    v_mov_b32 v96, 0
    v_mov_b32 v112, 0
    v_mov_b32 v97, 0
    v_mov_b32 v113, 0
    v_mov_b32 v98, 0
    v_mov_b32 v114, 0
    v_mov_b32 v99, 0
    v_mov_b32 v115, 0
    v_and_b32 v6, 31, v1
    v_cmp_eq_u32 vcc, 16, v6
    v_mov_b32 v7, 0x3f803f80
    s_nop 0
    v_cndmask_b32 v140, 0, v7, vcc
    v_cndmask_b32 v141, 0, v7, vcc
    v_cndmask_b32 v142, 0, v7, vcc
    v_cndmask_b32 v143, 0, v7, vcc
    v_cndmask_b32 v144, 0, v7, vcc
    v_cndmask_b32 v145, 0, v7, vcc
    v_cndmask_b32 v146, 0, v7, vcc
    v_cndmask_b32 v147, 0, v7, vcc
    s_mov_b32 s42, 0
att_fb2:
    buffer_load_dwordx4 v[132:135], v4, s[12:15], s40 offen sc1
    s_mov_b64 exec, s[50:51]
    buffer_load_dwordx4 v[140:143], v5, s[12:15], s41 offen sc1
    buffer_load_dwordx4 v[144:147], v5, s[12:15], s41 offen offset:512 sc1
    s_mov_b64 exec, -1
    s_waitcnt vmcnt(0)
    v_mfma_f32_32x32x16_bf16 v[20:35], v[132:135], v[124:127], v[52:67]
    v_mfma_f32_32x32x16_bf16 v[36:51], v[132:135], v[128:131], v[68:83]
    s_nop 12
    v_exp_f32 v20, v20
    v_exp_f32 v21, v21
    v_exp_f32 v22, v22
    v_exp_f32 v23, v23
    v_exp_f32 v24, v24
    v_exp_f32 v25, v25
    v_exp_f32 v26, v26
    v_exp_f32 v27, v27
    v_exp_f32 v28, v28
    v_exp_f32 v29, v29
    v_exp_f32 v30, v30
    v_exp_f32 v31, v31
    v_exp_f32 v32, v32
    v_exp_f32 v33, v33
    v_exp_f32 v34, v34
    v_exp_f32 v35, v35
    s_nop 0
    v_cvt_pk_bf16_f32 v116, v20, v21
    v_cvt_pk_bf16_f32 v117, v22, v23
    v_cvt_pk_bf16_f32 v118, v24, v25
    v_cvt_pk_bf16_f32 v119, v26, v27
    v_cvt_pk_bf16_f32 v120, v28, v29
    v_cvt_pk_bf16_f32 v121, v30, v31
    v_cvt_pk_bf16_f32 v122, v32, v33
    v_cvt_pk_bf16_f32 v123, v34, v35
    s_nop 1
    v_mfma_f32_32x32x16_bf16 v[84:99], v[140:143], v[116:119], v[84:99]
    v_mfma_f32_32x32x16_bf16 v[84:99], v[144:147], v[120:123], v[84:99]
    v_exp_f32 v36, v36
    v_exp_f32 v37, v37
    v_exp_f32 v38, v38
    v_exp_f32 v39, v39
    v_exp_f32 v40, v40
    v_exp_f32 v41, v41
    v_exp_f32 v42, v42
    v_exp_f32 v43, v43
    v_exp_f32 v44, v44
    v_exp_f32 v45, v45
    v_exp_f32 v46, v46
    v_exp_f32 v47, v47
    v_exp_f32 v48, v48
    v_exp_f32 v49, v49
    v_exp_f32 v50, v50
    v_exp_f32 v51, v51
    s_nop 0
    v_cvt_pk_bf16_f32 v116, v36, v37
    v_cvt_pk_bf16_f32 v117, v38, v39
    v_cvt_pk_bf16_f32 v118, v40, v41
    v_cvt_pk_bf16_f32 v119, v42, v43
    v_cvt_pk_bf16_f32 v120, v44, v45
    v_cvt_pk_bf16_f32 v121, v46, v47
    v_cvt_pk_bf16_f32 v122, v48, v49
    v_cvt_pk_bf16_f32 v123, v50, v51
    s_nop 1
    v_mfma_f32_32x32x16_bf16 v[100:115], v[140:143], v[116:119], v[100:115]
    v_mfma_f32_32x32x16_bf16 v[100:115], v[144:147], v[120:123], v[100:115]
    s_add_u32 s40, s40, 32768
    s_add_u32 s41, s41, 32768
    s_add_u32 s42, s42, 1
    s_cmp_lt_u32 s42, 64
    s_nop 7
    s_nop 7
    s_cbranch_scc1 att_fb2
    s_branch att_fin
k_chain:
    s_sub_u32 s36, s58, 5
    v_subrev_u32 v0, 320, v0
    s_waitcnt vmcnt(0)
    v_mov_b32 v52, 0
    v_lshlrev_b32 v16, 16, v4
    v_and_b32 v17, 0xffff0000, v4
    v_lshlrev_b32 v18, 16, v5
    v_and_b32 v19, 0xffff0000, v5
    v_lshlrev_b32 v20, 16, v6
    v_and_b32 v21, 0xffff0000, v6
    v_lshlrev_b32 v22, 16, v7
    v_and_b32 v23, 0xffff0000, v7
    v_lshlrev_b32 v24, 16, v8
    v_and_b32 v25, 0xffff0000, v8
    v_lshlrev_b32 v26, 16, v9
    v_and_b32 v27, 0xffff0000, v9
    v_lshlrev_b32 v28, 16, v10
    v_and_b32 v29, 0xffff0000, v10
    v_lshlrev_b32 v30, 16, v11
    v_and_b32 v31, 0xffff0000, v11
    v_add_f32 v32, v16, v17
    v_add_f32 v33, v24, v25
    v_mul_f32 v34, v16, v16
    v_mul_f32 v35, v24, v24
    v_fma_f32 v34, v17, v17, v34
    v_fma_f32 v35, v25, v25, v35
    v_add_f32 v32, v32, v18
    v_add_f32 v33, v33, v26
    v_fma_f32 v34, v18, v18, v34
    v_fma_f32 v35, v26, v26, v35
    v_add_f32 v32, v32, v19
    v_add_f32 v33, v33, v27
    v_fma_f32 v34, v19, v19, v34
    v_fma_f32 v35, v27, v27, v35
    v_add_f32 v32, v32, v20
    v_add_f32 v33, v33, v28
    v_fma_f32 v34, v20, v20, v34
    v_fma_f32 v35, v28, v28, v35
    v_add_f32 v32, v32, v21
    v_add_f32 v33, v33, v29
    v_fma_f32 v34, v21, v21, v34
    v_fma_f32 v35, v29, v29, v35
    v_add_f32 v32, v32, v22
    v_add_f32 v33, v33, v30
    v_fma_f32 v34, v22, v22, v34
    v_fma_f32 v35, v30, v30, v35
    v_add_f32 v32, v32, v23
    v_add_f32 v33, v33, v31
    v_fma_f32 v34, v23, v23, v34
    v_fma_f32 v35, v31, v31, v35
    s_nop 1
    v_add_f32_dpp v32, v32, v32 row_shr:1 row_mask:0xf bank_mask:0xf
    v_add_f32_dpp v33, v33, v33 row_shr:1 row_mask:0xf bank_mask:0xf
    v_add_f32_dpp v34, v34, v34 row_shr:1 row_mask:0xf bank_mask:0xf
    v_add_f32_dpp v35, v35, v35 row_shr:1 row_mask:0xf bank_mask:0xf
    v_add_f32_dpp v32, v32, v32 row_shr:2 row_mask:0xf bank_mask:0xf
    v_add_f32_dpp v33, v33, v33 row_shr:2 row_mask:0xf bank_mask:0xf
    v_add_f32_dpp v34, v34, v34 row_shr:2 row_mask:0xf bank_mask:0xf
    v_add_f32_dpp v35, v35, v35 row_shr:2 row_mask:0xf bank_mask:0xf
    v_add_f32_dpp v32, v32, v32 row_shr:4 row_mask:0xf bank_mask:0xf
    v_add_f32_dpp v33, v33, v33 row_shr:4 row_mask:0xf bank_mask:0xf
    v_add_f32_dpp v34, v34, v34 row_shr:4 row_mask:0xf bank_mask:0xf
    v_add_f32_dpp v35, v35, v35 row_shr:4 row_mask:0xf bank_mask:0xf
    v_add_f32_dpp v32, v32, v32 row_shr:8 row_mask:0xf bank_mask:0xf
    v_add_f32_dpp v33, v33, v33 row_shr:8 row_mask:0xf bank_mask:0xf
    v_add_f32_dpp v34, v34, v34 row_shr:8 row_mask:0xf bank_mask:0xf
    v_add_f32_dpp v35, v35, v35 row_shr:8 row_mask:0xf bank_mask:0xf
    v_add_f32_dpp v32, v32, v32 row_bcast:15 row_mask:0xa bank_mask:0xf
    v_add_f32_dpp v33, v33, v33 row_bcast:15 row_mask:0xa bank_mask:0xf
    v_add_f32_dpp v34, v34, v34 row_bcast:15 row_mask:0xa bank_mask:0xf
    v_add_f32_dpp v35, v35, v35 row_bcast:15 row_mask:0xa bank_mask:0xf
    v_add_f32_dpp v32, v32, v32 row_bcast:31 row_mask:0xc bank_mask:0xf
    v_add_f32_dpp v33, v33, v33 row_bcast:31 row_mask:0xc bank_mask:0xf
    v_add_f32_dpp v34, v34, v34 row_bcast:31 row_mask:0xc bank_mask:0xf
    v_add_f32_dpp v35, v35, v35 row_bcast:31 row_mask:0xc bank_mask:0xf
    v_mul_f32 v32, 0x3b000000, v32
    v_mul_f32 v33, 0x3b000000, v33
    v_mul_f32 v34, 0x3b000000, v34
    v_mul_f32 v35, 0x3b000000, v35
    v_fma_f32 v34, -v32, v32, v34
    v_fma_f32 v35, -v33, v33, v35
    v_max_f32 v34, 0, v34
    v_max_f32 v35, 0, v35
    v_mov_b32 v36, v32
    v_mov_b32 v37, v33
    v_mov_b32 v38, v34
    v_mov_b32 v39, v35
    v_cvt_pk_bf16_f32 v36, v36, v36
    v_cvt_pk_bf16_f32 v37, v37, v37
    v_cvt_pk_bf16_f32 v38, v38, v38
    v_cvt_pk_bf16_f32 v39, v39, v39
    v_lshlrev_b32 v36, 16, v36
    v_lshlrev_b32 v37, 16, v37
    v_lshlrev_b32 v38, 16, v38
    v_lshlrev_b32 v39, 16, v39
    v_add_f32 v38, 0x3727c5ac, v38
    v_add_f32 v39, 0x3727c5ac, v39
    v_cvt_pk_bf16_f32 v38, v38, v38
    v_cvt_pk_bf16_f32 v39, v39, v39
    v_lshlrev_b32 v38, 16, v38
    v_lshlrev_b32 v39, 16, v39
    v_sqrt_f32 v38, v38
    v_sqrt_f32 v39, v39
    s_nop 0
    v_cvt_pk_bf16_f32 v38, v38, v38
    v_cvt_pk_bf16_f32 v39, v39, v39
    v_lshlrev_b32 v38, 16, v38
    v_lshlrev_b32 v39, 16, v39
    v_rcp_f32 v40, v38
    v_rcp_f32 v41, v39
    s_nop 0
    v_sub_f32 v42, v32, v36
    v_sub_f32 v43, v33, v37
    v_mul_f32 v42, v42, v40
    v_mul_f32 v43, v43, v41
    v_mul_f32 v44, v34, v40
    v_mul_f32 v45, v35, v41
    v_mul_f32 v44, v44, v40
    v_mul_f32 v45, v45, v41
    v_cvt_pk_bf16_f32 v42, v42, v42
    v_cvt_pk_bf16_f32 v43, v43, v43
    v_cvt_pk_bf16_f32 v44, v44, v44
    v_cvt_pk_bf16_f32 v45, v45, v45
    v_lshlrev_b32 v42, 16, v42
    v_lshlrev_b32 v43, 16, v43
    v_lshlrev_b32 v44, 16, v44
    v_lshlrev_b32 v45, 16, v45
    v_add_f32 v44, 0x3727c5ac, v44
    v_add_f32 v45, 0x3727c5ac, v45
    v_cvt_pk_bf16_f32 v44, v44, v44
    v_cvt_pk_bf16_f32 v45, v45, v45
    v_lshlrev_b32 v44, 16, v44
    v_lshlrev_b32 v45, 16, v45
    v_sqrt_f32 v44, v44
    v_sqrt_f32 v45, v45
    s_nop 0
    v_cvt_pk_bf16_f32 v44, v44, v44
    v_cvt_pk_bf16_f32 v45, v45, v45
    v_lshlrev_b32 v44, 16, v44
    v_lshlrev_b32 v45, 16, v45
    v_rcp_f32 v44, v44
    v_rcp_f32 v45, v45
    s_nop 0
    v_mul_f32 v46, v36, v40
    v_mul_f32 v47, v37, v41
    v_sub_f32 v46, 0, v46
    v_sub_f32 v47, 0, v47
    v_mul_f32 v48, v40, v44
    v_mul_f32 v49, v41, v45
    v_fma_f32 v50, v42, v38, v36
    v_fma_f32 v51, v43, v39, v37
    v_mul_f32 v50, v50, v48
    v_mul_f32 v51, v51, v49
    v_sub_f32 v50, 0, v50
    v_sub_f32 v51, 0, v51
    s_lshl_b32 s44, s39, 2
    s_add_u32 s44, s44, 0x1600000
    s_mov_b32 exec_lo, 0
    s_mov_b32 exec_hi, 0x80000000
    s_add_u32 s45, s44, 0
    buffer_store_dwordx2 v[46:47], v52, s[12:15], s45 offen sc1
    s_add_u32 s45, s44, 8192
    buffer_store_dwordx2 v[40:41], v52, s[12:15], s45 offen sc1
    s_add_u32 s45, s44, 16384
    buffer_store_dwordx2 v[50:51], v52, s[12:15], s45 offen sc1
    s_add_u32 s45, s44, 24576
    buffer_store_dwordx2 v[48:49], v52, s[12:15], s45 offen sc1
    s_mov_b64 exec, -1
    s_mov_b32 s20, s90
    s_and_b32 s21, s91, 0xffff
    s_mov_b32 s22, 0x100
    s_mov_b32 s23, 0x20000
    s_barrier
    s_waitcnt vmcnt(0)
    s_barrier
    s_cmp_lg_u32 s36, 0
    s_cbranch_scc1 Lls_211
    s_and_b32 s43, s2, 0xf0
    v_mov_b32 v2, 0
    v_mov_b32 v3, 1
    s_mov_b64 exec, 1
    buffer_atomic_add v3, v2, s[20:23], s43 offen sc1
    s_mov_b64 exec, -1
Lls_211:
    s_setprio 2
    s_and_b32 s43, s2, 7
    s_lshr_b32 s44, s2, 3
    s_lshl_b32 s37, s43, 2
    s_and_b32 s45, s44, 3
    s_add_u32 s37, s37, s45
    s_lshr_b32 s38, s44, 2
    s_mov_b32 s16, s24
    s_and_b32 s17, s25, 0xffff
    s_mov_b32 s18, 0x200000
    s_mov_b32 s19, 0x20000
    s_mov_b32 s8, s32
    s_and_b32 s9, s33, 0xffff
    s_mov_b32 s10, 0x80000
    s_mov_b32 s11, 0x20000
    s_lshr_b32 s51, s36, 1
    s_and_b32 s52, s36, 1
    s_mul_i32 s50, s36, 14336
    s_add_u32 s50, s50, 98304
    v_lshlrev_b32 v7, 4, v1
    v_lshrrev_b32 v8, 5, v1
    v_lshlrev_b32 v8, 9, v8
    v_bfe_u32 v4, v1, 2, 2
    v_lshl_add_u32 v8, v4, 6, v8
    v_bfe_u32 v4, v1, 4, 1
    v_lshl_add_u32 v8, v4, 5, v8
    v_and_b32 v4, 3, v1
    v_lshl_add_u32 v8, v4, 3, v8
    v_add_u32 v8, s50, v8
    v_lshrrev_b32 v4, 2, v1
    s_mov_b32 s48, 1024
    v_mul_lo_u32 v9, v4, s48
    v_and_b32 v4, 3, v1
    v_lshl_add_u32 v9, v4, 4, v9
    s_lshl_b32 s42, s36, 14
    s_lshl_b32 s43, s38, 7
    s_add_u32 s42, s42, s43
    s_lshl_b32 s43, s52, 6
    s_xor_b32 s44, s43, 64
    s_add_u32 s47, s42, s44
    s_add_u32 s42, s42, s43
    s_lshl_b32 s43, s37, 1
    s_add_u32 s44, s43, s51
    s_mul_i32 s40, s44, 32768
    s_xor_b32 s44, s44, 1
    s_mul_i32 s41, s44, 32768
    s_lshl_b32 s43, s36, 10
    s_add_u32 s43, s43, 0x600000
    s_add_u32 s40, s40, s43
    s_add_u32 s41, s41, s43
    s_and_b32 s43, s37, 3
    s_lshl_b32 s43, s43, 1
    s_add_u32 s43, s43, s38
    s_and_b32 s60, s43, 7
    s_mov_b32 s61, s60
    s_barrier
    s_barrier
    s_barrier
    s_barrier
    s_barrier
    s_barrier
    s_barrier
    v_and_b32 v6, 31, v1
    v_lshlrev_b32 v6, 10, v6
    v_lshrrev_b32 v4, 5, v1
    v_lshl_add_u32 v6, v4, 3, v6
    s_lshl_b32 s43, s37, 16
    s_lshl_b32 s44, s51, 15
    s_add_u32 s43, s43, s44
    s_lshl_b32 s44, s38, 7
    s_add_u32 s43, s43, s44
    s_lshl_b32 s44, s52, 6
    s_add_u32 s43, s43, s44
    buffer_load_dwordx2 v[148:149], v6, s[16:19], s43 offen offset:0
    buffer_load_dwordx2 v[150:151], v6, s[16:19], s43 offen offset:16
    buffer_load_dwordx2 v[152:153], v6, s[16:19], s43 offen offset:32
    buffer_load_dwordx2 v[154:155], v6, s[16:19], s43 offen offset:48
    s_add_u32 m0, s50, 0
    s_lshl_b32 s48, s61, 16
    s_add_u32 s49, s42, s48
    buffer_load_dwordx4 v9, s[8:11], s49 offen lds
    s_add_u32 m0, s50, 1024
    s_lshl_b32 s48, s61, 16
    s_add_u32 s49, s47, s48
    buffer_load_dwordx4 v9, s[8:11], s49 offen lds
    s_add_u32 s61, s61, 1
    s_and_b32 s61, s61, 7
    s_add_u32 m0, s50, 2048
    s_lshl_b32 s48, s61, 16
    s_add_u32 s49, s42, s48
    buffer_load_dwordx4 v9, s[8:11], s49 offen lds
    s_add_u32 m0, s50, 3072
    s_lshl_b32 s48, s61, 16
    s_add_u32 s49, s47, s48
    buffer_load_dwordx4 v9, s[8:11], s49 offen lds
    s_add_u32 s61, s61, 1
    s_and_b32 s61, s61, 7
    s_add_u32 m0, s50, 4096
    s_lshl_b32 s48, s61, 16
    s_add_u32 s49, s42, s48
    buffer_load_dwordx4 v9, s[8:11], s49 offen lds
    s_add_u32 m0, s50, 5120
    s_lshl_b32 s48, s61, 16
    s_add_u32 s49, s47, s48
    buffer_load_dwordx4 v9, s[8:11], s49 offen lds
    s_add_u32 s61, s61, 1
    s_and_b32 s61, s61, 7
    s_add_u32 m0, s50, 6144
    s_lshl_b32 s48, s61, 16
    s_add_u32 s49, s42, s48
    buffer_load_dwordx4 v9, s[8:11], s49 offen lds
    s_add_u32 m0, s50, 7168
    s_lshl_b32 s48, s61, 16
    s_add_u32 s49, s47, s48
    buffer_load_dwordx4 v9, s[8:11], s49 offen lds
    s_add_u32 s61, s61, 1
    s_and_b32 s61, s61, 7
    s_add_u32 m0, s50, 8192
    s_lshl_b32 s48, s61, 16
    s_add_u32 s49, s42, s48
    buffer_load_dwordx4 v9, s[8:11], s49 offen lds
    s_add_u32 m0, s50, 9216
    s_lshl_b32 s48, s61, 16
    s_add_u32 s49, s47, s48
    buffer_load_dwordx4 v9, s[8:11], s49 offen lds
    s_add_u32 s61, s61, 1
    s_and_b32 s61, s61, 7
    s_add_u32 m0, s50, 10240
    s_lshl_b32 s48, s61, 16
    s_add_u32 s49, s42, s48
    buffer_load_dwordx4 v9, s[8:11], s49 offen lds
    s_add_u32 m0, s50, 11264
    s_lshl_b32 s48, s61, 16
    s_add_u32 s49, s47, s48
    buffer_load_dwordx4 v9, s[8:11], s49 offen lds
    s_add_u32 s61, s61, 1
    s_and_b32 s61, s61, 7
    s_add_u32 m0, s50, 12288
    s_lshl_b32 s48, s61, 16
    s_add_u32 s49, s42, s48
    buffer_load_dwordx4 v9, s[8:11], s49 offen lds
    s_add_u32 m0, s50, 13312
    s_lshl_b32 s48, s61, 16
    s_add_u32 s49, s47, s48
    buffer_load_dwordx4 v9, s[8:11], s49 offen lds
    s_add_u32 s61, s61, 1
    s_and_b32 s61, s61, 7
    s_barrier
    v_mov_b32 v2, 163584
    v_mov_b32 v3, 0x2
    s_mov_b64 exec, 1
    ds_or_b32 v2, v3 offset:12
    s_mov_b64 exec, -1
Lws_212:
    ds_read_b32 v3, v2 offset:0
    s_waitcnt lgkmcnt(0)
    v_readfirstlane_b32 s46, v3
    s_and_b32 s46, s46, 0x2
    s_cmp_eq_u32 s46, 0x2
    s_cbranch_scc1 Lwd_213
    s_sleep 4
    s_add_u32 s92, s92, 1
    s_cmp_gt_u32 s92, 0x400000
    s_cbranch_scc1 k_end
    s_branch Lws_212
Lwd_213:
    v_and_b32 v4, 31, v1
    v_lshlrev_b32 v4, 2, v4
    s_lshl_b32 s43, s37, 8
    s_lshl_b32 s44, s51, 7
    s_add_u32 s43, s43, s44
    s_add_u32 s43, s43, 0x1600000
    buffer_load_dword v156, v4, s[12:15], s43 offen sc1
    s_add_u32 s43, s43, 0x2000
    buffer_load_dword v157, v4, s[12:15], s43 offen sc1
    s_lshl_b32 s49, s60, 12
    s_add_u32 s48, s40, s49
    buffer_load_dwordx4 v[76:79], v7, s[12:15], s48 offen sc1
    s_lshl_b32 s49, s60, 12
    s_add_u32 s48, s41, s49
    buffer_load_dwordx4 v[80:83], v7, s[12:15], s48 offen sc1
    s_add_u32 s60, s60, 1
    s_and_b32 s60, s60, 7
    s_lshl_b32 s49, s60, 12
    s_add_u32 s48, s40, s49
    buffer_load_dwordx4 v[84:87], v7, s[12:15], s48 offen sc1
    s_lshl_b32 s49, s60, 12
    s_add_u32 s48, s41, s49
    buffer_load_dwordx4 v[88:91], v7, s[12:15], s48 offen sc1
    s_add_u32 s60, s60, 1
    s_and_b32 s60, s60, 7
    s_lshl_b32 s49, s60, 12
    s_add_u32 s48, s40, s49
    buffer_load_dwordx4 v[92:95], v7, s[12:15], s48 offen sc1
    s_lshl_b32 s49, s60, 12
    s_add_u32 s48, s41, s49
    buffer_load_dwordx4 v[96:99], v7, s[12:15], s48 offen sc1
    s_add_u32 s60, s60, 1
    s_and_b32 s60, s60, 7
    s_lshl_b32 s49, s60, 12
    s_add_u32 s48, s40, s49
    buffer_load_dwordx4 v[100:103], v7, s[12:15], s48 offen sc1
    s_lshl_b32 s49, s60, 12
    s_add_u32 s48, s41, s49
    buffer_load_dwordx4 v[104:107], v7, s[12:15], s48 offen sc1
    s_add_u32 s60, s60, 1
    s_and_b32 s60, s60, 7
    s_lshl_b32 s49, s60, 12
    s_add_u32 s48, s40, s49
    buffer_load_dwordx4 v[108:111], v7, s[12:15], s48 offen sc1
    s_lshl_b32 s49, s60, 12
    s_add_u32 s48, s41, s49
    buffer_load_dwordx4 v[112:115], v7, s[12:15], s48 offen sc1
    s_add_u32 s60, s60, 1
    s_and_b32 s60, s60, 7
    s_lshl_b32 s49, s60, 12
    s_add_u32 s48, s40, s49
    buffer_load_dwordx4 v[116:119], v7, s[12:15], s48 offen sc1
    s_lshl_b32 s49, s60, 12
    s_add_u32 s48, s41, s49
    buffer_load_dwordx4 v[120:123], v7, s[12:15], s48 offen sc1
    s_add_u32 s60, s60, 1
    s_and_b32 s60, s60, 7
    s_lshl_b32 s49, s60, 12
    s_add_u32 s48, s40, s49
    buffer_load_dwordx4 v[124:127], v7, s[12:15], s48 offen sc1
    s_lshl_b32 s49, s60, 12
    s_add_u32 s48, s41, s49
    buffer_load_dwordx4 v[128:131], v7, s[12:15], s48 offen sc1
    s_add_u32 s60, s60, 1
    s_and_b32 s60, s60, 7
    s_waitcnt vmcnt(14)
    v_lshlrev_b32 v12, 16, v148
    v_and_b32 v13, 0xffff0000, v148
    v_lshlrev_b32 v14, 16, v149
    v_and_b32 v15, 0xffff0000, v149
    v_lshlrev_b32 v16, 16, v150
    v_and_b32 v17, 0xffff0000, v150
    v_lshlrev_b32 v18, 16, v151
    v_and_b32 v19, 0xffff0000, v151
    v_lshlrev_b32 v20, 16, v152
    v_and_b32 v21, 0xffff0000, v152
    v_lshlrev_b32 v22, 16, v153
    v_and_b32 v23, 0xffff0000, v153
    v_lshlrev_b32 v24, 16, v154
    v_and_b32 v25, 0xffff0000, v154
    v_lshlrev_b32 v26, 16, v155
    v_and_b32 v27, 0xffff0000, v155
    v_fma_f32 v12, v12, v157, v156
    v_fma_f32 v13, v13, v157, v156
    v_fma_f32 v14, v14, v157, v156
    v_fma_f32 v15, v15, v157, v156
    v_fma_f32 v16, v16, v157, v156
    v_fma_f32 v17, v17, v157, v156
    v_fma_f32 v18, v18, v157, v156
    v_fma_f32 v19, v19, v157, v156
    v_fma_f32 v20, v20, v157, v156
    v_fma_f32 v21, v21, v157, v156
    v_fma_f32 v22, v22, v157, v156
    v_fma_f32 v23, v23, v157, v156
    v_fma_f32 v24, v24, v157, v156
    v_fma_f32 v25, v25, v157, v156
    v_fma_f32 v26, v26, v157, v156
    v_fma_f32 v27, v27, v157, v156
    s_waitcnt vmcnt(28)
    ds_read_b64_tr_b16 v[132:133], v8 offset:0
    ds_read_b64_tr_b16 v[134:135], v8 offset:256
    ds_read_b64_tr_b16 v[136:137], v8 offset:1024
    ds_read_b64_tr_b16 v[138:139], v8 offset:1280
    s_waitcnt vmcnt(26)
    ds_read_b64_tr_b16 v[140:141], v8 offset:2048
    ds_read_b64_tr_b16 v[142:143], v8 offset:2304
    ds_read_b64_tr_b16 v[144:145], v8 offset:3072
    ds_read_b64_tr_b16 v[146:147], v8 offset:3328
    s_waitcnt vmcnt(12) lgkmcnt(4)
    v_mfma_f32_32x32x16_bf16 v[12:27], v[132:135], v[76:79], v[12:27]
    s_add_u32 m0, s50, 0
    s_lshl_b32 s48, s61, 16
    s_add_u32 s49, s42, s48
    buffer_load_dwordx4 v9, s[8:11], s49 offen lds
    v_mfma_f32_32x32x16_bf16 v[28:43], v[136:139], v[76:79], 0
    s_add_u32 m0, s50, 1024
    s_lshl_b32 s48, s61, 16
    s_add_u32 s49, s47, s48
    buffer_load_dwordx4 v9, s[8:11], s49 offen lds
    s_add_u32 s61, s61, 1
    s_and_b32 s61, s61, 7
    v_mfma_f32_32x32x16_bf16 v[44:59], v[132:135], v[80:83], 0
    s_lshl_b32 s49, s60, 12
    s_add_u32 s48, s40, s49
    buffer_load_dwordx4 v[76:79], v7, s[12:15], s48 offen sc1
    v_mfma_f32_32x32x16_bf16 v[60:75], v[136:139], v[80:83], 0
    s_lshl_b32 s49, s60, 12
    s_add_u32 s48, s41, s49
    buffer_load_dwordx4 v[80:83], v7, s[12:15], s48 offen sc1
    s_add_u32 s60, s60, 1
    s_and_b32 s60, s60, 7
    s_waitcnt vmcnt(28)
    ds_read_b64_tr_b16 v[132:133], v8 offset:4096
    ds_read_b64_tr_b16 v[134:135], v8 offset:4352
    ds_read_b64_tr_b16 v[136:137], v8 offset:5120
    ds_read_b64_tr_b16 v[138:139], v8 offset:5376
    s_waitcnt vmcnt(14) lgkmcnt(4)
    v_mfma_f32_32x32x16_bf16 v[12:27], v[140:143], v[84:87], v[12:27]
    v_mfma_f32_32x32x16_bf16 v[28:43], v[144:147], v[84:87], v[28:43]
    v_mfma_f32_32x32x16_bf16 v[44:59], v[140:143], v[88:91], v[44:59]
    v_mfma_f32_32x32x16_bf16 v[60:75], v[144:147], v[88:91], v[60:75]
    s_waitcnt vmcnt(26)
    ds_read_b64_tr_b16 v[140:141], v8 offset:6144
    ds_read_b64_tr_b16 v[142:143], v8 offset:6400
    ds_read_b64_tr_b16 v[144:145], v8 offset:7168
    ds_read_b64_tr_b16 v[146:147], v8 offset:7424
    s_waitcnt vmcnt(12) lgkmcnt(4)
    v_mfma_f32_32x32x16_bf16 v[12:27], v[132:135], v[92:95], v[12:27]
    v_mfma_f32_32x32x16_bf16 v[28:43], v[136:139], v[92:95], v[28:43]
    v_mfma_f32_32x32x16_bf16 v[44:59], v[132:135], v[96:99], v[44:59]
    v_mfma_f32_32x32x16_bf16 v[60:75], v[136:139], v[96:99], v[60:75]
    s_waitcnt vmcnt(24)
    ds_read_b64_tr_b16 v[132:133], v8 offset:8192
    ds_read_b64_tr_b16 v[134:135], v8 offset:8448
    ds_read_b64_tr_b16 v[136:137], v8 offset:9216
    ds_read_b64_tr_b16 v[138:139], v8 offset:9472
    s_waitcnt vmcnt(10) lgkmcnt(4)
    v_mfma_f32_32x32x16_bf16 v[12:27], v[140:143], v[100:103], v[12:27]
    v_mfma_f32_32x32x16_bf16 v[28:43], v[144:147], v[100:103], v[28:43]
    v_mfma_f32_32x32x16_bf16 v[44:59], v[140:143], v[104:107], v[44:59]
    v_mfma_f32_32x32x16_bf16 v[60:75], v[144:147], v[104:107], v[60:75]
    s_waitcnt vmcnt(22)
    ds_read_b64_tr_b16 v[140:141], v8 offset:10240
    ds_read_b64_tr_b16 v[142:143], v8 offset:10496
    ds_read_b64_tr_b16 v[144:145], v8 offset:11264
    ds_read_b64_tr_b16 v[146:147], v8 offset:11520
    s_waitcnt vmcnt(8) lgkmcnt(4)
    v_mfma_f32_32x32x16_bf16 v[12:27], v[132:135], v[108:111], v[12:27]
    v_mfma_f32_32x32x16_bf16 v[28:43], v[136:139], v[108:111], v[28:43]
    v_mfma_f32_32x32x16_bf16 v[44:59], v[132:135], v[112:115], v[44:59]
    v_mfma_f32_32x32x16_bf16 v[60:75], v[136:139], v[112:115], v[60:75]
    s_waitcnt vmcnt(20)
    ds_read_b64_tr_b16 v[132:133], v8 offset:12288
    ds_read_b64_tr_b16 v[134:135], v8 offset:12544
    ds_read_b64_tr_b16 v[136:137], v8 offset:13312
    ds_read_b64_tr_b16 v[138:139], v8 offset:13568
    s_waitcnt vmcnt(6) lgkmcnt(4)
    v_mfma_f32_32x32x16_bf16 v[12:27], v[140:143], v[116:119], v[12:27]
    v_mfma_f32_32x32x16_bf16 v[28:43], v[144:147], v[116:119], v[28:43]
    v_mfma_f32_32x32x16_bf16 v[44:59], v[140:143], v[120:123], v[44:59]
    v_mfma_f32_32x32x16_bf16 v[60:75], v[144:147], v[120:123], v[60:75]
    s_waitcnt vmcnt(2)
    ds_read_b64_tr_b16 v[140:141], v8 offset:0
    ds_read_b64_tr_b16 v[142:143], v8 offset:256
    ds_read_b64_tr_b16 v[144:145], v8 offset:1024
    ds_read_b64_tr_b16 v[146:147], v8 offset:1280
    s_waitcnt vmcnt(4) lgkmcnt(4)
    v_mfma_f32_32x32x16_bf16 v[12:27], v[132:135], v[124:127], v[12:27]
    v_mfma_f32_32x32x16_bf16 v[28:43], v[136:139], v[124:127], v[28:43]
    v_mfma_f32_32x32x16_bf16 v[44:59], v[132:135], v[128:131], v[44:59]
    v_mfma_f32_32x32x16_bf16 v[60:75], v[136:139], v[128:131], v[60:75]
    s_waitcnt vmcnt(0) lgkmcnt(0)
    v_mfma_f32_32x32x16_bf16 v[12:27], v[140:143], v[76:79], v[12:27]
    v_mfma_f32_32x32x16_bf16 v[28:43], v[144:147], v[76:79], v[28:43]
    v_mfma_f32_32x32x16_bf16 v[44:59], v[140:143], v[80:83], v[44:59]
    v_mfma_f32_32x32x16_bf16 v[60:75], v[144:147], v[80:83], v[60:75]
    v_add_u32 v4, s50, v7
    s_nop 10
    ds_write_b128 v4, v[28:31] offset:0
    ds_write_b128 v4, v[32:35] offset:1024
    ds_write_b128 v4, v[36:39] offset:2048
    ds_write_b128 v4, v[40:43] offset:3072
    ds_write_b128 v4, v[44:47] offset:4096
    ds_write_b128 v4, v[48:51] offset:5120
    ds_write_b128 v4, v[52:55] offset:6144
    ds_write_b128 v4, v[56:59] offset:7168
    ds_write_b128 v4, v[60:63] offset:8192
    ds_write_b128 v4, v[64:67] offset:9216
    ds_write_b128 v4, v[68:71] offset:10240
    ds_write_b128 v4, v[72:75] offset:11264
    s_waitcnt lgkmcnt(0)
    v_mov_b32 v2, 163648
    v_mov_b32 v3, 1
    s_waitcnt lgkmcnt(0)
    s_mov_b64 exec, 1
    ds_add_u32 v2, v3 offset:0
Lsb_214:
    ds_read_b32 v3, v2 offset:0
    s_waitcnt lgkmcnt(0)
    v_readfirstlane_b32 s46, v3
    s_cmp_ge_u32 s46, 4
    s_cbranch_scc1 Lsbd_215
    s_sleep 1
    s_add_u32 s92, s92, 1
    s_cmp_gt_u32 s92, 0x400000
    s_cbranch_scc1 k_end
    s_branch Lsb_214
Lsbd_215:
    s_mov_b64 exec, -1
    s_xor_b32 s48, s36, 1
    s_mul_i32 s48, s48, 14336
    s_add_u32 s48, s48, 98304
    v_add_u32 v5, s48, v7
    ds_read_b128 v[28:31], v5 offset:0
    ds_read_b128 v[32:35], v5 offset:1024
    ds_read_b128 v[36:39], v5 offset:2048
    ds_read_b128 v[40:43], v5 offset:3072
    s_xor_b32 s48, s36, 2
    s_mul_i32 s48, s48, 14336
    s_add_u32 s48, s48, 98304
    v_add_u32 v5, s48, v7
    ds_read_b128 v[44:47], v5 offset:4096
    ds_read_b128 v[48:51], v5 offset:5120
    ds_read_b128 v[52:55], v5 offset:6144
    ds_read_b128 v[56:59], v5 offset:7168
    s_xor_b32 s48, s36, 3
    s_mul_i32 s48, s48, 14336
    s_add_u32 s48, s48, 98304
    v_add_u32 v5, s48, v7
    ds_read_b128 v[60:63], v5 offset:8192
    ds_read_b128 v[64:67], v5 offset:9216
    ds_read_b128 v[68:71], v5 offset:10240
    ds_read_b128 v[72:75], v5 offset:11264
    s_waitcnt lgkmcnt(8)
    v_add_f32 v12, v12, v28
    v_add_f32 v13, v13, v29
    v_add_f32 v14, v14, v30
    v_add_f32 v15, v15, v31
    v_add_f32 v16, v16, v32
    v_add_f32 v17, v17, v33
    v_add_f32 v18, v18, v34
    v_add_f32 v19, v19, v35
    v_add_f32 v20, v20, v36
    v_add_f32 v21, v21, v37
    v_add_f32 v22, v22, v38
    v_add_f32 v23, v23, v39
    v_add_f32 v24, v24, v40
    v_add_f32 v25, v25, v41
    v_add_f32 v26, v26, v42
    v_add_f32 v27, v27, v43
    s_waitcnt lgkmcnt(4)
    v_add_f32 v12, v12, v44
    v_add_f32 v13, v13, v45
    v_add_f32 v14, v14, v46
    v_add_f32 v15, v15, v47
    v_add_f32 v16, v16, v48
    v_add_f32 v17, v17, v49
    v_add_f32 v18, v18, v50
    v_add_f32 v19, v19, v51
    v_add_f32 v20, v20, v52
    v_add_f32 v21, v21, v53
    v_add_f32 v22, v22, v54
    v_add_f32 v23, v23, v55
    v_add_f32 v24, v24, v56
    v_add_f32 v25, v25, v57
    v_add_f32 v26, v26, v58
    v_add_f32 v27, v27, v59
    s_waitcnt lgkmcnt(0)
    v_add_f32 v12, v12, v60
    v_add_f32 v13, v13, v61
    v_add_f32 v14, v14, v62
    v_add_f32 v15, v15, v63
    v_add_f32 v16, v16, v64
    v_add_f32 v17, v17, v65
    v_add_f32 v18, v18, v66
    v_add_f32 v19, v19, v67
    v_add_f32 v20, v20, v68
    v_add_f32 v21, v21, v69
    v_add_f32 v22, v22, v70
    v_add_f32 v23, v23, v71
    v_add_f32 v24, v24, v72
    v_add_f32 v25, v25, v73
    v_add_f32 v26, v26, v74
    v_add_f32 v27, v27, v75
    s_lshl_b32 s43, s37, 1
    s_add_u32 s43, s43, s51
    s_mul_i32 s43, s43, 32
    s_lshl_b32 s46, s38, 2
    s_add_u32 s43, s43, s46
    s_lshl_b32 s46, s52, 1
    s_add_u32 s43, s43, s46
    s_lshl_b32 s43, s43, 10
    s_add_u32 s43, s43, 0x800000
    v_cvt_pk_bf16_f32 v44, v12, v13
    v_cvt_pk_bf16_f32 v45, v14, v15
    v_cvt_pk_bf16_f32 v46, v16, v17
    v_cvt_pk_bf16_f32 v47, v18, v19
    v_cvt_pk_bf16_f32 v48, v20, v21
    v_cvt_pk_bf16_f32 v49, v22, v23
    v_cvt_pk_bf16_f32 v50, v24, v25
    v_cvt_pk_bf16_f32 v51, v26, v27
    s_nop 1
    v_permlane32_swap_b32 v44, v46
    v_permlane32_swap_b32 v45, v47
    v_permlane32_swap_b32 v48, v50
    v_permlane32_swap_b32 v49, v51
    s_nop 1
    buffer_store_dwordx4 v[44:47], v7, s[12:15], s43 offen offset:0 sc1
    buffer_store_dwordx4 v[48:51], v7, s[12:15], s43 offen offset:1024 sc1
    v_lshlrev_b32 v28, 16, v44
    v_and_b32 v29, 0xffff0000, v44
    v_lshlrev_b32 v30, 16, v45
    v_and_b32 v31, 0xffff0000, v45
    v_lshlrev_b32 v32, 16, v46
    v_and_b32 v33, 0xffff0000, v46
    v_lshlrev_b32 v34, 16, v47
    v_and_b32 v35, 0xffff0000, v47
    v_lshlrev_b32 v36, 16, v48
    v_and_b32 v37, 0xffff0000, v48
    v_lshlrev_b32 v38, 16, v49
    v_and_b32 v39, 0xffff0000, v49
    v_lshlrev_b32 v40, 16, v50
    v_and_b32 v41, 0xffff0000, v50
    v_lshlrev_b32 v42, 16, v51
    v_and_b32 v43, 0xffff0000, v51
    v_add_f32 v60, v28, v29
    v_mul_f32 v61, v28, v28
    v_fma_f32 v61, v29, v29, v61
    v_add_f32 v60, v60, v30
    v_fma_f32 v61, v30, v30, v61
    v_add_f32 v60, v60, v31
    v_fma_f32 v61, v31, v31, v61
    v_add_f32 v60, v60, v32
    v_fma_f32 v61, v32, v32, v61
    v_add_f32 v60, v60, v33
    v_fma_f32 v61, v33, v33, v61
    v_add_f32 v60, v60, v34
    v_fma_f32 v61, v34, v34, v61
    v_add_f32 v60, v60, v35
    v_fma_f32 v61, v35, v35, v61
    v_add_f32 v60, v60, v36
    v_fma_f32 v61, v36, v36, v61
    v_add_f32 v60, v60, v37
    v_fma_f32 v61, v37, v37, v61
    v_add_f32 v60, v60, v38
    v_fma_f32 v61, v38, v38, v61
    v_add_f32 v60, v60, v39
    v_fma_f32 v61, v39, v39, v61
    v_add_f32 v60, v60, v40
    v_fma_f32 v61, v40, v40, v61
    v_add_f32 v60, v60, v41
    v_fma_f32 v61, v41, v41, v61
    v_add_f32 v60, v60, v42
    v_fma_f32 v61, v42, v42, v61
    v_add_f32 v60, v60, v43
    v_fma_f32 v61, v43, v43, v61
    v_mov_b32 v62, v60
    v_mov_b32 v63, v61
    s_nop 1
    v_permlane32_swap_b32 v60, v62
    v_permlane32_swap_b32 v61, v63
    s_nop 1
    v_add_f32 v64, v60, v62
    v_add_f32 v65, v61, v63
    s_lshl_b32 s43, s38, 1
    s_add_u32 s43, s43, s52
    s_lshl_b32 s43, s43, 14
    s_lshl_b32 s44, s37, 9
    s_add_u32 s43, s43, s44
    s_lshl_b32 s44, s51, 8
    s_add_u32 s43, s43, s44
    s_add_u32 s43, s43, 0x1610000
    v_lshlrev_b32 v4, 3, v1
    s_mov_b32 exec_hi, 0
    buffer_store_dwordx2 v[64:65], v4, s[12:15], s43 offen sc1
    s_mov_b64 exec, -1
    s_waitcnt vmcnt(0)
    v_mov_b32 v2, 163648
    v_mov_b32 v3, 1
    s_waitcnt lgkmcnt(0)
    s_mov_b64 exec, 1
    ds_add_u32 v2, v3 offset:4
Lsb_217:
    ds_read_b32 v3, v2 offset:4
    s_waitcnt lgkmcnt(0)
    v_readfirstlane_b32 s46, v3
    s_cmp_ge_u32 s46, 4
    s_cbranch_scc1 Lsbd_218
    s_sleep 1
    s_add_u32 s92, s92, 1
    s_cmp_gt_u32 s92, 0x400000
    s_cbranch_scc1 k_end
    s_branch Lsb_217
Lsbd_218:
    s_mov_b64 exec, -1
    s_cmp_lg_u32 s36, 0
    s_cbranch_scc1 Lsig_216
    s_lshr_b32 s43, s37, 1
    s_and_b32 s44, s43, 1
    s_lshl_b32 s44, s44, 3
    s_lshr_b32 s43, s43, 1
    s_or_b32 s43, s43, s44
    v_lshlrev_b32 v2, 4, v1
    v_or_b32 v2, s43, v2
    v_lshlrev_b32 v2, 7, v2
    v_mov_b32 v3, 1
    s_mov_b32 s43, 0x1680008
    s_mov_b32 exec_lo, 0x7fff
    s_mov_b32 exec_hi, 0x0
    buffer_atomic_add v3, v2, s[12:15], s43 offen sc1
    s_mov_b64 exec, -1
Lsig_216:
    s_and_b32 s43, s2, 7
    s_lshr_b32 s44, s2, 3
    s_lshl_b32 s37, s43, 1
    s_and_b32 s45, s44, 1
    s_add_u32 s37, s37, s45
    s_lshr_b32 s38, s44, 1
    s_cmp_ge_u32 s38, 15
    s_cbranch_scc1 k_g4
    s_mov_b32 s8, s84
    s_and_b32 s9, s85, 0xffff
    s_mov_b32 s10, 0x158000
    s_mov_b32 s11, 0x20000
    v_lshlrev_b32 v7, 4, v1
    v_lshrrev_b32 v8, 5, v1
    v_lshlrev_b32 v8, 9, v8
    v_bfe_u32 v4, v1, 2, 2
    v_lshl_add_u32 v8, v4, 6, v8
    v_bfe_u32 v4, v1, 4, 1
    v_lshl_add_u32 v8, v4, 5, v8
    v_and_b32 v4, 3, v1
    v_lshl_add_u32 v8, v4, 3, v8
    v_add_u32 v8, 81920, v8
    v_add_u32 v10, 49152, v8
    v_lshrrev_b32 v4, 2, v1
    s_mov_b32 s48, 2752
    v_mul_lo_u32 v9, v4, s48
    v_and_b32 v4, 3, v1
    v_lshl_add_u32 v9, v4, 4, v9
    v_mov_b32 v164, 0x3f803f80
    v_mov_b32 v165, 0x3f803f80
    v_mov_b32 v166, 0x3f803f80
    v_mov_b32 v167, 0x3f803f80
    s_mul_i32 s42, s36, 44032
    s_mul_i32 s43, s38, 192
    s_add_u32 s42, s42, s43
    s_mul_i32 s50, s36, 3072
    s_add_u32 s50, s50, 81920
    s_and_b32 s43, s37, 1
    s_lshl_b32 s43, s43, 1
    s_add_u32 s60, s43, s38
    v_mov_b32 v2, 163584
    v_mov_b32 v3, 0x4
    s_mov_b64 exec, 1
    ds_or_b32 v2, v3 offset:12
    s_mov_b64 exec, -1
    s_add_u32 s61, s60, 0
    s_and_b32 s61, s61, 3
    s_mul_i32 s61, s61, 352256
    s_add_u32 s61, s61, s42
    s_add_u32 m0, s50, 0
    s_add_u32 s49, s61, 0
    buffer_load_dwordx4 v9, s[8:11], s49 offen lds
    s_add_u32 m0, s50, 1024
    s_add_u32 s49, s61, 64
    buffer_load_dwordx4 v9, s[8:11], s49 offen lds
    s_add_u32 m0, s50, 2048
    s_add_u32 s49, s61, 128
    buffer_load_dwordx4 v9, s[8:11], s49 offen lds
    s_add_u32 m0, s50, 12288
    s_add_u32 s49, s61, 176128
    buffer_load_dwordx4 v9, s[8:11], s49 offen lds
    s_add_u32 m0, s50, 13312
    s_add_u32 s49, s61, 176192
    buffer_load_dwordx4 v9, s[8:11], s49 offen lds
    s_add_u32 m0, s50, 14336
    s_add_u32 s49, s61, 176256
    buffer_load_dwordx4 v9, s[8:11], s49 offen lds
    s_add_u32 s61, s60, 1
    s_and_b32 s61, s61, 3
    s_mul_i32 s61, s61, 352256
    s_add_u32 s61, s61, s42
    s_add_u32 m0, s50, 24576
    s_add_u32 s49, s61, 0
    buffer_load_dwordx4 v9, s[8:11], s49 offen lds
    s_add_u32 m0, s50, 25600
    s_add_u32 s49, s61, 64
    buffer_load_dwordx4 v9, s[8:11], s49 offen lds
    s_add_u32 m0, s50, 26624
    s_add_u32 s49, s61, 128
    buffer_load_dwordx4 v9, s[8:11], s49 offen lds
    s_add_u32 m0, s50, 36864
    s_add_u32 s49, s61, 176128
    buffer_load_dwordx4 v9, s[8:11], s49 offen lds
    s_add_u32 m0, s50, 37888
    s_add_u32 s49, s61, 176192
    buffer_load_dwordx4 v9, s[8:11], s49 offen lds
    s_add_u32 m0, s50, 38912
    s_add_u32 s49, s61, 176256
    buffer_load_dwordx4 v9, s[8:11], s49 offen lds
    s_add_u32 s61, s60, 2
    s_and_b32 s61, s61, 3
    s_mul_i32 s61, s61, 352256
    s_add_u32 s61, s61, s42
    s_add_u32 m0, s50, 49152
    s_add_u32 s49, s61, 0
    buffer_load_dwordx4 v9, s[8:11], s49 offen lds
    s_add_u32 m0, s50, 50176
    s_add_u32 s49, s61, 64
    buffer_load_dwordx4 v9, s[8:11], s49 offen lds
    s_add_u32 m0, s50, 51200
    s_add_u32 s49, s61, 128
    buffer_load_dwordx4 v9, s[8:11], s49 offen lds
    s_add_u32 m0, s50, 61440
    s_add_u32 s49, s61, 176128
    buffer_load_dwordx4 v9, s[8:11], s49 offen lds
    s_add_u32 m0, s50, 62464
    s_add_u32 s49, s61, 176192
    buffer_load_dwordx4 v9, s[8:11], s49 offen lds
    s_add_u32 m0, s50, 63488
    s_add_u32 s49, s61, 176256
    buffer_load_dwordx4 v9, s[8:11], s49 offen lds
    s_lshl_b32 s40, s37, 2
    s_add_u32 s40, s40, s36
    s_lshl_b32 s40, s40, 15
    s_add_u32 s40, s40, 0x800000
    v_mov_b32 v2, 163584
    v_mov_b32 v3, 0x4
    s_mov_b64 exec, 1
    ds_or_b32 v2, v3 offset:12
    s_mov_b64 exec, -1
Lws_219:
    ds_read_b32 v3, v2 offset:0
    s_waitcnt lgkmcnt(0)
    v_readfirstlane_b32 s46, v3
    s_and_b32 s46, s46, 0x4
    s_cmp_eq_u32 s46, 0x4
    s_cbranch_scc1 Lwd_220
    s_sleep 4
    s_add_u32 s92, s92, 1
    s_cmp_gt_u32 s92, 0x400000
    s_cbranch_scc1 k_end
    s_branch Lws_219
Lwd_220:
    s_add_u32 s62, s60, 0
    s_and_b32 s62, s62, 3
    s_lshl_b32 s62, s62, 13
    s_add_u32 s62, s62, s40
    s_add_u32 s48, s62, 0
    buffer_load_dwordx4 v[60:63], v7, s[12:15], s48 offen sc1
    s_add_u32 s48, s62, 1024
    buffer_load_dwordx4 v[64:67], v7, s[12:15], s48 offen sc1
    s_add_u32 s48, s62, 2048
    buffer_load_dwordx4 v[68:71], v7, s[12:15], s48 offen sc1
    s_add_u32 s48, s62, 3072
    buffer_load_dwordx4 v[72:75], v7, s[12:15], s48 offen sc1
    s_add_u32 s48, s62, 4096
    buffer_load_dwordx4 v[76:79], v7, s[12:15], s48 offen sc1
    s_add_u32 s48, s62, 5120
    buffer_load_dwordx4 v[80:83], v7, s[12:15], s48 offen sc1
    s_add_u32 s48, s62, 6144
    buffer_load_dwordx4 v[84:87], v7, s[12:15], s48 offen sc1
    v_and_b32 v4, 31, v1
    v_lshlrev_b32 v4, 3, v4
    v_lshrrev_b32 v6, 5, v1
    v_lshl_add_u32 v4, v6, 17, v4
    s_lshl_b32 s43, s37, 10
    s_lshl_b32 s44, s36, 8
    s_add_u32 s43, s43, s44
    s_add_u32 s43, s43, 0x1610000
    buffer_load_dwordx2 v[124:125], v4, s[12:15], s43 offen sc1
    s_add_u32 s43, s43, 16384
    buffer_load_dwordx2 v[126:127], v4, s[12:15], s43 offen sc1
    s_add_u32 s43, s43, 16384
    buffer_load_dwordx2 v[128:129], v4, s[12:15], s43 offen sc1
    s_add_u32 s43, s43, 16384
    buffer_load_dwordx2 v[130:131], v4, s[12:15], s43 offen sc1
    s_add_u32 s43, s43, 16384
    buffer_load_dwordx2 v[132:133], v4, s[12:15], s43 offen sc1
    s_add_u32 s43, s43, 16384
    buffer_load_dwordx2 v[134:135], v4, s[12:15], s43 offen sc1
    s_add_u32 s43, s43, 16384
    buffer_load_dwordx2 v[136:137], v4, s[12:15], s43 offen sc1
    s_add_u32 s43, s43, 16384
    buffer_load_dwordx2 v[138:139], v4, s[12:15], s43 offen sc1
    s_add_u32 s43, s43, 16384
    s_waitcnt vmcnt(15)
    v_mov_b32 v2, 163648
    v_mov_b32 v3, 1
    s_waitcnt lgkmcnt(0)
    s_mov_b64 exec, 1
    ds_add_u32 v2, v3 offset:8
Lsb_221:
    ds_read_b32 v3, v2 offset:8
    s_waitcnt lgkmcnt(0)
    v_readfirstlane_b32 s46, v3
    s_cmp_ge_u32 s46, 4
    s_cbranch_scc1 Lsbd_222
    s_sleep 1
    s_add_u32 s92, s92, 1
    s_cmp_gt_u32 s92, 0x400000
    s_cbranch_scc1 k_end
    s_branch Lsb_221
Lsbd_222:
    s_mov_b64 exec, -1
    ds_read_b64_tr_b16 v[88:89], v8 offset:0
    ds_read_b64_tr_b16 v[90:91], v8 offset:256
    ds_read_b64_tr_b16 v[92:93], v8 offset:1024
    ds_read_b64_tr_b16 v[94:95], v8 offset:1280
    ds_read_b64_tr_b16 v[96:97], v8 offset:2048
    ds_read_b64_tr_b16 v[98:99], v8 offset:2304
    ds_read_b64_tr_b16 v[100:101], v8 offset:3072
    ds_read_b64_tr_b16 v[102:103], v8 offset:3328
    ds_read_b64_tr_b16 v[104:105], v8 offset:4096
    ds_read_b64_tr_b16 v[106:107], v8 offset:4352
    ds_read_b64_tr_b16 v[108:109], v8 offset:5120
    ds_read_b64_tr_b16 v[110:111], v8 offset:5376
    s_waitcnt vmcnt(14) lgkmcnt(6)
    v_mfma_f32_32x32x16_bf16 v[12:27], v[88:91], v[60:63], 0
    ds_read_b64_tr_b16 v[112:113], v8 offset:6144
    ds_read_b64_tr_b16 v[114:115], v8 offset:6400
    v_mfma_f32_32x32x16_bf16 v[28:43], v[92:95], v[60:63], 0
    ds_read_b64_tr_b16 v[116:117], v8 offset:7168
    ds_read_b64_tr_b16 v[118:119], v8 offset:7424
    v_mfma_f32_32x32x16_bf16 v[44:59], v[96:99], v[60:63], 0
    ds_read_b64_tr_b16 v[120:121], v8 offset:8192
    ds_read_b64_tr_b16 v[122:123], v8 offset:8448
    s_cmp_lg_u32 s36, 0
    s_cbranch_scc1 Lcn_224
    v_mfma_f32_32x32x16_bf16 v[140:155], v[164:167], v[88:91], 0
    s_branch Lcs_223
Lcn_224:
    s_cmp_lg_u32 s36, 1
    s_cbranch_scc1 Lcn_225
    v_mfma_f32_32x32x16_bf16 v[140:155], v[164:167], v[92:95], 0
    s_branch Lcs_223
Lcn_225:
    s_cmp_lg_u32 s36, 2
    s_cbranch_scc1 Lcn_226
    v_mfma_f32_32x32x16_bf16 v[140:155], v[164:167], v[96:99], 0
Lcn_226:
Lcs_223:
    s_add_u32 s48, s62, 7168
    buffer_load_dwordx4 v[60:63], v7, s[12:15], s48 offen sc1
    s_waitcnt vmcnt(14) lgkmcnt(6)
    v_mfma_f32_32x32x16_bf16 v[12:27], v[100:103], v[64:67], v[12:27]
    ds_read_b64_tr_b16 v[88:89], v8 offset:9216
    ds_read_b64_tr_b16 v[90:91], v8 offset:9472
    v_mfma_f32_32x32x16_bf16 v[28:43], v[104:107], v[64:67], v[28:43]
    ds_read_b64_tr_b16 v[92:93], v8 offset:10240
    ds_read_b64_tr_b16 v[94:95], v8 offset:10496
    v_mfma_f32_32x32x16_bf16 v[44:59], v[108:111], v[64:67], v[44:59]
    ds_read_b64_tr_b16 v[96:97], v8 offset:11264
    ds_read_b64_tr_b16 v[98:99], v8 offset:11520
    s_cmp_lg_u32 s36, 0
    s_cbranch_scc1 Lcn_228
    v_mfma_f32_32x32x16_bf16 v[140:155], v[164:167], v[100:103], v[140:155]
    s_branch Lcs_227
Lcn_228:
    s_cmp_lg_u32 s36, 1
    s_cbranch_scc1 Lcn_229
    v_mfma_f32_32x32x16_bf16 v[140:155], v[164:167], v[104:107], v[140:155]
    s_branch Lcs_227
Lcn_229:
    s_cmp_lg_u32 s36, 2
    s_cbranch_scc1 Lcn_230
    v_mfma_f32_32x32x16_bf16 v[140:155], v[164:167], v[108:111], v[140:155]
Lcn_230:
Lcs_227:
    s_add_u32 s62, s60, 1
    s_and_b32 s62, s62, 3
    s_lshl_b32 s62, s62, 13
    s_add_u32 s62, s62, s40
    s_add_u32 s48, s62, 0
    buffer_load_dwordx4 v[64:67], v7, s[12:15], s48 offen sc1
    s_waitcnt vmcnt(14) lgkmcnt(6)
    v_mfma_f32_32x32x16_bf16 v[12:27], v[112:115], v[68:71], v[12:27]
    ds_read_b64_tr_b16 v[100:101], v8 offset:12288
    ds_read_b64_tr_b16 v[102:103], v8 offset:12544
    v_mfma_f32_32x32x16_bf16 v[28:43], v[116:119], v[68:71], v[28:43]
    ds_read_b64_tr_b16 v[104:105], v8 offset:13312
    ds_read_b64_tr_b16 v[106:107], v8 offset:13568
    v_mfma_f32_32x32x16_bf16 v[44:59], v[120:123], v[68:71], v[44:59]
    ds_read_b64_tr_b16 v[108:109], v8 offset:14336
    ds_read_b64_tr_b16 v[110:111], v8 offset:14592
    s_cmp_lg_u32 s36, 0
    s_cbranch_scc1 Lcn_232
    v_mfma_f32_32x32x16_bf16 v[140:155], v[164:167], v[112:115], v[140:155]
    s_branch Lcs_231
Lcn_232:
    s_cmp_lg_u32 s36, 1
    s_cbranch_scc1 Lcn_233
    v_mfma_f32_32x32x16_bf16 v[140:155], v[164:167], v[116:119], v[140:155]
    s_branch Lcs_231
Lcn_233:
    s_cmp_lg_u32 s36, 2
    s_cbranch_scc1 Lcn_234
    v_mfma_f32_32x32x16_bf16 v[140:155], v[164:167], v[120:123], v[140:155]
Lcn_234:
Lcs_231:
    s_add_u32 s48, s62, 1024
    buffer_load_dwordx4 v[68:71], v7, s[12:15], s48 offen sc1
    s_waitcnt vmcnt(14) lgkmcnt(6)
    v_mfma_f32_32x32x16_bf16 v[12:27], v[88:91], v[72:75], v[12:27]
    ds_read_b64_tr_b16 v[112:113], v8 offset:15360
    ds_read_b64_tr_b16 v[114:115], v8 offset:15616
    v_mfma_f32_32x32x16_bf16 v[28:43], v[92:95], v[72:75], v[28:43]
    ds_read_b64_tr_b16 v[116:117], v8 offset:16384
    ds_read_b64_tr_b16 v[118:119], v8 offset:16640
    v_mfma_f32_32x32x16_bf16 v[44:59], v[96:99], v[72:75], v[44:59]
    ds_read_b64_tr_b16 v[120:121], v8 offset:17408
    ds_read_b64_tr_b16 v[122:123], v8 offset:17664
    s_cmp_lg_u32 s36, 0
    s_cbranch_scc1 Lcn_236
    v_mfma_f32_32x32x16_bf16 v[140:155], v[164:167], v[88:91], v[140:155]
    s_branch Lcs_235
Lcn_236:
    s_cmp_lg_u32 s36, 1
    s_cbranch_scc1 Lcn_237
    v_mfma_f32_32x32x16_bf16 v[140:155], v[164:167], v[92:95], v[140:155]
    s_branch Lcs_235
Lcn_237:
    s_cmp_lg_u32 s36, 2
    s_cbranch_scc1 Lcn_238
    v_mfma_f32_32x32x16_bf16 v[140:155], v[164:167], v[96:99], v[140:155]
Lcn_238:
Lcs_235:
    s_add_u32 s48, s62, 2048
    buffer_load_dwordx4 v[72:75], v7, s[12:15], s48 offen sc1
    s_waitcnt vmcnt(14) lgkmcnt(6)
    v_mfma_f32_32x32x16_bf16 v[12:27], v[100:103], v[76:79], v[12:27]
    ds_read_b64_tr_b16 v[88:89], v8 offset:18432
    ds_read_b64_tr_b16 v[90:91], v8 offset:18688
    v_mfma_f32_32x32x16_bf16 v[28:43], v[104:107], v[76:79], v[28:43]
    ds_read_b64_tr_b16 v[92:93], v8 offset:19456
    ds_read_b64_tr_b16 v[94:95], v8 offset:19712
    v_mfma_f32_32x32x16_bf16 v[44:59], v[108:111], v[76:79], v[44:59]
    ds_read_b64_tr_b16 v[96:97], v8 offset:20480
    ds_read_b64_tr_b16 v[98:99], v8 offset:20736
    s_cmp_lg_u32 s36, 0
    s_cbranch_scc1 Lcn_240
    v_mfma_f32_32x32x16_bf16 v[140:155], v[164:167], v[100:103], v[140:155]
    s_branch Lcs_239
Lcn_240:
    s_cmp_lg_u32 s36, 1
    s_cbranch_scc1 Lcn_241
    v_mfma_f32_32x32x16_bf16 v[140:155], v[164:167], v[104:107], v[140:155]
    s_branch Lcs_239
Lcn_241:
    s_cmp_lg_u32 s36, 2
    s_cbranch_scc1 Lcn_242
    v_mfma_f32_32x32x16_bf16 v[140:155], v[164:167], v[108:111], v[140:155]
Lcn_242:
Lcs_239:
    s_add_u32 s48, s62, 3072
    buffer_load_dwordx4 v[76:79], v7, s[12:15], s48 offen sc1
    s_waitcnt vmcnt(14) lgkmcnt(6)
    v_mfma_f32_32x32x16_bf16 v[12:27], v[112:115], v[80:83], v[12:27]
    ds_read_b64_tr_b16 v[100:101], v8 offset:21504
    ds_read_b64_tr_b16 v[102:103], v8 offset:21760
    v_mfma_f32_32x32x16_bf16 v[28:43], v[116:119], v[80:83], v[28:43]
    ds_read_b64_tr_b16 v[104:105], v8 offset:22528
    ds_read_b64_tr_b16 v[106:107], v8 offset:22784
    v_mfma_f32_32x32x16_bf16 v[44:59], v[120:123], v[80:83], v[44:59]
    ds_read_b64_tr_b16 v[108:109], v8 offset:23552
    ds_read_b64_tr_b16 v[110:111], v8 offset:23808
    s_cmp_lg_u32 s36, 0
    s_cbranch_scc1 Lcn_244
    v_mfma_f32_32x32x16_bf16 v[140:155], v[164:167], v[112:115], v[140:155]
    s_branch Lcs_243
Lcn_244:
    s_cmp_lg_u32 s36, 1
    s_cbranch_scc1 Lcn_245
    v_mfma_f32_32x32x16_bf16 v[140:155], v[164:167], v[116:119], v[140:155]
    s_branch Lcs_243
Lcn_245:
    s_cmp_lg_u32 s36, 2
    s_cbranch_scc1 Lcn_246
    v_mfma_f32_32x32x16_bf16 v[140:155], v[164:167], v[120:123], v[140:155]
Lcn_246:
Lcs_243:
    s_add_u32 s48, s62, 4096
    buffer_load_dwordx4 v[80:83], v7, s[12:15], s48 offen sc1
    v_mov_b32 v2, 163648
    v_mov_b32 v3, 1
    s_waitcnt lgkmcnt(0)
    s_mov_b64 exec, 1
    ds_add_u32 v2, v3 offset:12
Lsb_247:
    ds_read_b32 v3, v2 offset:12
    s_waitcnt lgkmcnt(0)
    v_readfirstlane_b32 s46, v3
    s_cmp_ge_u32 s46, 4
    s_cbranch_scc1 Lsbd_248
    s_sleep 1
    s_add_u32 s92, s92, 1
    s_cmp_gt_u32 s92, 0x400000
    s_cbranch_scc1 k_end
    s_branch Lsb_247
Lsbd_248:
    s_mov_b64 exec, -1
    s_add_u32 s61, s60, 3
    s_and_b32 s61, s61, 3
    s_mul_i32 s61, s61, 352256
    s_add_u32 s61, s61, s42
    s_add_u32 m0, s50, 0
    s_add_u32 s49, s61, 0
    buffer_load_dwordx4 v9, s[8:11], s49 offen lds
    s_add_u32 m0, s50, 1024
    s_add_u32 s49, s61, 64
    buffer_load_dwordx4 v9, s[8:11], s49 offen lds
    s_add_u32 m0, s50, 2048
    s_add_u32 s49, s61, 128
    buffer_load_dwordx4 v9, s[8:11], s49 offen lds
    s_add_u32 m0, s50, 12288
    s_add_u32 s49, s61, 176128
    buffer_load_dwordx4 v9, s[8:11], s49 offen lds
    s_add_u32 m0, s50, 13312
    s_add_u32 s49, s61, 176192
    buffer_load_dwordx4 v9, s[8:11], s49 offen lds
    s_add_u32 m0, s50, 14336
    s_add_u32 s49, s61, 176256
    buffer_load_dwordx4 v9, s[8:11], s49 offen lds
    s_waitcnt vmcnt(20) lgkmcnt(6)
    v_mfma_f32_32x32x16_bf16 v[12:27], v[88:91], v[84:87], v[12:27]
    ds_read_b64_tr_b16 v[112:113], v8 offset:24576
    ds_read_b64_tr_b16 v[114:115], v8 offset:24832
    v_mfma_f32_32x32x16_bf16 v[28:43], v[92:95], v[84:87], v[28:43]
    ds_read_b64_tr_b16 v[116:117], v8 offset:25600
    ds_read_b64_tr_b16 v[118:119], v8 offset:25856
    v_mfma_f32_32x32x16_bf16 v[44:59], v[96:99], v[84:87], v[44:59]
    ds_read_b64_tr_b16 v[120:121], v8 offset:26624
    ds_read_b64_tr_b16 v[122:123], v8 offset:26880
    s_cmp_lg_u32 s36, 0
    s_cbranch_scc1 Lcn_250
    v_mfma_f32_32x32x16_bf16 v[140:155], v[164:167], v[88:91], v[140:155]
    s_branch Lcs_249
Lcn_250:
    s_cmp_lg_u32 s36, 1
    s_cbranch_scc1 Lcn_251
    v_mfma_f32_32x32x16_bf16 v[140:155], v[164:167], v[92:95], v[140:155]
    s_branch Lcs_249
Lcn_251:
    s_cmp_lg_u32 s36, 2
    s_cbranch_scc1 Lcn_252
    v_mfma_f32_32x32x16_bf16 v[140:155], v[164:167], v[96:99], v[140:155]
Lcn_252:
Lcs_249:
    s_add_u32 s48, s62, 5120
    buffer_load_dwordx4 v[84:87], v7, s[12:15], s48 offen sc1
    s_waitcnt vmcnt(12) lgkmcnt(6)
    v_mfma_f32_32x32x16_bf16 v[12:27], v[100:103], v[60:63], v[12:27]
    ds_read_b64_tr_b16 v[88:89], v8 offset:27648
    ds_read_b64_tr_b16 v[90:91], v8 offset:27904
    v_mfma_f32_32x32x16_bf16 v[28:43], v[104:107], v[60:63], v[28:43]
    ds_read_b64_tr_b16 v[92:93], v8 offset:28672
    ds_read_b64_tr_b16 v[94:95], v8 offset:28928
    v_mfma_f32_32x32x16_bf16 v[44:59], v[108:111], v[60:63], v[44:59]
    ds_read_b64_tr_b16 v[96:97], v8 offset:29696
    ds_read_b64_tr_b16 v[98:99], v8 offset:29952
    s_cmp_lg_u32 s36, 0
    s_cbranch_scc1 Lcn_254
    v_mfma_f32_32x32x16_bf16 v[140:155], v[164:167], v[100:103], v[140:155]
    s_branch Lcs_253
Lcn_254:
    s_cmp_lg_u32 s36, 1
    s_cbranch_scc1 Lcn_255
    v_mfma_f32_32x32x16_bf16 v[140:155], v[164:167], v[104:107], v[140:155]
    s_branch Lcs_253
Lcn_255:
    s_cmp_lg_u32 s36, 2
    s_cbranch_scc1 Lcn_256
    v_mfma_f32_32x32x16_bf16 v[140:155], v[164:167], v[108:111], v[140:155]
Lcn_256:
Lcs_253:
    s_add_u32 s48, s62, 6144
    buffer_load_dwordx4 v[60:63], v7, s[12:15], s48 offen sc1
    s_waitcnt vmcnt(12) lgkmcnt(6)
    v_mfma_f32_32x32x16_bf16 v[12:27], v[112:115], v[64:67], v[12:27]
    ds_read_b64_tr_b16 v[100:101], v8 offset:30720
    ds_read_b64_tr_b16 v[102:103], v8 offset:30976
    v_mfma_f32_32x32x16_bf16 v[28:43], v[116:119], v[64:67], v[28:43]
    ds_read_b64_tr_b16 v[104:105], v8 offset:31744
    ds_read_b64_tr_b16 v[106:107], v8 offset:32000
    v_mfma_f32_32x32x16_bf16 v[44:59], v[120:123], v[64:67], v[44:59]
    ds_read_b64_tr_b16 v[108:109], v8 offset:32768
    ds_read_b64_tr_b16 v[110:111], v8 offset:33024
    s_cmp_lg_u32 s36, 0
    s_cbranch_scc1 Lcn_258
    v_mfma_f32_32x32x16_bf16 v[140:155], v[164:167], v[112:115], v[140:155]
    s_branch Lcs_257
Lcn_258:
    s_cmp_lg_u32 s36, 1
    s_cbranch_scc1 Lcn_259
    v_mfma_f32_32x32x16_bf16 v[140:155], v[164:167], v[116:119], v[140:155]
    s_branch Lcs_257
Lcn_259:
    s_cmp_lg_u32 s36, 2
    s_cbranch_scc1 Lcn_260
    v_mfma_f32_32x32x16_bf16 v[140:155], v[164:167], v[120:123], v[140:155]
Lcn_260:
Lcs_257:
    s_add_u32 s48, s62, 7168
    buffer_load_dwordx4 v[64:67], v7, s[12:15], s48 offen sc1
    s_waitcnt vmcnt(12) lgkmcnt(6)
    v_mfma_f32_32x32x16_bf16 v[12:27], v[88:91], v[68:71], v[12:27]
    ds_read_b64_tr_b16 v[112:113], v8 offset:33792
    ds_read_b64_tr_b16 v[114:115], v8 offset:34048
    v_mfma_f32_32x32x16_bf16 v[28:43], v[92:95], v[68:71], v[28:43]
    ds_read_b64_tr_b16 v[116:117], v8 offset:34816
    ds_read_b64_tr_b16 v[118:119], v8 offset:35072
    v_mfma_f32_32x32x16_bf16 v[44:59], v[96:99], v[68:71], v[44:59]
    ds_read_b64_tr_b16 v[120:121], v8 offset:35840
    ds_read_b64_tr_b16 v[122:123], v8 offset:36096
    s_cmp_lg_u32 s36, 0
    s_cbranch_scc1 Lcn_262
    v_mfma_f32_32x32x16_bf16 v[140:155], v[164:167], v[88:91], v[140:155]
    s_branch Lcs_261
Lcn_262:
    s_cmp_lg_u32 s36, 1
    s_cbranch_scc1 Lcn_263
    v_mfma_f32_32x32x16_bf16 v[140:155], v[164:167], v[92:95], v[140:155]
    s_branch Lcs_261
Lcn_263:
    s_cmp_lg_u32 s36, 2
    s_cbranch_scc1 Lcn_264
    v_mfma_f32_32x32x16_bf16 v[140:155], v[164:167], v[96:99], v[140:155]
Lcn_264:
Lcs_261:
    s_add_u32 s62, s60, 2
    s_and_b32 s62, s62, 3
    s_lshl_b32 s62, s62, 13
    s_add_u32 s62, s62, s40
    s_add_u32 s48, s62, 0
    buffer_load_dwordx4 v[68:71], v7, s[12:15], s48 offen sc1
    s_waitcnt vmcnt(12) lgkmcnt(6)
    v_mfma_f32_32x32x16_bf16 v[12:27], v[100:103], v[72:75], v[12:27]
    ds_read_b64_tr_b16 v[88:89], v8 offset:36864
    ds_read_b64_tr_b16 v[90:91], v8 offset:37120
    v_mfma_f32_32x32x16_bf16 v[28:43], v[104:107], v[72:75], v[28:43]
    ds_read_b64_tr_b16 v[92:93], v8 offset:37888
    ds_read_b64_tr_b16 v[94:95], v8 offset:38144
    v_mfma_f32_32x32x16_bf16 v[44:59], v[108:111], v[72:75], v[44:59]
    ds_read_b64_tr_b16 v[96:97], v8 offset:38912
    ds_read_b64_tr_b16 v[98:99], v8 offset:39168
    s_cmp_lg_u32 s36, 0
    s_cbranch_scc1 Lcn_266
    v_mfma_f32_32x32x16_bf16 v[140:155], v[164:167], v[100:103], v[140:155]
    s_branch Lcs_265
Lcn_266:
    s_cmp_lg_u32 s36, 1
    s_cbranch_scc1 Lcn_267
    v_mfma_f32_32x32x16_bf16 v[140:155], v[164:167], v[104:107], v[140:155]
    s_branch Lcs_265
Lcn_267:
    s_cmp_lg_u32 s36, 2
    s_cbranch_scc1 Lcn_268
    v_mfma_f32_32x32x16_bf16 v[140:155], v[164:167], v[108:111], v[140:155]
Lcn_268:
Lcs_265:
    s_add_u32 s48, s62, 1024
    buffer_load_dwordx4 v[72:75], v7, s[12:15], s48 offen sc1
    s_waitcnt vmcnt(12) lgkmcnt(6)
    v_mfma_f32_32x32x16_bf16 v[12:27], v[112:115], v[76:79], v[12:27]
    ds_read_b64_tr_b16 v[100:101], v8 offset:39936
    ds_read_b64_tr_b16 v[102:103], v8 offset:40192
    v_mfma_f32_32x32x16_bf16 v[28:43], v[116:119], v[76:79], v[28:43]
    ds_read_b64_tr_b16 v[104:105], v8 offset:40960
    ds_read_b64_tr_b16 v[106:107], v8 offset:41216
    v_mfma_f32_32x32x16_bf16 v[44:59], v[120:123], v[76:79], v[44:59]
    ds_read_b64_tr_b16 v[108:109], v8 offset:41984
    ds_read_b64_tr_b16 v[110:111], v8 offset:42240
    s_cmp_lg_u32 s36, 0
    s_cbranch_scc1 Lcn_270
    v_mfma_f32_32x32x16_bf16 v[140:155], v[164:167], v[112:115], v[140:155]
    s_branch Lcs_269
Lcn_270:
    s_cmp_lg_u32 s36, 1
    s_cbranch_scc1 Lcn_271
    v_mfma_f32_32x32x16_bf16 v[140:155], v[164:167], v[116:119], v[140:155]
    s_branch Lcs_269
Lcn_271:
    s_cmp_lg_u32 s36, 2
    s_cbranch_scc1 Lcn_272
    v_mfma_f32_32x32x16_bf16 v[140:155], v[164:167], v[120:123], v[140:155]
Lcn_272:
Lcs_269:
    s_add_u32 s48, s62, 2048
    buffer_load_dwordx4 v[76:79], v7, s[12:15], s48 offen sc1
    s_waitcnt vmcnt(12) lgkmcnt(6)
    v_mfma_f32_32x32x16_bf16 v[12:27], v[88:91], v[80:83], v[12:27]
    ds_read_b64_tr_b16 v[112:113], v8 offset:43008
    ds_read_b64_tr_b16 v[114:115], v8 offset:43264
    v_mfma_f32_32x32x16_bf16 v[28:43], v[92:95], v[80:83], v[28:43]
    ds_read_b64_tr_b16 v[116:117], v8 offset:44032
    ds_read_b64_tr_b16 v[118:119], v8 offset:44288
    v_mfma_f32_32x32x16_bf16 v[44:59], v[96:99], v[80:83], v[44:59]
    ds_read_b64_tr_b16 v[120:121], v8 offset:45056
    ds_read_b64_tr_b16 v[122:123], v8 offset:45312
    s_cmp_lg_u32 s36, 0
    s_cbranch_scc1 Lcn_274
    v_mfma_f32_32x32x16_bf16 v[140:155], v[164:167], v[88:91], v[140:155]
    s_branch Lcs_273
Lcn_274:
    s_cmp_lg_u32 s36, 1
    s_cbranch_scc1 Lcn_275
    v_mfma_f32_32x32x16_bf16 v[140:155], v[164:167], v[92:95], v[140:155]
    s_branch Lcs_273
Lcn_275:
    s_cmp_lg_u32 s36, 2
    s_cbranch_scc1 Lcn_276
    v_mfma_f32_32x32x16_bf16 v[140:155], v[164:167], v[96:99], v[140:155]
Lcn_276:
Lcs_273:
    s_add_u32 s48, s62, 3072
    buffer_load_dwordx4 v[80:83], v7, s[12:15], s48 offen sc1
    v_add_f32 v124, v124, v126
    v_add_f32 v125, v125, v127
    v_add_f32 v124, v124, v128
    v_add_f32 v125, v125, v129
    v_add_f32 v124, v124, v130
    v_add_f32 v125, v125, v131
    v_add_f32 v124, v124, v132
    v_add_f32 v125, v125, v133
    v_add_f32 v124, v124, v134
    v_add_f32 v125, v125, v135
    v_add_f32 v124, v124, v136
    v_add_f32 v125, v125, v137
    v_add_f32 v124, v124, v138
    v_add_f32 v125, v125, v139
    v_mov_b32 v126, v124
    v_mov_b32 v127, v125
    s_nop 1
    v_permlane32_swap_b32 v124, v126
    v_permlane32_swap_b32 v125, v127
    s_nop 1
    v_add_f32 v124, v124, v126
    v_add_f32 v125, v125, v127
    v_mul_f32 v124, 0x3b000000, v124
    v_mul_f32 v125, 0x3b000000, v125
    v_fma_f32 v158, -v124, v124, v125
    v_max_f32 v158, 0, v158
    v_mov_b32 v159, v124
    v_cvt_pk_bf16_f32 v159, v159, v159
    v_lshlrev_b32 v159, 16, v159
    v_mov_b32 v160, v158
    v_cvt_pk_bf16_f32 v160, v160, v160
    v_lshlrev_b32 v160, 16, v160
    v_add_f32 v160, 0x3727c5ac, v160
    v_cvt_pk_bf16_f32 v160, v160, v160
    v_lshlrev_b32 v160, 16, v160
    v_sqrt_f32 v160, v160
    s_nop 0
    v_cvt_pk_bf16_f32 v160, v160, v160
    v_lshlrev_b32 v160, 16, v160
    v_rcp_f32 v161, v160
    s_nop 0
    v_mov_b32 v157, v161
    v_mul_f32 v156, v159, v161
    v_sub_f32 v156, 0, v156
    s_waitcnt vmcnt(6) lgkmcnt(6)
    v_mfma_f32_32x32x16_bf16 v[12:27], v[100:103], v[84:87], v[12:27]
    ds_read_b64_tr_b16 v[88:89], v8 offset:46080
    ds_read_b64_tr_b16 v[90:91], v8 offset:46336
    v_mfma_f32_32x32x16_bf16 v[28:43], v[104:107], v[84:87], v[28:43]
    ds_read_b64_tr_b16 v[92:93], v8 offset:47104
    ds_read_b64_tr_b16 v[94:95], v8 offset:47360
    v_mfma_f32_32x32x16_bf16 v[44:59], v[108:111], v[84:87], v[44:59]
    ds_read_b64_tr_b16 v[96:97], v8 offset:48128
    ds_read_b64_tr_b16 v[98:99], v8 offset:48384
    s_cmp_lg_u32 s36, 0
    s_cbranch_scc1 Lcn_278
    v_mfma_f32_32x32x16_bf16 v[140:155], v[164:167], v[100:103], v[140:155]
    s_branch Lcs_277
Lcn_278:
    s_cmp_lg_u32 s36, 1
    s_cbranch_scc1 Lcn_279
    v_mfma_f32_32x32x16_bf16 v[140:155], v[164:167], v[104:107], v[140:155]
    s_branch Lcs_277
Lcn_279:
    s_cmp_lg_u32 s36, 2
    s_cbranch_scc1 Lcn_280
    v_mfma_f32_32x32x16_bf16 v[140:155], v[164:167], v[108:111], v[140:155]
Lcn_280:
Lcs_277:
    s_add_u32 s48, s62, 4096
    buffer_load_dwordx4 v[84:87], v7, s[12:15], s48 offen sc1
    s_waitcnt vmcnt(6) lgkmcnt(6)
    v_mfma_f32_32x32x16_bf16 v[12:27], v[112:115], v[60:63], v[12:27]
    ds_read_b64_tr_b16 v[100:101], v8 offset:49152
    ds_read_b64_tr_b16 v[102:103], v8 offset:49408
    v_mfma_f32_32x32x16_bf16 v[28:43], v[116:119], v[60:63], v[28:43]
    ds_read_b64_tr_b16 v[104:105], v8 offset:50176
    ds_read_b64_tr_b16 v[106:107], v8 offset:50432
    v_mfma_f32_32x32x16_bf16 v[44:59], v[120:123], v[60:63], v[44:59]
    ds_read_b64_tr_b16 v[108:109], v8 offset:51200
    ds_read_b64_tr_b16 v[110:111], v8 offset:51456
    s_cmp_lg_u32 s36, 0
    s_cbranch_scc1 Lcn_282
    v_mfma_f32_32x32x16_bf16 v[140:155], v[164:167], v[112:115], v[140:155]
    s_branch Lcs_281
Lcn_282:
    s_cmp_lg_u32 s36, 1
    s_cbranch_scc1 Lcn_283
    v_mfma_f32_32x32x16_bf16 v[140:155], v[164:167], v[116:119], v[140:155]
    s_branch Lcs_281
Lcn_283:
    s_cmp_lg_u32 s36, 2
    s_cbranch_scc1 Lcn_284
    v_mfma_f32_32x32x16_bf16 v[140:155], v[164:167], v[120:123], v[140:155]
Lcn_284:
Lcs_281:
    s_add_u32 s48, s62, 5120
    buffer_load_dwordx4 v[60:63], v7, s[12:15], s48 offen sc1
    s_waitcnt vmcnt(6) lgkmcnt(6)
    v_mfma_f32_32x32x16_bf16 v[12:27], v[88:91], v[64:67], v[12:27]
    ds_read_b64_tr_b16 v[112:113], v8 offset:52224
    ds_read_b64_tr_b16 v[114:115], v8 offset:52480
    v_mfma_f32_32x32x16_bf16 v[28:43], v[92:95], v[64:67], v[28:43]
    ds_read_b64_tr_b16 v[116:117], v8 offset:53248
    ds_read_b64_tr_b16 v[118:119], v8 offset:53504
    v_mfma_f32_32x32x16_bf16 v[44:59], v[96:99], v[64:67], v[44:59]
    ds_read_b64_tr_b16 v[120:121], v8 offset:54272
    ds_read_b64_tr_b16 v[122:123], v8 offset:54528
    s_cmp_lg_u32 s36, 0
    s_cbranch_scc1 Lcn_286
    v_mfma_f32_32x32x16_bf16 v[140:155], v[164:167], v[88:91], v[140:155]
    s_branch Lcs_285
Lcn_286:
    s_cmp_lg_u32 s36, 1
    s_cbranch_scc1 Lcn_287
    v_mfma_f32_32x32x16_bf16 v[140:155], v[164:167], v[92:95], v[140:155]
    s_branch Lcs_285
Lcn_287:
    s_cmp_lg_u32 s36, 2
    s_cbranch_scc1 Lcn_288
    v_mfma_f32_32x32x16_bf16 v[140:155], v[164:167], v[96:99], v[140:155]
Lcn_288:
Lcs_285:
    s_add_u32 s48, s62, 6144
    buffer_load_dwordx4 v[64:67], v7, s[12:15], s48 offen sc1
    s_waitcnt vmcnt(6) lgkmcnt(6)
    v_mfma_f32_32x32x16_bf16 v[12:27], v[100:103], v[68:71], v[12:27]
    ds_read_b64_tr_b16 v[88:89], v8 offset:55296
    ds_read_b64_tr_b16 v[90:91], v8 offset:55552
    v_mfma_f32_32x32x16_bf16 v[28:43], v[104:107], v[68:71], v[28:43]
    ds_read_b64_tr_b16 v[92:93], v8 offset:56320
    ds_read_b64_tr_b16 v[94:95], v8 offset:56576
    v_mfma_f32_32x32x16_bf16 v[44:59], v[108:111], v[68:71], v[44:59]
    ds_read_b64_tr_b16 v[96:97], v8 offset:57344
    ds_read_b64_tr_b16 v[98:99], v8 offset:57600
    s_cmp_lg_u32 s36, 0
    s_cbranch_scc1 Lcn_290
    v_mfma_f32_32x32x16_bf16 v[140:155], v[164:167], v[100:103], v[140:155]
    s_branch Lcs_289
Lcn_290:
    s_cmp_lg_u32 s36, 1
    s_cbranch_scc1 Lcn_291
    v_mfma_f32_32x32x16_bf16 v[140:155], v[164:167], v[104:107], v[140:155]
    s_branch Lcs_289
Lcn_291:
    s_cmp_lg_u32 s36, 2
    s_cbranch_scc1 Lcn_292
    v_mfma_f32_32x32x16_bf16 v[140:155], v[164:167], v[108:111], v[140:155]
Lcn_292:
Lcs_289:
    s_add_u32 s48, s62, 7168
    buffer_load_dwordx4 v[68:71], v7, s[12:15], s48 offen sc1
    s_waitcnt vmcnt(6) lgkmcnt(6)
    v_mfma_f32_32x32x16_bf16 v[12:27], v[112:115], v[72:75], v[12:27]
    ds_read_b64_tr_b16 v[100:101], v8 offset:58368
    ds_read_b64_tr_b16 v[102:103], v8 offset:58624
    v_mfma_f32_32x32x16_bf16 v[28:43], v[116:119], v[72:75], v[28:43]
    ds_read_b64_tr_b16 v[104:105], v8 offset:59392
    ds_read_b64_tr_b16 v[106:107], v8 offset:59648
    v_mfma_f32_32x32x16_bf16 v[44:59], v[120:123], v[72:75], v[44:59]
    ds_read_b64_tr_b16 v[108:109], v8 offset:60416
    ds_read_b64_tr_b16 v[110:111], v8 offset:60672
    s_cmp_lg_u32 s36, 0
    s_cbranch_scc1 Lcn_294
    v_mfma_f32_32x32x16_bf16 v[140:155], v[164:167], v[112:115], v[140:155]
    s_branch Lcs_293
Lcn_294:
    s_cmp_lg_u32 s36, 1
    s_cbranch_scc1 Lcn_295
    v_mfma_f32_32x32x16_bf16 v[140:155], v[164:167], v[116:119], v[140:155]
    s_branch Lcs_293
Lcn_295:
    s_cmp_lg_u32 s36, 2
    s_cbranch_scc1 Lcn_296
    v_mfma_f32_32x32x16_bf16 v[140:155], v[164:167], v[120:123], v[140:155]
Lcn_296:
Lcs_293:
    s_add_u32 s62, s60, 3
    s_and_b32 s62, s62, 3
    s_lshl_b32 s62, s62, 13
    s_add_u32 s62, s62, s40
    s_add_u32 s48, s62, 0
    buffer_load_dwordx4 v[72:75], v7, s[12:15], s48 offen sc1
    s_waitcnt vmcnt(6) lgkmcnt(6)
    v_mfma_f32_32x32x16_bf16 v[12:27], v[88:91], v[76:79], v[12:27]
    ds_read_b64_tr_b16 v[112:113], v8 offset:61440
    ds_read_b64_tr_b16 v[114:115], v8 offset:61696
    v_mfma_f32_32x32x16_bf16 v[28:43], v[92:95], v[76:79], v[28:43]
    ds_read_b64_tr_b16 v[116:117], v8 offset:62464
    ds_read_b64_tr_b16 v[118:119], v8 offset:62720
    v_mfma_f32_32x32x16_bf16 v[44:59], v[96:99], v[76:79], v[44:59]
    ds_read_b64_tr_b16 v[120:121], v8 offset:63488
    ds_read_b64_tr_b16 v[122:123], v8 offset:63744
    s_cmp_lg_u32 s36, 0
    s_cbranch_scc1 Lcn_298
    v_mfma_f32_32x32x16_bf16 v[140:155], v[164:167], v[88:91], v[140:155]
    s_branch Lcs_297
Lcn_298:
    s_cmp_lg_u32 s36, 1
    s_cbranch_scc1 Lcn_299
    v_mfma_f32_32x32x16_bf16 v[140:155], v[164:167], v[92:95], v[140:155]
    s_branch Lcs_297
Lcn_299:
    s_cmp_lg_u32 s36, 2
    s_cbranch_scc1 Lcn_300
    v_mfma_f32_32x32x16_bf16 v[140:155], v[164:167], v[96:99], v[140:155]
Lcn_300:
Lcs_297:
    s_add_u32 s48, s62, 1024
    buffer_load_dwordx4 v[76:79], v7, s[12:15], s48 offen sc1
    s_waitcnt vmcnt(6) lgkmcnt(6)
    v_mfma_f32_32x32x16_bf16 v[12:27], v[100:103], v[80:83], v[12:27]
    ds_read_b64_tr_b16 v[88:89], v8 offset:64512
    ds_read_b64_tr_b16 v[90:91], v8 offset:64768
    v_mfma_f32_32x32x16_bf16 v[28:43], v[104:107], v[80:83], v[28:43]
    ds_read_b64_tr_b16 v[92:93], v10 offset:16384
    ds_read_b64_tr_b16 v[94:95], v10 offset:16640
    v_mfma_f32_32x32x16_bf16 v[44:59], v[108:111], v[80:83], v[44:59]
    ds_read_b64_tr_b16 v[96:97], v10 offset:17408
    ds_read_b64_tr_b16 v[98:99], v10 offset:17664
    s_cmp_lg_u32 s36, 0
    s_cbranch_scc1 Lcn_302
    v_mfma_f32_32x32x16_bf16 v[140:155], v[164:167], v[100:103], v[140:155]
    s_branch Lcs_301
Lcn_302:
    s_cmp_lg_u32 s36, 1
    s_cbranch_scc1 Lcn_303
    v_mfma_f32_32x32x16_bf16 v[140:155], v[164:167], v[104:107], v[140:155]
    s_branch Lcs_301
Lcn_303:
    s_cmp_lg_u32 s36, 2
    s_cbranch_scc1 Lcn_304
    v_mfma_f32_32x32x16_bf16 v[140:155], v[164:167], v[108:111], v[140:155]
Lcn_304:
Lcs_301:
    s_add_u32 s48, s62, 2048
    buffer_load_dwordx4 v[80:83], v7, s[12:15], s48 offen sc1
    s_waitcnt vmcnt(6) lgkmcnt(6)
    v_mfma_f32_32x32x16_bf16 v[12:27], v[112:115], v[84:87], v[12:27]
    ds_read_b64_tr_b16 v[100:101], v10 offset:18432
    ds_read_b64_tr_b16 v[102:103], v10 offset:18688
    v_mfma_f32_32x32x16_bf16 v[28:43], v[116:119], v[84:87], v[28:43]
    ds_read_b64_tr_b16 v[104:105], v10 offset:19456
    ds_read_b64_tr_b16 v[106:107], v10 offset:19712
    v_mfma_f32_32x32x16_bf16 v[44:59], v[120:123], v[84:87], v[44:59]
    ds_read_b64_tr_b16 v[108:109], v10 offset:20480
    ds_read_b64_tr_b16 v[110:111], v10 offset:20736
    s_cmp_lg_u32 s36, 0
    s_cbranch_scc1 Lcn_306
    v_mfma_f32_32x32x16_bf16 v[140:155], v[164:167], v[112:115], v[140:155]
    s_branch Lcs_305
Lcn_306:
    s_cmp_lg_u32 s36, 1
    s_cbranch_scc1 Lcn_307
    v_mfma_f32_32x32x16_bf16 v[140:155], v[164:167], v[116:119], v[140:155]
    s_branch Lcs_305
Lcn_307:
    s_cmp_lg_u32 s36, 2
    s_cbranch_scc1 Lcn_308
    v_mfma_f32_32x32x16_bf16 v[140:155], v[164:167], v[120:123], v[140:155]
Lcn_308:
Lcs_305:
    s_add_u32 s48, s62, 3072
    buffer_load_dwordx4 v[84:87], v7, s[12:15], s48 offen sc1
    s_waitcnt vmcnt(6) lgkmcnt(6)
    v_mfma_f32_32x32x16_bf16 v[12:27], v[88:91], v[60:63], v[12:27]
    ds_read_b64_tr_b16 v[112:113], v10 offset:21504
    ds_read_b64_tr_b16 v[114:115], v10 offset:21760
    v_mfma_f32_32x32x16_bf16 v[28:43], v[92:95], v[60:63], v[28:43]
    ds_read_b64_tr_b16 v[116:117], v10 offset:22528
    ds_read_b64_tr_b16 v[118:119], v10 offset:22784
    v_mfma_f32_32x32x16_bf16 v[44:59], v[96:99], v[60:63], v[44:59]
    ds_read_b64_tr_b16 v[120:121], v10 offset:23552
    ds_read_b64_tr_b16 v[122:123], v10 offset:23808
    s_cmp_lg_u32 s36, 0
    s_cbranch_scc1 Lcn_310
    v_mfma_f32_32x32x16_bf16 v[140:155], v[164:167], v[88:91], v[140:155]
    s_branch Lcs_309
Lcn_310:
    s_cmp_lg_u32 s36, 1
    s_cbranch_scc1 Lcn_311
    v_mfma_f32_32x32x16_bf16 v[140:155], v[164:167], v[92:95], v[140:155]
    s_branch Lcs_309
Lcn_311:
    s_cmp_lg_u32 s36, 2
    s_cbranch_scc1 Lcn_312
    v_mfma_f32_32x32x16_bf16 v[140:155], v[164:167], v[96:99], v[140:155]
Lcn_312:
Lcs_309:
    s_add_u32 s48, s62, 4096
    buffer_load_dwordx4 v[60:63], v7, s[12:15], s48 offen sc1
    s_waitcnt vmcnt(16)
    v_mov_b32 v2, 163648
    v_mov_b32 v3, 1
    s_waitcnt lgkmcnt(0)
    s_mov_b64 exec, 1
    ds_add_u32 v2, v3 offset:16
Lsb_313:
    ds_read_b32 v3, v2 offset:16
    s_waitcnt lgkmcnt(0)
    v_readfirstlane_b32 s46, v3
    s_cmp_ge_u32 s46, 4
    s_cbranch_scc1 Lsbd_314
    s_sleep 1
    s_add_u32 s92, s92, 1
    s_cmp_gt_u32 s92, 0x400000
    s_cbranch_scc1 k_end
    s_branch Lsb_313
Lsbd_314:
    s_mov_b64 exec, -1
    s_waitcnt vmcnt(6) lgkmcnt(6)
    v_mfma_f32_32x32x16_bf16 v[12:27], v[100:103], v[64:67], v[12:27]
    ds_read_b64_tr_b16 v[88:89], v8 offset:0
    ds_read_b64_tr_b16 v[90:91], v8 offset:256
    v_mfma_f32_32x32x16_bf16 v[28:43], v[104:107], v[64:67], v[28:43]
    ds_read_b64_tr_b16 v[92:93], v8 offset:1024
    ds_read_b64_tr_b16 v[94:95], v8 offset:1280
    v_mfma_f32_32x32x16_bf16 v[44:59], v[108:111], v[64:67], v[44:59]
    ds_read_b64_tr_b16 v[96:97], v8 offset:2048
    ds_read_b64_tr_b16 v[98:99], v8 offset:2304
    s_cmp_lg_u32 s36, 0
    s_cbranch_scc1 Lcn_316
    v_mfma_f32_32x32x16_bf16 v[140:155], v[164:167], v[100:103], v[140:155]
    s_branch Lcs_315
Lcn_316:
    s_cmp_lg_u32 s36, 1
    s_cbranch_scc1 Lcn_317
    v_mfma_f32_32x32x16_bf16 v[140:155], v[164:167], v[104:107], v[140:155]
    s_branch Lcs_315
Lcn_317:
    s_cmp_lg_u32 s36, 2
    s_cbranch_scc1 Lcn_318
    v_mfma_f32_32x32x16_bf16 v[140:155], v[164:167], v[108:111], v[140:155]
Lcn_318:
Lcs_315:
    s_add_u32 s48, s62, 5120
    buffer_load_dwordx4 v[64:67], v7, s[12:15], s48 offen sc1
    s_waitcnt vmcnt(6) lgkmcnt(6)
    v_mfma_f32_32x32x16_bf16 v[12:27], v[112:115], v[68:71], v[12:27]
    ds_read_b64_tr_b16 v[100:101], v8 offset:3072
    ds_read_b64_tr_b16 v[102:103], v8 offset:3328
    v_mfma_f32_32x32x16_bf16 v[28:43], v[116:119], v[68:71], v[28:43]
    ds_read_b64_tr_b16 v[104:105], v8 offset:4096
    ds_read_b64_tr_b16 v[106:107], v8 offset:4352
    v_mfma_f32_32x32x16_bf16 v[44:59], v[120:123], v[68:71], v[44:59]
    ds_read_b64_tr_b16 v[108:109], v8 offset:5120
    ds_read_b64_tr_b16 v[110:111], v8 offset:5376
    s_cmp_lg_u32 s36, 0
    s_cbranch_scc1 Lcn_320
    v_mfma_f32_32x32x16_bf16 v[140:155], v[164:167], v[112:115], v[140:155]
    s_branch Lcs_319
Lcn_320:
    s_cmp_lg_u32 s36, 1
    s_cbranch_scc1 Lcn_321
    v_mfma_f32_32x32x16_bf16 v[140:155], v[164:167], v[116:119], v[140:155]
    s_branch Lcs_319
Lcn_321:
    s_cmp_lg_u32 s36, 2
    s_cbranch_scc1 Lcn_322
    v_mfma_f32_32x32x16_bf16 v[140:155], v[164:167], v[120:123], v[140:155]
Lcn_322:
Lcs_319:
    s_add_u32 s48, s62, 6144
    buffer_load_dwordx4 v[68:71], v7, s[12:15], s48 offen sc1
    s_waitcnt vmcnt(6) lgkmcnt(6)
    v_mfma_f32_32x32x16_bf16 v[12:27], v[88:91], v[72:75], v[12:27]
    ds_read_b64_tr_b16 v[112:113], v8 offset:6144
    ds_read_b64_tr_b16 v[114:115], v8 offset:6400
    v_mfma_f32_32x32x16_bf16 v[28:43], v[92:95], v[72:75], v[28:43]
    ds_read_b64_tr_b16 v[116:117], v8 offset:7168
    ds_read_b64_tr_b16 v[118:119], v8 offset:7424
    v_mfma_f32_32x32x16_bf16 v[44:59], v[96:99], v[72:75], v[44:59]
    ds_read_b64_tr_b16 v[120:121], v8 offset:8192
    ds_read_b64_tr_b16 v[122:123], v8 offset:8448
    s_cmp_lg_u32 s36, 0
    s_cbranch_scc1 Lcn_324
    v_mfma_f32_32x32x16_bf16 v[140:155], v[164:167], v[88:91], v[140:155]
    s_branch Lcs_323
Lcn_324:
    s_cmp_lg_u32 s36, 1
    s_cbranch_scc1 Lcn_325
    v_mfma_f32_32x32x16_bf16 v[140:155], v[164:167], v[92:95], v[140:155]
    s_branch Lcs_323
Lcn_325:
    s_cmp_lg_u32 s36, 2
    s_cbranch_scc1 Lcn_326
    v_mfma_f32_32x32x16_bf16 v[140:155], v[164:167], v[96:99], v[140:155]
Lcn_326:
Lcs_323:
    s_add_u32 s48, s62, 7168
    buffer_load_dwordx4 v[72:75], v7, s[12:15], s48 offen sc1
    s_waitcnt vmcnt(6) lgkmcnt(6)
    v_mfma_f32_32x32x16_bf16 v[12:27], v[100:103], v[76:79], v[12:27]
    ds_read_b64_tr_b16 v[88:89], v8 offset:9216
    ds_read_b64_tr_b16 v[90:91], v8 offset:9472
    v_mfma_f32_32x32x16_bf16 v[28:43], v[104:107], v[76:79], v[28:43]
    ds_read_b64_tr_b16 v[92:93], v8 offset:10240
    ds_read_b64_tr_b16 v[94:95], v8 offset:10496
    v_mfma_f32_32x32x16_bf16 v[44:59], v[108:111], v[76:79], v[44:59]
    ds_read_b64_tr_b16 v[96:97], v8 offset:11264
    ds_read_b64_tr_b16 v[98:99], v8 offset:11520
    s_cmp_lg_u32 s36, 0
    s_cbranch_scc1 Lcn_328
    v_mfma_f32_32x32x16_bf16 v[140:155], v[164:167], v[100:103], v[140:155]
    s_branch Lcs_327
Lcn_328:
    s_cmp_lg_u32 s36, 1
    s_cbranch_scc1 Lcn_329
    v_mfma_f32_32x32x16_bf16 v[140:155], v[164:167], v[104:107], v[140:155]
    s_branch Lcs_327
Lcn_329:
    s_cmp_lg_u32 s36, 2
    s_cbranch_scc1 Lcn_330
    v_mfma_f32_32x32x16_bf16 v[140:155], v[164:167], v[108:111], v[140:155]
Lcn_330:
Lcs_327:
    s_waitcnt vmcnt(5) lgkmcnt(6)
    v_mfma_f32_32x32x16_bf16 v[12:27], v[112:115], v[80:83], v[12:27]
    ds_read_b64_tr_b16 v[100:101], v8 offset:12288
    ds_read_b64_tr_b16 v[102:103], v8 offset:12544
    v_mfma_f32_32x32x16_bf16 v[28:43], v[116:119], v[80:83], v[28:43]
    ds_read_b64_tr_b16 v[104:105], v8 offset:13312
    ds_read_b64_tr_b16 v[106:107], v8 offset:13568
    v_mfma_f32_32x32x16_bf16 v[44:59], v[120:123], v[80:83], v[44:59]
    ds_read_b64_tr_b16 v[108:109], v8 offset:14336
    ds_read_b64_tr_b16 v[110:111], v8 offset:14592
    s_cmp_lg_u32 s36, 0
    s_cbranch_scc1 Lcn_332
    v_mfma_f32_32x32x16_bf16 v[140:155], v[164:167], v[112:115], v[140:155]
    s_branch Lcs_331
Lcn_332:
    s_cmp_lg_u32 s36, 1
    s_cbranch_scc1 Lcn_333
    v_mfma_f32_32x32x16_bf16 v[140:155], v[164:167], v[116:119], v[140:155]
    s_branch Lcs_331
Lcn_333:
    s_cmp_lg_u32 s36, 2
    s_cbranch_scc1 Lcn_334
    v_mfma_f32_32x32x16_bf16 v[140:155], v[164:167], v[120:123], v[140:155]
Lcn_334:
Lcs_331:
    s_waitcnt vmcnt(4) lgkmcnt(6)
    v_mfma_f32_32x32x16_bf16 v[12:27], v[88:91], v[84:87], v[12:27]
    ds_read_b64_tr_b16 v[112:113], v8 offset:15360
    ds_read_b64_tr_b16 v[114:115], v8 offset:15616
    v_mfma_f32_32x32x16_bf16 v[28:43], v[92:95], v[84:87], v[28:43]
    ds_read_b64_tr_b16 v[116:117], v8 offset:16384
    ds_read_b64_tr_b16 v[118:119], v8 offset:16640
    v_mfma_f32_32x32x16_bf16 v[44:59], v[96:99], v[84:87], v[44:59]
    ds_read_b64_tr_b16 v[120:121], v8 offset:17408
    ds_read_b64_tr_b16 v[122:123], v8 offset:17664
    s_cmp_lg_u32 s36, 0
    s_cbranch_scc1 Lcn_336
    v_mfma_f32_32x32x16_bf16 v[140:155], v[164:167], v[88:91], v[140:155]
    s_branch Lcs_335
Lcn_336:
    s_cmp_lg_u32 s36, 1
    s_cbranch_scc1 Lcn_337
    v_mfma_f32_32x32x16_bf16 v[140:155], v[164:167], v[92:95], v[140:155]
    s_branch Lcs_335
Lcn_337:
    s_cmp_lg_u32 s36, 2
    s_cbranch_scc1 Lcn_338
    v_mfma_f32_32x32x16_bf16 v[140:155], v[164:167], v[96:99], v[140:155]
Lcn_338:
Lcs_335:
    s_waitcnt vmcnt(3) lgkmcnt(6)
    v_mfma_f32_32x32x16_bf16 v[12:27], v[100:103], v[60:63], v[12:27]
    ds_read_b64_tr_b16 v[88:89], v8 offset:18432
    ds_read_b64_tr_b16 v[90:91], v8 offset:18688
    v_mfma_f32_32x32x16_bf16 v[28:43], v[104:107], v[60:63], v[28:43]
    ds_read_b64_tr_b16 v[92:93], v8 offset:19456
    ds_read_b64_tr_b16 v[94:95], v8 offset:19712
    v_mfma_f32_32x32x16_bf16 v[44:59], v[108:111], v[60:63], v[44:59]
    ds_read_b64_tr_b16 v[96:97], v8 offset:20480
    ds_read_b64_tr_b16 v[98:99], v8 offset:20736
    s_cmp_lg_u32 s36, 0
    s_cbranch_scc1 Lcn_340
    v_mfma_f32_32x32x16_bf16 v[140:155], v[164:167], v[100:103], v[140:155]
    s_branch Lcs_339
Lcn_340:
    s_cmp_lg_u32 s36, 1
    s_cbranch_scc1 Lcn_341
    v_mfma_f32_32x32x16_bf16 v[140:155], v[164:167], v[104:107], v[140:155]
    s_branch Lcs_339
Lcn_341:
    s_cmp_lg_u32 s36, 2
    s_cbranch_scc1 Lcn_342
    v_mfma_f32_32x32x16_bf16 v[140:155], v[164:167], v[108:111], v[140:155]
Lcn_342:
Lcs_339:
    s_waitcnt vmcnt(2) lgkmcnt(6)
    v_mfma_f32_32x32x16_bf16 v[12:27], v[112:115], v[64:67], v[12:27]
    ds_read_b64_tr_b16 v[100:101], v8 offset:21504
    ds_read_b64_tr_b16 v[102:103], v8 offset:21760
    v_mfma_f32_32x32x16_bf16 v[28:43], v[116:119], v[64:67], v[28:43]
    ds_read_b64_tr_b16 v[104:105], v8 offset:22528
    ds_read_b64_tr_b16 v[106:107], v8 offset:22784
    v_mfma_f32_32x32x16_bf16 v[44:59], v[120:123], v[64:67], v[44:59]
    ds_read_b64_tr_b16 v[108:109], v8 offset:23552
    ds_read_b64_tr_b16 v[110:111], v8 offset:23808
    s_cmp_lg_u32 s36, 0
    s_cbranch_scc1 Lcn_344
    v_mfma_f32_32x32x16_bf16 v[140:155], v[164:167], v[112:115], v[140:155]
    s_branch Lcs_343
Lcn_344:
    s_cmp_lg_u32 s36, 1
    s_cbranch_scc1 Lcn_345
    v_mfma_f32_32x32x16_bf16 v[140:155], v[164:167], v[116:119], v[140:155]
    s_branch Lcs_343
Lcn_345:
    s_cmp_lg_u32 s36, 2
    s_cbranch_scc1 Lcn_346
    v_mfma_f32_32x32x16_bf16 v[140:155], v[164:167], v[120:123], v[140:155]
Lcn_346:
Lcs_343:
    s_waitcnt vmcnt(1) lgkmcnt(6)
    v_mfma_f32_32x32x16_bf16 v[12:27], v[88:91], v[68:71], v[12:27]
    v_mfma_f32_32x32x16_bf16 v[28:43], v[92:95], v[68:71], v[28:43]
    v_mfma_f32_32x32x16_bf16 v[44:59], v[96:99], v[68:71], v[44:59]
    s_cmp_lg_u32 s36, 0
    s_cbranch_scc1 Lcn_348
    v_mfma_f32_32x32x16_bf16 v[140:155], v[164:167], v[88:91], v[140:155]
    s_branch Lcs_347
Lcn_348:
    s_cmp_lg_u32 s36, 1
    s_cbranch_scc1 Lcn_349
    v_mfma_f32_32x32x16_bf16 v[140:155], v[164:167], v[92:95], v[140:155]
    s_branch Lcs_347
Lcn_349:
    s_cmp_lg_u32 s36, 2
    s_cbranch_scc1 Lcn_350
    v_mfma_f32_32x32x16_bf16 v[140:155], v[164:167], v[96:99], v[140:155]
Lcn_350:
Lcs_347:
    s_waitcnt vmcnt(0) lgkmcnt(0)
    v_mfma_f32_32x32x16_bf16 v[12:27], v[100:103], v[72:75], v[12:27]
    v_mfma_f32_32x32x16_bf16 v[28:43], v[104:107], v[72:75], v[28:43]
    v_mfma_f32_32x32x16_bf16 v[44:59], v[108:111], v[72:75], v[44:59]
    s_cmp_lg_u32 s36, 0
    s_cbranch_scc1 Lcn_352
    v_mfma_f32_32x32x16_bf16 v[140:155], v[164:167], v[100:103], v[140:155]
    s_branch Lcs_351
Lcn_352:
    s_cmp_lg_u32 s36, 1
    s_cbranch_scc1 Lcn_353
    v_mfma_f32_32x32x16_bf16 v[140:155], v[164:167], v[104:107], v[140:155]
    s_branch Lcs_351
Lcn_353:
    s_cmp_lg_u32 s36, 2
    s_cbranch_scc1 Lcn_354
    v_mfma_f32_32x32x16_bf16 v[140:155], v[164:167], v[108:111], v[140:155]
Lcn_354:
Lcs_351:
    v_and_b32 v5, 31, v1
    v_lshlrev_b32 v5, 2, v5
    s_lshl_b32 s43, s36, 7
    s_add_u32 s43, s43, 155648
    v_add_u32 v5, s43, v5
    s_nop 7
    ds_write_b32 v5, v140
    v_mov_b32 v2, 163648
    v_mov_b32 v3, 1
    s_waitcnt lgkmcnt(0)
    s_mov_b64 exec, 1
    ds_add_u32 v2, v3 offset:20
Lsb_355:
    ds_read_b32 v3, v2 offset:20
    s_waitcnt lgkmcnt(0)
    v_readfirstlane_b32 s46, v3
    s_cmp_ge_u32 s46, 4
    s_cbranch_scc1 Lsbd_356
    s_sleep 1
    s_add_u32 s92, s92, 1
    s_cmp_gt_u32 s92, 0x400000
    s_cbranch_scc1 k_end
    s_branch Lsb_355
Lsbd_356:
    s_mov_b64 exec, -1
    v_mov_b32 v158, 0xbdd2d3e8
    s_mov_b32 s45, 0xc0135761
    v_lshrrev_b32 v5, 5, v1
    v_lshlrev_b32 v5, 4, v5
    v_add_u32 v5, 155648, v5
    s_lshl_b32 s43, s37, 2
    s_add_u32 s43, s43, s36
    s_mul_i32 s43, s43, 86
    s_mul_i32 s44, s38, 6
    s_add_u32 s43, s43, s44
    s_lshl_b32 s43, s43, 10
    s_add_u32 s43, s43, 0xc00000
    ds_read_b128 v[140:143], v5 offset:0
    ds_read_b128 v[144:147], v5 offset:32
    ds_read_b128 v[148:151], v5 offset:64
    ds_read_b128 v[152:155], v5 offset:96
    v_mul_f32 v12, v12, v157
    v_mul_f32 v13, v13, v157
    v_mul_f32 v14, v14, v157
    v_mul_f32 v15, v15, v157
    v_mul_f32 v16, v16, v157
    v_mul_f32 v17, v17, v157
    v_mul_f32 v18, v18, v157
    v_mul_f32 v19, v19, v157
    v_mul_f32 v20, v20, v157
    v_mul_f32 v21, v21, v157
    v_mul_f32 v22, v22, v157
    v_mul_f32 v23, v23, v157
    v_mul_f32 v24, v24, v157
    v_mul_f32 v25, v25, v157
    v_mul_f32 v26, v26, v157
    v_mul_f32 v27, v27, v157
    s_waitcnt lgkmcnt(0)
    v_fma_f32 v12, v156, v140, v12
    v_fma_f32 v13, v156, v141, v13
    v_fma_f32 v14, v156, v142, v14
    v_fma_f32 v15, v156, v143, v15
    v_fma_f32 v16, v156, v144, v16
    v_fma_f32 v17, v156, v145, v17
    v_fma_f32 v18, v156, v146, v18
    v_fma_f32 v19, v156, v147, v19
    v_fma_f32 v20, v156, v148, v20
    v_fma_f32 v21, v156, v149, v21
    v_fma_f32 v22, v156, v150, v22
    v_fma_f32 v23, v156, v151, v23
    v_fma_f32 v24, v156, v152, v24
    v_fma_f32 v25, v156, v153, v25
    v_fma_f32 v26, v156, v154, v26
    v_fma_f32 v27, v156, v155, v27
    v_mul_f32 v124, v12, v12
    v_mul_f32 v125, v13, v13
    v_mul_f32 v126, v14, v14
    v_mul_f32 v127, v15, v15
    v_mul_f32 v128, v16, v16
    v_mul_f32 v129, v17, v17
    v_mul_f32 v130, v18, v18
    v_mul_f32 v131, v19, v19
    v_mul_f32 v132, v20, v20
    v_mul_f32 v133, v21, v21
    v_mul_f32 v134, v22, v22
    v_mul_f32 v135, v23, v23
    v_mul_f32 v136, v24, v24
    v_mul_f32 v137, v25, v25
    v_mul_f32 v138, v26, v26
    v_mul_f32 v139, v27, v27
    v_fma_f32 v124, v124, v158, s45
    v_fma_f32 v125, v125, v158, s45
    v_fma_f32 v126, v126, v158, s45
    v_fma_f32 v127, v127, v158, s45
    v_fma_f32 v128, v128, v158, s45
    v_fma_f32 v129, v129, v158, s45
    v_fma_f32 v130, v130, v158, s45
    v_fma_f32 v131, v131, v158, s45
    v_fma_f32 v132, v132, v158, s45
    v_fma_f32 v133, v133, v158, s45
    v_fma_f32 v134, v134, v158, s45
    v_fma_f32 v135, v135, v158, s45
    v_fma_f32 v136, v136, v158, s45
    v_fma_f32 v137, v137, v158, s45
    v_fma_f32 v138, v138, v158, s45
    v_fma_f32 v139, v139, v158, s45
    v_mul_f32 v124, v124, v12
    v_mul_f32 v125, v125, v13
    v_mul_f32 v126, v126, v14
    v_mul_f32 v127, v127, v15
    v_mul_f32 v128, v128, v16
    v_mul_f32 v129, v129, v17
    v_mul_f32 v130, v130, v18
    v_mul_f32 v131, v131, v19
    v_mul_f32 v132, v132, v20
    v_mul_f32 v133, v133, v21
    v_mul_f32 v134, v134, v22
    v_mul_f32 v135, v135, v23
    v_mul_f32 v136, v136, v24
    v_mul_f32 v137, v137, v25
    v_mul_f32 v138, v138, v26
    v_mul_f32 v139, v139, v27
    v_exp_f32 v124, v124
    v_exp_f32 v125, v125
    v_exp_f32 v126, v126
    v_exp_f32 v127, v127
    v_exp_f32 v128, v128
    v_exp_f32 v129, v129
    v_exp_f32 v130, v130
    v_exp_f32 v131, v131
    v_exp_f32 v132, v132
    v_exp_f32 v133, v133
    v_exp_f32 v134, v134
    v_exp_f32 v135, v135
    v_exp_f32 v136, v136
    v_exp_f32 v137, v137
    v_exp_f32 v138, v138
    v_exp_f32 v139, v139
    s_nop 0
    v_add_f32 v124, 1.0, v124
    v_add_f32 v125, 1.0, v125
    v_add_f32 v126, 1.0, v126
    v_add_f32 v127, 1.0, v127
    v_add_f32 v128, 1.0, v128
    v_add_f32 v129, 1.0, v129
    v_add_f32 v130, 1.0, v130
    v_add_f32 v131, 1.0, v131
    v_add_f32 v132, 1.0, v132
    v_add_f32 v133, 1.0, v133
    v_add_f32 v134, 1.0, v134
    v_add_f32 v135, 1.0, v135
    v_add_f32 v136, 1.0, v136
    v_add_f32 v137, 1.0, v137
    v_add_f32 v138, 1.0, v138
    v_add_f32 v139, 1.0, v139
    v_rcp_f32 v124, v124
    v_rcp_f32 v125, v125
    v_rcp_f32 v126, v126
    v_rcp_f32 v127, v127
    v_rcp_f32 v128, v128
    v_rcp_f32 v129, v129
    v_rcp_f32 v130, v130
    v_rcp_f32 v131, v131
    v_rcp_f32 v132, v132
    v_rcp_f32 v133, v133
    v_rcp_f32 v134, v134
    v_rcp_f32 v135, v135
    v_rcp_f32 v136, v136
    v_rcp_f32 v137, v137
    v_rcp_f32 v138, v138
    v_rcp_f32 v139, v139
    s_nop 0
    v_mul_f32 v12, v12, v124
    v_mul_f32 v13, v13, v125
    v_mul_f32 v14, v14, v126
    v_mul_f32 v15, v15, v127
    v_mul_f32 v16, v16, v128
    v_mul_f32 v17, v17, v129
    v_mul_f32 v18, v18, v130
    v_mul_f32 v19, v19, v131
    v_mul_f32 v20, v20, v132
    v_mul_f32 v21, v21, v133
    v_mul_f32 v22, v22, v134
    v_mul_f32 v23, v23, v135
    v_mul_f32 v24, v24, v136
    v_mul_f32 v25, v25, v137
    v_mul_f32 v26, v26, v138
    v_mul_f32 v27, v27, v139
    s_add_u32 s44, s43, 0
    v_cvt_pk_bf16_f32 v60, v12, v13
    v_cvt_pk_bf16_f32 v61, v14, v15
    v_cvt_pk_bf16_f32 v62, v16, v17
    v_cvt_pk_bf16_f32 v63, v18, v19
    v_cvt_pk_bf16_f32 v64, v20, v21
    v_cvt_pk_bf16_f32 v65, v22, v23
    v_cvt_pk_bf16_f32 v66, v24, v25
    v_cvt_pk_bf16_f32 v67, v26, v27
    s_nop 1
    v_permlane32_swap_b32 v60, v62
    v_permlane32_swap_b32 v61, v63
    v_permlane32_swap_b32 v64, v66
    v_permlane32_swap_b32 v65, v67
    s_nop 1
    buffer_store_dwordx4 v[60:63], v7, s[12:15], s44 offen offset:0 sc1
    buffer_store_dwordx4 v[64:67], v7, s[12:15], s44 offen offset:1024 sc1
    s_cmp_eq_u32 s38, 14
    s_cbranch_scc1 g3_skip_357
    ds_read_b128 v[140:143], v5 offset:128
    ds_read_b128 v[144:147], v5 offset:160
    ds_read_b128 v[148:151], v5 offset:192
    ds_read_b128 v[152:155], v5 offset:224
    v_mul_f32 v28, v28, v157
    v_mul_f32 v29, v29, v157
    v_mul_f32 v30, v30, v157
    v_mul_f32 v31, v31, v157
    v_mul_f32 v32, v32, v157
    v_mul_f32 v33, v33, v157
    v_mul_f32 v34, v34, v157
    v_mul_f32 v35, v35, v157
    v_mul_f32 v36, v36, v157
    v_mul_f32 v37, v37, v157
    v_mul_f32 v38, v38, v157
    v_mul_f32 v39, v39, v157
    v_mul_f32 v40, v40, v157
    v_mul_f32 v41, v41, v157
    v_mul_f32 v42, v42, v157
    v_mul_f32 v43, v43, v157
    s_waitcnt lgkmcnt(0)
    v_fma_f32 v28, v156, v140, v28
    v_fma_f32 v29, v156, v141, v29
    v_fma_f32 v30, v156, v142, v30
    v_fma_f32 v31, v156, v143, v31
    v_fma_f32 v32, v156, v144, v32
    v_fma_f32 v33, v156, v145, v33
    v_fma_f32 v34, v156, v146, v34
    v_fma_f32 v35, v156, v147, v35
    v_fma_f32 v36, v156, v148, v36
    v_fma_f32 v37, v156, v149, v37
    v_fma_f32 v38, v156, v150, v38
    v_fma_f32 v39, v156, v151, v39
    v_fma_f32 v40, v156, v152, v40
    v_fma_f32 v41, v156, v153, v41
    v_fma_f32 v42, v156, v154, v42
    v_fma_f32 v43, v156, v155, v43
    v_mul_f32 v124, v28, v28
    v_mul_f32 v125, v29, v29
    v_mul_f32 v126, v30, v30
    v_mul_f32 v127, v31, v31
    v_mul_f32 v128, v32, v32
    v_mul_f32 v129, v33, v33
    v_mul_f32 v130, v34, v34
    v_mul_f32 v131, v35, v35
    v_mul_f32 v132, v36, v36
    v_mul_f32 v133, v37, v37
    v_mul_f32 v134, v38, v38
    v_mul_f32 v135, v39, v39
    v_mul_f32 v136, v40, v40
    v_mul_f32 v137, v41, v41
    v_mul_f32 v138, v42, v42
    v_mul_f32 v139, v43, v43
    v_fma_f32 v124, v124, v158, s45
    v_fma_f32 v125, v125, v158, s45
    v_fma_f32 v126, v126, v158, s45
    v_fma_f32 v127, v127, v158, s45
    v_fma_f32 v128, v128, v158, s45
    v_fma_f32 v129, v129, v158, s45
    v_fma_f32 v130, v130, v158, s45
    v_fma_f32 v131, v131, v158, s45
    v_fma_f32 v132, v132, v158, s45
    v_fma_f32 v133, v133, v158, s45
    v_fma_f32 v134, v134, v158, s45
    v_fma_f32 v135, v135, v158, s45
    v_fma_f32 v136, v136, v158, s45
    v_fma_f32 v137, v137, v158, s45
    v_fma_f32 v138, v138, v158, s45
    v_fma_f32 v139, v139, v158, s45
    v_mul_f32 v124, v124, v28
    v_mul_f32 v125, v125, v29
    v_mul_f32 v126, v126, v30
    v_mul_f32 v127, v127, v31
    v_mul_f32 v128, v128, v32
    v_mul_f32 v129, v129, v33
    v_mul_f32 v130, v130, v34
    v_mul_f32 v131, v131, v35
    v_mul_f32 v132, v132, v36
    v_mul_f32 v133, v133, v37
    v_mul_f32 v134, v134, v38
    v_mul_f32 v135, v135, v39
    v_mul_f32 v136, v136, v40
    v_mul_f32 v137, v137, v41
    v_mul_f32 v138, v138, v42
    v_mul_f32 v139, v139, v43
    v_exp_f32 v124, v124
    v_exp_f32 v125, v125
    v_exp_f32 v126, v126
    v_exp_f32 v127, v127
    v_exp_f32 v128, v128
    v_exp_f32 v129, v129
    v_exp_f32 v130, v130
    v_exp_f32 v131, v131
    v_exp_f32 v132, v132
    v_exp_f32 v133, v133
    v_exp_f32 v134, v134
    v_exp_f32 v135, v135
    v_exp_f32 v136, v136
    v_exp_f32 v137, v137
    v_exp_f32 v138, v138
    v_exp_f32 v139, v139
    s_nop 0
    v_add_f32 v124, 1.0, v124
    v_add_f32 v125, 1.0, v125
    v_add_f32 v126, 1.0, v126
    v_add_f32 v127, 1.0, v127
    v_add_f32 v128, 1.0, v128
    v_add_f32 v129, 1.0, v129
    v_add_f32 v130, 1.0, v130
    v_add_f32 v131, 1.0, v131
    v_add_f32 v132, 1.0, v132
    v_add_f32 v133, 1.0, v133
    v_add_f32 v134, 1.0, v134
    v_add_f32 v135, 1.0, v135
    v_add_f32 v136, 1.0, v136
    v_add_f32 v137, 1.0, v137
    v_add_f32 v138, 1.0, v138
    v_add_f32 v139, 1.0, v139
    v_rcp_f32 v124, v124
    v_rcp_f32 v125, v125
    v_rcp_f32 v126, v126
    v_rcp_f32 v127, v127
    v_rcp_f32 v128, v128
    v_rcp_f32 v129, v129
    v_rcp_f32 v130, v130
    v_rcp_f32 v131, v131
    v_rcp_f32 v132, v132
    v_rcp_f32 v133, v133
    v_rcp_f32 v134, v134
    v_rcp_f32 v135, v135
    v_rcp_f32 v136, v136
    v_rcp_f32 v137, v137
    v_rcp_f32 v138, v138
    v_rcp_f32 v139, v139
    s_nop 0
    v_mul_f32 v28, v28, v124
    v_mul_f32 v29, v29, v125
    v_mul_f32 v30, v30, v126
    v_mul_f32 v31, v31, v127
    v_mul_f32 v32, v32, v128
    v_mul_f32 v33, v33, v129
    v_mul_f32 v34, v34, v130
    v_mul_f32 v35, v35, v131
    v_mul_f32 v36, v36, v132
    v_mul_f32 v37, v37, v133
    v_mul_f32 v38, v38, v134
    v_mul_f32 v39, v39, v135
    v_mul_f32 v40, v40, v136
    v_mul_f32 v41, v41, v137
    v_mul_f32 v42, v42, v138
    v_mul_f32 v43, v43, v139
    s_add_u32 s44, s43, 2048
    v_cvt_pk_bf16_f32 v68, v28, v29
    v_cvt_pk_bf16_f32 v69, v30, v31
    v_cvt_pk_bf16_f32 v70, v32, v33
    v_cvt_pk_bf16_f32 v71, v34, v35
    v_cvt_pk_bf16_f32 v72, v36, v37
    v_cvt_pk_bf16_f32 v73, v38, v39
    v_cvt_pk_bf16_f32 v74, v40, v41
    v_cvt_pk_bf16_f32 v75, v42, v43
    s_nop 1
    v_permlane32_swap_b32 v68, v70
    v_permlane32_swap_b32 v69, v71
    v_permlane32_swap_b32 v72, v74
    v_permlane32_swap_b32 v73, v75
    s_nop 1
    buffer_store_dwordx4 v[68:71], v7, s[12:15], s44 offen offset:0 sc1
    buffer_store_dwordx4 v[72:75], v7, s[12:15], s44 offen offset:1024 sc1
    ds_read_b128 v[140:143], v5 offset:256
    ds_read_b128 v[144:147], v5 offset:288
    ds_read_b128 v[148:151], v5 offset:320
    ds_read_b128 v[152:155], v5 offset:352
    v_mul_f32 v44, v44, v157
    v_mul_f32 v45, v45, v157
    v_mul_f32 v46, v46, v157
    v_mul_f32 v47, v47, v157
    v_mul_f32 v48, v48, v157
    v_mul_f32 v49, v49, v157
    v_mul_f32 v50, v50, v157
    v_mul_f32 v51, v51, v157
    v_mul_f32 v52, v52, v157
    v_mul_f32 v53, v53, v157
    v_mul_f32 v54, v54, v157
    v_mul_f32 v55, v55, v157
    v_mul_f32 v56, v56, v157
    v_mul_f32 v57, v57, v157
    v_mul_f32 v58, v58, v157
    v_mul_f32 v59, v59, v157
    s_waitcnt lgkmcnt(0)
    v_fma_f32 v44, v156, v140, v44
    v_fma_f32 v45, v156, v141, v45
    v_fma_f32 v46, v156, v142, v46
    v_fma_f32 v47, v156, v143, v47
    v_fma_f32 v48, v156, v144, v48
    v_fma_f32 v49, v156, v145, v49
    v_fma_f32 v50, v156, v146, v50
    v_fma_f32 v51, v156, v147, v51
    v_fma_f32 v52, v156, v148, v52
    v_fma_f32 v53, v156, v149, v53
    v_fma_f32 v54, v156, v150, v54
    v_fma_f32 v55, v156, v151, v55
    v_fma_f32 v56, v156, v152, v56
    v_fma_f32 v57, v156, v153, v57
    v_fma_f32 v58, v156, v154, v58
    v_fma_f32 v59, v156, v155, v59
    v_mul_f32 v124, v44, v44
    v_mul_f32 v125, v45, v45
    v_mul_f32 v126, v46, v46
    v_mul_f32 v127, v47, v47
    v_mul_f32 v128, v48, v48
    v_mul_f32 v129, v49, v49
    v_mul_f32 v130, v50, v50
    v_mul_f32 v131, v51, v51
    v_mul_f32 v132, v52, v52
    v_mul_f32 v133, v53, v53
    v_mul_f32 v134, v54, v54
    v_mul_f32 v135, v55, v55
    v_mul_f32 v136, v56, v56
    v_mul_f32 v137, v57, v57
    v_mul_f32 v138, v58, v58
    v_mul_f32 v139, v59, v59
    v_fma_f32 v124, v124, v158, s45
    v_fma_f32 v125, v125, v158, s45
    v_fma_f32 v126, v126, v158, s45
    v_fma_f32 v127, v127, v158, s45
    v_fma_f32 v128, v128, v158, s45
    v_fma_f32 v129, v129, v158, s45
    v_fma_f32 v130, v130, v158, s45
    v_fma_f32 v131, v131, v158, s45
    v_fma_f32 v132, v132, v158, s45
    v_fma_f32 v133, v133, v158, s45
    v_fma_f32 v134, v134, v158, s45
    v_fma_f32 v135, v135, v158, s45
    v_fma_f32 v136, v136, v158, s45
    v_fma_f32 v137, v137, v158, s45
    v_fma_f32 v138, v138, v158, s45
    v_fma_f32 v139, v139, v158, s45
    v_mul_f32 v124, v124, v44
    v_mul_f32 v125, v125, v45
    v_mul_f32 v126, v126, v46
    v_mul_f32 v127, v127, v47
    v_mul_f32 v128, v128, v48
    v_mul_f32 v129, v129, v49
    v_mul_f32 v130, v130, v50
    v_mul_f32 v131, v131, v51
    v_mul_f32 v132, v132, v52
    v_mul_f32 v133, v133, v53
    v_mul_f32 v134, v134, v54
    v_mul_f32 v135, v135, v55
    v_mul_f32 v136, v136, v56
    v_mul_f32 v137, v137, v57
    v_mul_f32 v138, v138, v58
    v_mul_f32 v139, v139, v59
    v_exp_f32 v124, v124
    v_exp_f32 v125, v125
    v_exp_f32 v126, v126
    v_exp_f32 v127, v127
    v_exp_f32 v128, v128
    v_exp_f32 v129, v129
    v_exp_f32 v130, v130
    v_exp_f32 v131, v131
    v_exp_f32 v132, v132
    v_exp_f32 v133, v133
    v_exp_f32 v134, v134
    v_exp_f32 v135, v135
    v_exp_f32 v136, v136
    v_exp_f32 v137, v137
    v_exp_f32 v138, v138
    v_exp_f32 v139, v139
    s_nop 0
    v_add_f32 v124, 1.0, v124
    v_add_f32 v125, 1.0, v125
    v_add_f32 v126, 1.0, v126
    v_add_f32 v127, 1.0, v127
    v_add_f32 v128, 1.0, v128
    v_add_f32 v129, 1.0, v129
    v_add_f32 v130, 1.0, v130
    v_add_f32 v131, 1.0, v131
    v_add_f32 v132, 1.0, v132
    v_add_f32 v133, 1.0, v133
    v_add_f32 v134, 1.0, v134
    v_add_f32 v135, 1.0, v135
    v_add_f32 v136, 1.0, v136
    v_add_f32 v137, 1.0, v137
    v_add_f32 v138, 1.0, v138
    v_add_f32 v139, 1.0, v139
    v_rcp_f32 v124, v124
    v_rcp_f32 v125, v125
    v_rcp_f32 v126, v126
    v_rcp_f32 v127, v127
    v_rcp_f32 v128, v128
    v_rcp_f32 v129, v129
    v_rcp_f32 v130, v130
    v_rcp_f32 v131, v131
    v_rcp_f32 v132, v132
    v_rcp_f32 v133, v133
    v_rcp_f32 v134, v134
    v_rcp_f32 v135, v135
    v_rcp_f32 v136, v136
    v_rcp_f32 v137, v137
    v_rcp_f32 v138, v138
    v_rcp_f32 v139, v139
    s_nop 0
    v_mul_f32 v44, v44, v124
    v_mul_f32 v45, v45, v125
    v_mul_f32 v46, v46, v126
    v_mul_f32 v47, v47, v127
    v_mul_f32 v48, v48, v128
    v_mul_f32 v49, v49, v129
    v_mul_f32 v50, v50, v130
    v_mul_f32 v51, v51, v131
    v_mul_f32 v52, v52, v132
    v_mul_f32 v53, v53, v133
    v_mul_f32 v54, v54, v134
    v_mul_f32 v55, v55, v135
    v_mul_f32 v56, v56, v136
    v_mul_f32 v57, v57, v137
    v_mul_f32 v58, v58, v138
    v_mul_f32 v59, v59, v139
    s_add_u32 s44, s43, 4096
    v_cvt_pk_bf16_f32 v60, v44, v45
    v_cvt_pk_bf16_f32 v61, v46, v47
    v_cvt_pk_bf16_f32 v62, v48, v49
    v_cvt_pk_bf16_f32 v63, v50, v51
    v_cvt_pk_bf16_f32 v64, v52, v53
    v_cvt_pk_bf16_f32 v65, v54, v55
    v_cvt_pk_bf16_f32 v66, v56, v57
    v_cvt_pk_bf16_f32 v67, v58, v59
    s_nop 1
    v_permlane32_swap_b32 v60, v62
    v_permlane32_swap_b32 v61, v63
    v_permlane32_swap_b32 v64, v66
    v_permlane32_swap_b32 v65, v67
    s_nop 1
    buffer_store_dwordx4 v[60:63], v7, s[12:15], s44 offen offset:0 sc1
    buffer_store_dwordx4 v[64:67], v7, s[12:15], s44 offen offset:1024 sc1
g3_skip_357:
    s_lshl_b32 s44, s37, 1
    s_waitcnt vmcnt(0)
    v_mov_b32 v2, 163648
    v_mov_b32 v3, 1
    s_waitcnt lgkmcnt(0)
    s_mov_b64 exec, 1
    ds_add_u32 v2, v3 offset:24
Lsb_359:
    ds_read_b32 v3, v2 offset:24
    s_waitcnt lgkmcnt(0)
    v_readfirstlane_b32 s46, v3
    s_cmp_ge_u32 s46, 4
    s_cbranch_scc1 Lsbd_360
    s_sleep 1
    s_add_u32 s92, s92, 1
    s_cmp_gt_u32 s92, 0x400000
    s_cbranch_scc1 k_end
    s_branch Lsb_359
Lsbd_360:
    s_mov_b64 exec, -1
    s_cmp_lg_u32 s36, 0
    s_cbranch_scc1 Lsig_358
    v_lshrrev_b32 v2, 3, v1
    v_add_u32 v2, s44, v2
    v_and_b32 v3, 3, v2
    v_lshrrev_b32 v2, 2, v2
    v_lshl_add_u32 v2, v3, 3, v2
    v_and_b32 v3, 7, v1
    v_lshl_add_u32 v2, v3, 5, v2
    v_lshlrev_b32 v2, 7, v2
    v_mov_b32 v3, 1
    s_mov_b32 s43, 0x168000c
    s_mov_b32 exec_lo, 0xffff
    s_mov_b32 exec_hi, 0x0
    buffer_atomic_add v3, v2, s[12:15], s43 offen sc1
    s_mov_b64 exec, -1
Lsig_358:
k_g4:
    s_and_b32 s43, s2, 7
    s_lshr_b32 s44, s2, 3
    s_lshl_b32 s37, s43, 2
    s_and_b32 s45, s44, 3
    s_add_u32 s37, s37, s45
    s_lshr_b32 s38, s44, 2
    s_mov_b32 s8, s86
    s_and_b32 s9, s87, 0xffff
    s_mov_b32 s10, 0x158000
    s_mov_b32 s11, 0x20000
    s_mov_b32 s20, s28
    s_and_b32 s21, s29, 0xffff
    s_mov_b32 s22, 0x80000
    s_mov_b32 s23, 0x20000
    s_mov_b32 s16, s24
    s_and_b32 s17, s25, 0xffff
    s_mov_b32 s18, 0x200000
    s_mov_b32 s19, 0x20000
    s_lshr_b32 s51, s36, 1
    s_and_b32 s52, s36, 1
    s_mul_i32 s50, s36, 14336
    s_add_u32 s50, s50, 98304
    v_lshlrev_b32 v7, 4, v1
    v_lshrrev_b32 v8, 5, v1
    v_lshlrev_b32 v8, 9, v8
    v_bfe_u32 v4, v1, 2, 2
    v_lshl_add_u32 v8, v4, 6, v8
    v_bfe_u32 v4, v1, 4, 1
    v_lshl_add_u32 v8, v4, 5, v8
    v_and_b32 v4, 3, v1
    v_lshl_add_u32 v8, v4, 3, v8
    v_add_u32 v8, s50, v8
    v_lshrrev_b32 v4, 2, v1
    s_mov_b32 s48, 1024
    v_mul_lo_u32 v9, v4, s48
    v_and_b32 v4, 3, v1
    v_lshl_add_u32 v9, v4, 4, v9
    s_lshl_b32 s42, s36, 14
    s_lshl_b32 s43, s38, 7
    s_add_u32 s42, s42, s43
    s_lshl_b32 s43, s52, 6
    s_xor_b32 s44, s43, 64
    s_add_u32 s47, s42, s44
    s_add_u32 s42, s42, s43
    s_lshl_b32 s43, s37, 1
    s_add_u32 s44, s43, s51
    s_mul_i32 s40, s44, 88064
    s_xor_b32 s44, s44, 1
    s_mul_i32 s41, s44, 88064
    s_lshl_b32 s43, s36, 10
    s_add_u32 s43, s43, 0xc00000
    s_add_u32 s40, s40, s43
    s_add_u32 s41, s41, s43
    s_lshl_b32 s43, s37, 1
    s_add_u32 s44, s43, s51
    s_mul_i32 s55, s44, 32768
    s_xor_b32 s44, s44, 1
    s_mul_i32 s56, s44, 32768
    s_lshl_b32 s43, s36, 10
    s_add_u32 s43, s43, 0xa00000
    s_add_u32 s55, s55, s43
    s_add_u32 s56, s56, s43
    s_cmp_lt_u32 s36, 2
    s_cselect_b32 s57, 22, 21
    s_and_b32 s43, s37, 3
    s_lshl_b32 s43, s43, 1
    s_add_u32 s43, s43, s38
    s_and_b32 s60, s43, 7
    s_mul_i32 s60, s60, 5
    s_lshr_b32 s60, s60, 1
    s_mov_b32 s61, s60
    s_and_b32 s43, s37, 3
    s_lshl_b32 s43, s43, 1
    s_add_u32 s43, s43, s38
    s_and_b32 s62, s43, 7
    s_mov_b32 s63, s62
    v_mov_b32 v2, 163584
    v_mov_b32 v3, 0x8
    s_mov_b64 exec, 1
    ds_or_b32 v2, v3 offset:12
    s_mov_b64 exec, -1
    v_and_b32 v6, 31, v1
    v_lshlrev_b32 v6, 10, v6
    v_lshrrev_b32 v4, 5, v1
    v_lshl_add_u32 v6, v4, 3, v6
    s_lshl_b32 s43, s37, 16
    s_lshl_b32 s44, s51, 15
    s_add_u32 s43, s43, s44
    s_lshl_b32 s44, s38, 7
    s_add_u32 s43, s43, s44
    s_lshl_b32 s44, s52, 6
    s_add_u32 s43, s43, s44
    buffer_load_dwordx2 v[160:161], v6, s[16:19], s43 offen offset:0
    buffer_load_dwordx2 v[162:163], v6, s[16:19], s43 offen offset:16
    buffer_load_dwordx2 v[164:165], v6, s[16:19], s43 offen offset:32
    buffer_load_dwordx2 v[166:167], v6, s[16:19], s43 offen offset:48
    v_and_b32 v148, 31, v1
    v_lshlrev_b32 v148, 4, v148
    v_lshrrev_b32 v4, 5, v1
    v_lshl_add_u32 v148, v4, 3, v148
    s_lshl_b32 s43, s37, 1
    s_add_u32 s43, s43, s51
    s_mul_i32 s43, s43, 32
    s_lshl_b32 s46, s38, 2
    s_add_u32 s43, s43, s46
    s_lshl_b32 s46, s52, 1
    s_add_u32 s43, s43, s46
    s_lshl_b32 s43, s43, 10
    s_add_u32 s43, s43, 0x800000
    buffer_load_dwordx2 v[152:153], v148, s[12:15], s43 offen offset:0 sc1
    buffer_load_dwordx2 v[154:155], v148, s[12:15], s43 offen offset:512 sc1
    buffer_load_dwordx2 v[156:157], v148, s[12:15], s43 offen offset:1024 sc1
    buffer_load_dwordx2 v[158:159], v148, s[12:15], s43 offen offset:1536 sc1
    s_add_u32 m0, s50, 0
    s_lshl_b32 s48, s61, 16
    s_add_u32 s49, s42, s48
    buffer_load_dwordx4 v9, s[8:11], s49 offen lds
    s_add_u32 m0, s50, 1024
    s_lshl_b32 s48, s61, 16
    s_add_u32 s49, s47, s48
    buffer_load_dwordx4 v9, s[8:11], s49 offen lds
    s_add_u32 s61, s61, 1
    s_cmp_lt_u32 s61, s57
    s_cselect_b32 s61, s61, 0
    s_add_u32 m0, s50, 2048
    s_lshl_b32 s48, s61, 16
    s_add_u32 s49, s42, s48
    buffer_load_dwordx4 v9, s[8:11], s49 offen lds
    s_add_u32 m0, s50, 3072
    s_lshl_b32 s48, s61, 16
    s_add_u32 s49, s47, s48
    buffer_load_dwordx4 v9, s[8:11], s49 offen lds
    s_add_u32 s61, s61, 1
    s_cmp_lt_u32 s61, s57
    s_cselect_b32 s61, s61, 0
    s_add_u32 m0, s50, 4096
    s_lshl_b32 s48, s61, 16
    s_add_u32 s49, s42, s48
    buffer_load_dwordx4 v9, s[8:11], s49 offen lds
    s_add_u32 m0, s50, 5120
    s_lshl_b32 s48, s61, 16
    s_add_u32 s49, s47, s48
    buffer_load_dwordx4 v9, s[8:11], s49 offen lds
    s_add_u32 s61, s61, 1
    s_cmp_lt_u32 s61, s57
    s_cselect_b32 s61, s61, 0
    s_add_u32 m0, s50, 6144
    s_lshl_b32 s48, s61, 16
    s_add_u32 s49, s42, s48
    buffer_load_dwordx4 v9, s[8:11], s49 offen lds
    s_add_u32 m0, s50, 7168
    s_lshl_b32 s48, s61, 16
    s_add_u32 s49, s47, s48
    buffer_load_dwordx4 v9, s[8:11], s49 offen lds
    s_add_u32 s61, s61, 1
    s_cmp_lt_u32 s61, s57
    s_cselect_b32 s61, s61, 0
    s_add_u32 m0, s50, 8192
    s_lshl_b32 s48, s61, 16
    s_add_u32 s49, s42, s48
    buffer_load_dwordx4 v9, s[8:11], s49 offen lds
    s_add_u32 m0, s50, 9216
    s_lshl_b32 s48, s61, 16
    s_add_u32 s49, s47, s48
    buffer_load_dwordx4 v9, s[8:11], s49 offen lds
    s_add_u32 s61, s61, 1
    s_cmp_lt_u32 s61, s57
    s_cselect_b32 s61, s61, 0
    s_add_u32 m0, s50, 10240
    s_lshl_b32 s48, s61, 16
    s_add_u32 s49, s42, s48
    buffer_load_dwordx4 v9, s[8:11], s49 offen lds
    s_add_u32 m0, s50, 11264
    s_lshl_b32 s48, s61, 16
    s_add_u32 s49, s47, s48
    buffer_load_dwordx4 v9, s[8:11], s49 offen lds
    s_add_u32 s61, s61, 1
    s_cmp_lt_u32 s61, s57
    s_cselect_b32 s61, s61, 0
    s_add_u32 m0, s50, 12288
    s_lshl_b32 s48, s61, 16
    s_add_u32 s49, s42, s48
    buffer_load_dwordx4 v9, s[8:11], s49 offen lds
    s_add_u32 m0, s50, 13312
    s_lshl_b32 s48, s61, 16
    s_add_u32 s49, s47, s48
    buffer_load_dwordx4 v9, s[8:11], s49 offen lds
    s_add_u32 s61, s61, 1
    s_cmp_lt_u32 s61, s57
    s_cselect_b32 s61, s61, 0
    s_waitcnt vmcnt(14)
    v_lshlrev_b32 v12, 16, v160
    v_and_b32 v13, 0xffff0000, v160
    v_lshlrev_b32 v4, 16, v152
    v_and_b32 v5, 0xffff0000, v152
    v_add_f32 v12, v12, v4
    v_add_f32 v13, v13, v5
    v_lshlrev_b32 v14, 16, v161
    v_and_b32 v15, 0xffff0000, v161
    v_lshlrev_b32 v4, 16, v153
    v_and_b32 v5, 0xffff0000, v153
    v_add_f32 v14, v14, v4
    v_add_f32 v15, v15, v5
    v_lshlrev_b32 v16, 16, v162
    v_and_b32 v17, 0xffff0000, v162
    v_lshlrev_b32 v4, 16, v154
    v_and_b32 v5, 0xffff0000, v154
    v_add_f32 v16, v16, v4
    v_add_f32 v17, v17, v5
    v_lshlrev_b32 v18, 16, v163
    v_and_b32 v19, 0xffff0000, v163
    v_lshlrev_b32 v4, 16, v155
    v_and_b32 v5, 0xffff0000, v155
    v_add_f32 v18, v18, v4
    v_add_f32 v19, v19, v5
    v_lshlrev_b32 v20, 16, v164
    v_and_b32 v21, 0xffff0000, v164
    v_lshlrev_b32 v4, 16, v156
    v_and_b32 v5, 0xffff0000, v156
    v_add_f32 v20, v20, v4
    v_add_f32 v21, v21, v5
    v_lshlrev_b32 v22, 16, v165
    v_and_b32 v23, 0xffff0000, v165
    v_lshlrev_b32 v4, 16, v157
    v_and_b32 v5, 0xffff0000, v157
    v_add_f32 v22, v22, v4
    v_add_f32 v23, v23, v5
    v_lshlrev_b32 v24, 16, v166
    v_and_b32 v25, 0xffff0000, v166
    v_lshlrev_b32 v4, 16, v158
    v_and_b32 v5, 0xffff0000, v158
    v_add_f32 v24, v24, v4
    v_add_f32 v25, v25, v5
    v_lshlrev_b32 v26, 16, v167
    v_and_b32 v27, 0xffff0000, v167
    v_lshlrev_b32 v4, 16, v159
    v_and_b32 v5, 0xffff0000, v159
    v_add_f32 v26, v26, v4
    v_add_f32 v27, v27, v5
    v_mov_b32 v2, 163584
    v_mov_b32 v3, 0x8
    s_mov_b64 exec, 1
    ds_or_b32 v2, v3 offset:12
    s_mov_b64 exec, -1
Lws_361:
    ds_read_b32 v3, v2 offset:0
    s_waitcnt lgkmcnt(0)
    v_readfirstlane_b32 s46, v3
    s_and_b32 s46, s46, 0x8
    s_cmp_eq_u32 s46, 0x8
    s_cbranch_scc1 Lwd_362
    s_sleep 4
    s_add_u32 s92, s92, 1
    s_cmp_gt_u32 s92, 0x400000
    s_cbranch_scc1 k_end
    s_branch Lws_361
Lwd_362:
    s_lshl_b32 s49, s60, 12
    s_add_u32 s48, s40, s49
    buffer_load_dwordx4 v[76:79], v7, s[12:15], s48 offen sc1
    s_lshl_b32 s49, s60, 12
    s_add_u32 s48, s41, s49
    buffer_load_dwordx4 v[80:83], v7, s[12:15], s48 offen sc1
    s_add_u32 s60, s60, 1
    s_cmp_lt_u32 s60, s57
    s_cselect_b32 s60, s60, 0
    s_lshl_b32 s49, s60, 12
    s_add_u32 s48, s40, s49
    buffer_load_dwordx4 v[84:87], v7, s[12:15], s48 offen sc1
    s_lshl_b32 s49, s60, 12
    s_add_u32 s48, s41, s49
    buffer_load_dwordx4 v[88:91], v7, s[12:15], s48 offen sc1
    s_add_u32 s60, s60, 1
    s_cmp_lt_u32 s60, s57
    s_cselect_b32 s60, s60, 0
    s_lshl_b32 s49, s60, 12
    s_add_u32 s48, s40, s49
    buffer_load_dwordx4 v[92:95], v7, s[12:15], s48 offen sc1
    s_lshl_b32 s49, s60, 12
    s_add_u32 s48, s41, s49
    buffer_load_dwordx4 v[96:99], v7, s[12:15], s48 offen sc1
    s_add_u32 s60, s60, 1
    s_cmp_lt_u32 s60, s57
    s_cselect_b32 s60, s60, 0
    s_lshl_b32 s49, s60, 12
    s_add_u32 s48, s40, s49
    buffer_load_dwordx4 v[100:103], v7, s[12:15], s48 offen sc1
    s_lshl_b32 s49, s60, 12
    s_add_u32 s48, s41, s49
    buffer_load_dwordx4 v[104:107], v7, s[12:15], s48 offen sc1
    s_add_u32 s60, s60, 1
    s_cmp_lt_u32 s60, s57
    s_cselect_b32 s60, s60, 0
    s_lshl_b32 s49, s60, 12
    s_add_u32 s48, s40, s49
    buffer_load_dwordx4 v[108:111], v7, s[12:15], s48 offen sc1
    s_lshl_b32 s49, s60, 12
    s_add_u32 s48, s41, s49
    buffer_load_dwordx4 v[112:115], v7, s[12:15], s48 offen sc1
    s_add_u32 s60, s60, 1
    s_cmp_lt_u32 s60, s57
    s_cselect_b32 s60, s60, 0
    s_lshl_b32 s49, s60, 12
    s_add_u32 s48, s40, s49
    buffer_load_dwordx4 v[116:119], v7, s[12:15], s48 offen sc1
    s_lshl_b32 s49, s60, 12
    s_add_u32 s48, s41, s49
    buffer_load_dwordx4 v[120:123], v7, s[12:15], s48 offen sc1
    s_add_u32 s60, s60, 1
    s_cmp_lt_u32 s60, s57
    s_cselect_b32 s60, s60, 0
    s_lshl_b32 s49, s60, 12
    s_add_u32 s48, s40, s49
    buffer_load_dwordx4 v[124:127], v7, s[12:15], s48 offen sc1
    s_lshl_b32 s49, s60, 12
    s_add_u32 s48, s41, s49
    buffer_load_dwordx4 v[128:131], v7, s[12:15], s48 offen sc1
    s_add_u32 s60, s60, 1
    s_cmp_lt_u32 s60, s57
    s_cselect_b32 s60, s60, 0
    s_waitcnt vmcnt(26)
    ds_read_b64_tr_b16 v[132:133], v8 offset:0
    ds_read_b64_tr_b16 v[134:135], v8 offset:256
    ds_read_b64_tr_b16 v[136:137], v8 offset:1024
    ds_read_b64_tr_b16 v[138:139], v8 offset:1280
    s_waitcnt vmcnt(24)
    ds_read_b64_tr_b16 v[140:141], v8 offset:2048
    ds_read_b64_tr_b16 v[142:143], v8 offset:2304
    ds_read_b64_tr_b16 v[144:145], v8 offset:3072
    ds_read_b64_tr_b16 v[146:147], v8 offset:3328
    s_waitcnt vmcnt(12) lgkmcnt(4)
    v_mfma_f32_32x32x16_bf16 v[12:27], v[132:135], v[76:79], v[12:27]
    s_add_u32 m0, s50, 0
    s_lshl_b32 s48, s61, 16
    s_add_u32 s49, s42, s48
    buffer_load_dwordx4 v9, s[8:11], s49 offen lds
    v_mfma_f32_32x32x16_bf16 v[28:43], v[136:139], v[76:79], 0
    s_add_u32 m0, s50, 1024
    s_lshl_b32 s48, s61, 16
    s_add_u32 s49, s47, s48
    buffer_load_dwordx4 v9, s[8:11], s49 offen lds
    s_add_u32 s61, s61, 1
    s_cmp_lt_u32 s61, s57
    s_cselect_b32 s61, s61, 0
    v_mfma_f32_32x32x16_bf16 v[44:59], v[132:135], v[80:83], 0
    s_lshl_b32 s49, s60, 12
    s_add_u32 s48, s40, s49
    buffer_load_dwordx4 v[76:79], v7, s[12:15], s48 offen sc1
    v_mfma_f32_32x32x16_bf16 v[60:75], v[136:139], v[80:83], 0
    s_lshl_b32 s49, s60, 12
    s_add_u32 s48, s41, s49
    buffer_load_dwordx4 v[80:83], v7, s[12:15], s48 offen sc1
    s_add_u32 s60, s60, 1
    s_cmp_lt_u32 s60, s57
    s_cselect_b32 s60, s60, 0
    s_waitcnt vmcnt(26)
    ds_read_b64_tr_b16 v[132:133], v8 offset:4096
    ds_read_b64_tr_b16 v[134:135], v8 offset:4352
    ds_read_b64_tr_b16 v[136:137], v8 offset:5120
    ds_read_b64_tr_b16 v[138:139], v8 offset:5376
    s_waitcnt vmcnt(14) lgkmcnt(4)
    v_mfma_f32_32x32x16_bf16 v[12:27], v[140:143], v[84:87], v[12:27]
    s_add_u32 m0, s50, 2048
    s_lshl_b32 s48, s61, 16
    s_add_u32 s49, s42, s48
    buffer_load_dwordx4 v9, s[8:11], s49 offen lds
    v_mfma_f32_32x32x16_bf16 v[28:43], v[144:147], v[84:87], v[28:43]
    s_add_u32 m0, s50, 3072
    s_lshl_b32 s48, s61, 16
    s_add_u32 s49, s47, s48
    buffer_load_dwordx4 v9, s[8:11], s49 offen lds
    s_add_u32 s61, s61, 1
    s_cmp_lt_u32 s61, s57
    s_cselect_b32 s61, s61, 0
    v_mfma_f32_32x32x16_bf16 v[44:59], v[140:143], v[88:91], v[44:59]
    s_lshl_b32 s49, s60, 12
    s_add_u32 s48, s40, s49
    buffer_load_dwordx4 v[84:87], v7, s[12:15], s48 offen sc1
    v_mfma_f32_32x32x16_bf16 v[60:75], v[144:147], v[88:91], v[60:75]
    s_lshl_b32 s49, s60, 12
    s_add_u32 s48, s41, s49
    buffer_load_dwordx4 v[88:91], v7, s[12:15], s48 offen sc1
    s_add_u32 s60, s60, 1
    s_cmp_lt_u32 s60, s57
    s_cselect_b32 s60, s60, 0
    s_waitcnt vmcnt(28)
    ds_read_b64_tr_b16 v[140:141], v8 offset:6144
    ds_read_b64_tr_b16 v[142:143], v8 offset:6400
    ds_read_b64_tr_b16 v[144:145], v8 offset:7168
    ds_read_b64_tr_b16 v[146:147], v8 offset:7424
    s_waitcnt vmcnt(16) lgkmcnt(4)
    v_mfma_f32_32x32x16_bf16 v[12:27], v[132:135], v[92:95], v[12:27]
    s_add_u32 m0, s50, 4096
    s_lshl_b32 s48, s61, 16
    s_add_u32 s49, s42, s48
    buffer_load_dwordx4 v9, s[8:11], s49 offen lds
    v_mfma_f32_32x32x16_bf16 v[28:43], v[136:139], v[92:95], v[28:43]
    s_add_u32 m0, s50, 5120
    s_lshl_b32 s48, s61, 16
    s_add_u32 s49, s47, s48
    buffer_load_dwordx4 v9, s[8:11], s49 offen lds
    s_add_u32 s61, s61, 1
    s_cmp_lt_u32 s61, s57
    s_cselect_b32 s61, s61, 0
    v_mfma_f32_32x32x16_bf16 v[44:59], v[132:135], v[96:99], v[44:59]
    s_lshl_b32 s49, s60, 12
    s_add_u32 s48, s40, s49
    buffer_load_dwordx4 v[92:95], v7, s[12:15], s48 offen sc1
    v_mfma_f32_32x32x16_bf16 v[60:75], v[136:139], v[96:99], v[60:75]
    s_lshl_b32 s49, s60, 12
    s_add_u32 s48, s41, s49
    buffer_load_dwordx4 v[96:99], v7, s[12:15], s48 offen sc1
    s_add_u32 s60, s60, 1
    s_cmp_lt_u32 s60, s57
    s_cselect_b32 s60, s60, 0
    s_waitcnt vmcnt(30)
    ds_read_b64_tr_b16 v[132:133], v8 offset:8192
    ds_read_b64_tr_b16 v[134:135], v8 offset:8448
    ds_read_b64_tr_b16 v[136:137], v8 offset:9216
    ds_read_b64_tr_b16 v[138:139], v8 offset:9472
    s_waitcnt vmcnt(18) lgkmcnt(4)
    v_mfma_f32_32x32x16_bf16 v[12:27], v[140:143], v[100:103], v[12:27]
    s_add_u32 m0, s50, 6144
    s_lshl_b32 s48, s61, 16
    s_add_u32 s49, s42, s48
    buffer_load_dwordx4 v9, s[8:11], s49 offen lds
    v_mfma_f32_32x32x16_bf16 v[28:43], v[144:147], v[100:103], v[28:43]
    s_add_u32 m0, s50, 7168
    s_lshl_b32 s48, s61, 16
    s_add_u32 s49, s47, s48
    buffer_load_dwordx4 v9, s[8:11], s49 offen lds
    s_add_u32 s61, s61, 1
    s_cmp_lt_u32 s61, s57
    s_cselect_b32 s61, s61, 0
    v_mfma_f32_32x32x16_bf16 v[44:59], v[140:143], v[104:107], v[44:59]
    s_lshl_b32 s49, s60, 12
    s_add_u32 s48, s40, s49
    buffer_load_dwordx4 v[100:103], v7, s[12:15], s48 offen sc1
    v_mfma_f32_32x32x16_bf16 v[60:75], v[144:147], v[104:107], v[60:75]
    s_lshl_b32 s49, s60, 12
    s_add_u32 s48, s41, s49
    buffer_load_dwordx4 v[104:107], v7, s[12:15], s48 offen sc1
    s_add_u32 s60, s60, 1
    s_cmp_lt_u32 s60, s57
    s_cselect_b32 s60, s60, 0
    s_waitcnt vmcnt(32)
    ds_read_b64_tr_b16 v[140:141], v8 offset:10240
    ds_read_b64_tr_b16 v[142:143], v8 offset:10496
    ds_read_b64_tr_b16 v[144:145], v8 offset:11264
    ds_read_b64_tr_b16 v[146:147], v8 offset:11520
    s_waitcnt vmcnt(20) lgkmcnt(4)
    v_mfma_f32_32x32x16_bf16 v[12:27], v[132:135], v[108:111], v[12:27]
    s_add_u32 m0, s50, 8192
    s_lshl_b32 s48, s61, 16
    s_add_u32 s49, s42, s48
    buffer_load_dwordx4 v9, s[8:11], s49 offen lds
    v_mfma_f32_32x32x16_bf16 v[28:43], v[136:139], v[108:111], v[28:43]
    s_add_u32 m0, s50, 9216
    s_lshl_b32 s48, s61, 16
    s_add_u32 s49, s47, s48
    buffer_load_dwordx4 v9, s[8:11], s49 offen lds
    s_add_u32 s61, s61, 1
    s_cmp_lt_u32 s61, s57
    s_cselect_b32 s61, s61, 0
    v_mfma_f32_32x32x16_bf16 v[44:59], v[132:135], v[112:115], v[44:59]
    s_lshl_b32 s49, s60, 12
    s_add_u32 s48, s40, s49
    buffer_load_dwordx4 v[108:111], v7, s[12:15], s48 offen sc1
    v_mfma_f32_32x32x16_bf16 v[60:75], v[136:139], v[112:115], v[60:75]
    s_lshl_b32 s49, s60, 12
    s_add_u32 s48, s41, s49
    buffer_load_dwordx4 v[112:115], v7, s[12:15], s48 offen sc1
    s_add_u32 s60, s60, 1
    s_cmp_lt_u32 s60, s57
    s_cselect_b32 s60, s60, 0
    s_waitcnt vmcnt(34)
    ds_read_b64_tr_b16 v[132:133], v8 offset:12288
    ds_read_b64_tr_b16 v[134:135], v8 offset:12544
    ds_read_b64_tr_b16 v[136:137], v8 offset:13312
    ds_read_b64_tr_b16 v[138:139], v8 offset:13568
    s_waitcnt vmcnt(22) lgkmcnt(4)
    v_mfma_f32_32x32x16_bf16 v[12:27], v[140:143], v[116:119], v[12:27]
    s_add_u32 m0, s50, 10240
    s_lshl_b32 s48, s61, 16
    s_add_u32 s49, s42, s48
    buffer_load_dwordx4 v9, s[8:11], s49 offen lds
    v_mfma_f32_32x32x16_bf16 v[28:43], v[144:147], v[116:119], v[28:43]
    s_add_u32 m0, s50, 11264
    s_lshl_b32 s48, s61, 16
    s_add_u32 s49, s47, s48
    buffer_load_dwordx4 v9, s[8:11], s49 offen lds
    s_add_u32 s61, s61, 1
    s_cmp_lt_u32 s61, s57
    s_cselect_b32 s61, s61, 0
    v_mfma_f32_32x32x16_bf16 v[44:59], v[140:143], v[120:123], v[44:59]
    s_lshl_b32 s49, s60, 12
    s_add_u32 s48, s40, s49
    buffer_load_dwordx4 v[116:119], v7, s[12:15], s48 offen sc1
    v_mfma_f32_32x32x16_bf16 v[60:75], v[144:147], v[120:123], v[60:75]
    s_lshl_b32 s49, s60, 12
    s_add_u32 s48, s41, s49
    buffer_load_dwordx4 v[120:123], v7, s[12:15], s48 offen sc1
    s_add_u32 s60, s60, 1
    s_cmp_lt_u32 s60, s57
    s_cselect_b32 s60, s60, 0
    s_waitcnt vmcnt(22)
    ds_read_b64_tr_b16 v[140:141], v8 offset:0
    ds_read_b64_tr_b16 v[142:143], v8 offset:256
    ds_read_b64_tr_b16 v[144:145], v8 offset:1024
    ds_read_b64_tr_b16 v[146:147], v8 offset:1280
    s_waitcnt vmcnt(24) lgkmcnt(4)
    v_mfma_f32_32x32x16_bf16 v[12:27], v[132:135], v[124:127], v[12:27]
    s_add_u32 m0, s50, 12288
    s_lshl_b32 s48, s61, 16
    s_add_u32 s49, s42, s48
    buffer_load_dwordx4 v9, s[8:11], s49 offen lds
    v_mfma_f32_32x32x16_bf16 v[28:43], v[136:139], v[124:127], v[28:43]
    s_add_u32 m0, s50, 13312
    s_lshl_b32 s48, s61, 16
    s_add_u32 s49, s47, s48
    buffer_load_dwordx4 v9, s[8:11], s49 offen lds
    s_add_u32 s61, s61, 1
    s_cmp_lt_u32 s61, s57
    s_cselect_b32 s61, s61, 0
    v_mfma_f32_32x32x16_bf16 v[44:59], v[132:135], v[128:131], v[44:59]
    s_lshl_b32 s49, s60, 12
    s_add_u32 s48, s40, s49
    buffer_load_dwordx4 v[124:127], v7, s[12:15], s48 offen sc1
    v_mfma_f32_32x32x16_bf16 v[60:75], v[136:139], v[128:131], v[60:75]
    s_lshl_b32 s49, s60, 12
    s_add_u32 s48, s41, s49
    buffer_load_dwordx4 v[128:131], v7, s[12:15], s48 offen sc1
    s_add_u32 s60, s60, 1
    s_cmp_lt_u32 s60, s57
    s_cselect_b32 s60, s60, 0
    s_waitcnt vmcnt(22)
    ds_read_b64_tr_b16 v[132:133], v8 offset:2048
    ds_read_b64_tr_b16 v[134:135], v8 offset:2304
    ds_read_b64_tr_b16 v[136:137], v8 offset:3072
    ds_read_b64_tr_b16 v[138:139], v8 offset:3328
    s_waitcnt vmcnt(24) lgkmcnt(4)
    v_mfma_f32_32x32x16_bf16 v[12:27], v[140:143], v[76:79], v[12:27]
    s_add_u32 m0, s50, 0
    s_lshl_b32 s48, s61, 16
    s_add_u32 s49, s42, s48
    buffer_load_dwordx4 v9, s[8:11], s49 offen lds
    v_mfma_f32_32x32x16_bf16 v[28:43], v[144:147], v[76:79], v[28:43]
    s_add_u32 m0, s50, 1024
    s_lshl_b32 s48, s61, 16
    s_add_u32 s49, s47, s48
    buffer_load_dwordx4 v9, s[8:11], s49 offen lds
    s_add_u32 s61, s61, 1
    s_cmp_lt_u32 s61, s57
    s_cselect_b32 s61, s61, 0
    v_mfma_f32_32x32x16_bf16 v[44:59], v[140:143], v[80:83], v[44:59]
    s_lshl_b32 s49, s60, 12
    s_add_u32 s48, s40, s49
    buffer_load_dwordx4 v[76:79], v7, s[12:15], s48 offen sc1
    v_mfma_f32_32x32x16_bf16 v[60:75], v[144:147], v[80:83], v[60:75]
    s_lshl_b32 s49, s60, 12
    s_add_u32 s48, s41, s49
    buffer_load_dwordx4 v[80:83], v7, s[12:15], s48 offen sc1
    s_add_u32 s60, s60, 1
    s_cmp_lt_u32 s60, s57
    s_cselect_b32 s60, s60, 0
    s_waitcnt vmcnt(22)
    ds_read_b64_tr_b16 v[140:141], v8 offset:4096
    ds_read_b64_tr_b16 v[142:143], v8 offset:4352
    ds_read_b64_tr_b16 v[144:145], v8 offset:5120
    ds_read_b64_tr_b16 v[146:147], v8 offset:5376
    s_waitcnt vmcnt(24) lgkmcnt(4)
    v_mfma_f32_32x32x16_bf16 v[12:27], v[132:135], v[84:87], v[12:27]
    s_add_u32 m0, s50, 2048
    s_lshl_b32 s48, s61, 16
    s_add_u32 s49, s42, s48
    buffer_load_dwordx4 v9, s[8:11], s49 offen lds
    v_mfma_f32_32x32x16_bf16 v[28:43], v[136:139], v[84:87], v[28:43]
    s_add_u32 m0, s50, 3072
    s_lshl_b32 s48, s61, 16
    s_add_u32 s49, s47, s48
    buffer_load_dwordx4 v9, s[8:11], s49 offen lds
    s_add_u32 s61, s61, 1
    s_cmp_lt_u32 s61, s57
    s_cselect_b32 s61, s61, 0
    v_mfma_f32_32x32x16_bf16 v[44:59], v[132:135], v[88:91], v[44:59]
    s_lshl_b32 s49, s60, 12
    s_add_u32 s48, s40, s49
    buffer_load_dwordx4 v[84:87], v7, s[12:15], s48 offen sc1
    v_mfma_f32_32x32x16_bf16 v[60:75], v[136:139], v[88:91], v[60:75]
    s_lshl_b32 s49, s60, 12
    s_add_u32 s48, s41, s49
    buffer_load_dwordx4 v[88:91], v7, s[12:15], s48 offen sc1
    s_add_u32 s60, s60, 1
    s_cmp_lt_u32 s60, s57
    s_cselect_b32 s60, s60, 0
    s_waitcnt vmcnt(22)
    ds_read_b64_tr_b16 v[132:133], v8 offset:6144
    ds_read_b64_tr_b16 v[134:135], v8 offset:6400
    ds_read_b64_tr_b16 v[136:137], v8 offset:7168
    ds_read_b64_tr_b16 v[138:139], v8 offset:7424
    s_waitcnt vmcnt(24) lgkmcnt(4)
    v_mfma_f32_32x32x16_bf16 v[12:27], v[140:143], v[92:95], v[12:27]
    s_add_u32 m0, s50, 4096
    s_lshl_b32 s48, s61, 16
    s_add_u32 s49, s42, s48
    buffer_load_dwordx4 v9, s[8:11], s49 offen lds
    v_mfma_f32_32x32x16_bf16 v[28:43], v[144:147], v[92:95], v[28:43]
    s_add_u32 m0, s50, 5120
    s_lshl_b32 s48, s61, 16
    s_add_u32 s49, s47, s48
    buffer_load_dwordx4 v9, s[8:11], s49 offen lds
    s_add_u32 s61, s61, 1
    s_cmp_lt_u32 s61, s57
    s_cselect_b32 s61, s61, 0
    v_mfma_f32_32x32x16_bf16 v[44:59], v[140:143], v[96:99], v[44:59]
    s_lshl_b32 s49, s60, 12
    s_add_u32 s48, s40, s49
    buffer_load_dwordx4 v[92:95], v7, s[12:15], s48 offen sc1
    v_mfma_f32_32x32x16_bf16 v[60:75], v[144:147], v[96:99], v[60:75]
    s_lshl_b32 s49, s60, 12
    s_add_u32 s48, s41, s49
    buffer_load_dwordx4 v[96:99], v7, s[12:15], s48 offen sc1
    s_add_u32 s60, s60, 1
    s_cmp_lt_u32 s60, s57
    s_cselect_b32 s60, s60, 0
    s_waitcnt vmcnt(22)
    ds_read_b64_tr_b16 v[140:141], v8 offset:8192
    ds_read_b64_tr_b16 v[142:143], v8 offset:8448
    ds_read_b64_tr_b16 v[144:145], v8 offset:9216
    ds_read_b64_tr_b16 v[146:147], v8 offset:9472
    s_waitcnt vmcnt(24) lgkmcnt(4)
    v_mfma_f32_32x32x16_bf16 v[12:27], v[132:135], v[100:103], v[12:27]
    s_add_u32 m0, s50, 6144
    s_lshl_b32 s48, s61, 16
    s_add_u32 s49, s42, s48
    buffer_load_dwordx4 v9, s[8:11], s49 offen lds
    v_mfma_f32_32x32x16_bf16 v[28:43], v[136:139], v[100:103], v[28:43]
    s_add_u32 m0, s50, 7168
    s_lshl_b32 s48, s61, 16
    s_add_u32 s49, s47, s48
    buffer_load_dwordx4 v9, s[8:11], s49 offen lds
    s_add_u32 s61, s61, 1
    s_cmp_lt_u32 s61, s57
    s_cselect_b32 s61, s61, 0
    v_mfma_f32_32x32x16_bf16 v[44:59], v[132:135], v[104:107], v[44:59]
    s_lshl_b32 s49, s60, 12
    s_add_u32 s48, s40, s49
    buffer_load_dwordx4 v[100:103], v7, s[12:15], s48 offen sc1
    v_mfma_f32_32x32x16_bf16 v[60:75], v[136:139], v[104:107], v[60:75]
    s_lshl_b32 s49, s60, 12
    s_add_u32 s48, s41, s49
    buffer_load_dwordx4 v[104:107], v7, s[12:15], s48 offen sc1
    s_add_u32 s60, s60, 1
    s_cmp_lt_u32 s60, s57
    s_cselect_b32 s60, s60, 0
    s_waitcnt vmcnt(22)
    ds_read_b64_tr_b16 v[132:133], v8 offset:10240
    ds_read_b64_tr_b16 v[134:135], v8 offset:10496
    ds_read_b64_tr_b16 v[136:137], v8 offset:11264
    ds_read_b64_tr_b16 v[138:139], v8 offset:11520
    s_waitcnt vmcnt(24) lgkmcnt(4)
    v_mfma_f32_32x32x16_bf16 v[12:27], v[140:143], v[108:111], v[12:27]
    s_add_u32 m0, s50, 8192
    s_lshl_b32 s48, s61, 16
    s_add_u32 s49, s42, s48
    buffer_load_dwordx4 v9, s[8:11], s49 offen lds
    v_mfma_f32_32x32x16_bf16 v[28:43], v[144:147], v[108:111], v[28:43]
    s_add_u32 m0, s50, 9216
    s_lshl_b32 s48, s61, 16
    s_add_u32 s49, s47, s48
    buffer_load_dwordx4 v9, s[8:11], s49 offen lds
    s_add_u32 s61, s61, 1
    s_cmp_lt_u32 s61, s57
    s_cselect_b32 s61, s61, 0
    v_mfma_f32_32x32x16_bf16 v[44:59], v[140:143], v[112:115], v[44:59]
    s_lshl_b32 s49, s60, 12
    s_add_u32 s48, s40, s49
    buffer_load_dwordx4 v[108:111], v7, s[12:15], s48 offen sc1
    v_mfma_f32_32x32x16_bf16 v[60:75], v[144:147], v[112:115], v[60:75]
    s_lshl_b32 s49, s60, 12
    s_add_u32 s48, s41, s49
    buffer_load_dwordx4 v[112:115], v7, s[12:15], s48 offen sc1
    s_add_u32 s60, s60, 1
    s_cmp_lt_u32 s60, s57
    s_cselect_b32 s60, s60, 0
    s_waitcnt vmcnt(22)
    ds_read_b64_tr_b16 v[140:141], v8 offset:12288
    ds_read_b64_tr_b16 v[142:143], v8 offset:12544
    ds_read_b64_tr_b16 v[144:145], v8 offset:13312
    ds_read_b64_tr_b16 v[146:147], v8 offset:13568
    s_waitcnt vmcnt(24) lgkmcnt(4)
    v_mfma_f32_32x32x16_bf16 v[12:27], v[132:135], v[116:119], v[12:27]
    s_add_u32 m0, s50, 10240
    s_lshl_b32 s48, s61, 16
    s_add_u32 s49, s42, s48
    buffer_load_dwordx4 v9, s[8:11], s49 offen lds
    v_mfma_f32_32x32x16_bf16 v[28:43], v[136:139], v[116:119], v[28:43]
    s_add_u32 m0, s50, 11264
    s_lshl_b32 s48, s61, 16
    s_add_u32 s49, s47, s48
    buffer_load_dwordx4 v9, s[8:11], s49 offen lds
    s_add_u32 s61, s61, 1
    s_cmp_lt_u32 s61, s57
    s_cselect_b32 s61, s61, 0
    v_mfma_f32_32x32x16_bf16 v[44:59], v[132:135], v[120:123], v[44:59]
    s_lshl_b32 s49, s60, 12
    s_add_u32 s48, s40, s49
    buffer_load_dwordx4 v[116:119], v7, s[12:15], s48 offen sc1
    v_mfma_f32_32x32x16_bf16 v[60:75], v[136:139], v[120:123], v[60:75]
    s_lshl_b32 s49, s60, 12
    s_add_u32 s48, s41, s49
    buffer_load_dwordx4 v[120:123], v7, s[12:15], s48 offen sc1
    s_add_u32 s60, s60, 1
    s_cmp_lt_u32 s60, s57
    s_cselect_b32 s60, s60, 0
    s_waitcnt vmcnt(22)
    ds_read_b64_tr_b16 v[132:133], v8 offset:0
    ds_read_b64_tr_b16 v[134:135], v8 offset:256
    ds_read_b64_tr_b16 v[136:137], v8 offset:1024
    ds_read_b64_tr_b16 v[138:139], v8 offset:1280
    s_waitcnt vmcnt(24) lgkmcnt(4)
    v_mfma_f32_32x32x16_bf16 v[12:27], v[140:143], v[124:127], v[12:27]
    s_add_u32 m0, s50, 12288
    s_lshl_b32 s48, s61, 16
    s_add_u32 s49, s42, s48
    buffer_load_dwordx4 v9, s[8:11], s49 offen lds
    v_mfma_f32_32x32x16_bf16 v[28:43], v[144:147], v[124:127], v[28:43]
    s_add_u32 m0, s50, 13312
    s_lshl_b32 s48, s61, 16
    s_add_u32 s49, s47, s48
    buffer_load_dwordx4 v9, s[8:11], s49 offen lds
    s_add_u32 s61, s61, 1
    s_cmp_lt_u32 s61, s57
    s_cselect_b32 s61, s61, 0
    v_mfma_f32_32x32x16_bf16 v[44:59], v[140:143], v[128:131], v[44:59]
    s_lshl_b32 s49, s60, 12
    s_add_u32 s48, s40, s49
    buffer_load_dwordx4 v[124:127], v7, s[12:15], s48 offen sc1
    v_mfma_f32_32x32x16_bf16 v[60:75], v[144:147], v[128:131], v[60:75]
    s_lshl_b32 s49, s60, 12
    s_add_u32 s48, s41, s49
    buffer_load_dwordx4 v[128:131], v7, s[12:15], s48 offen sc1
    s_add_u32 s60, s60, 1
    s_cmp_lt_u32 s60, s57
    s_cselect_b32 s60, s60, 0
    s_waitcnt vmcnt(22)
    ds_read_b64_tr_b16 v[140:141], v8 offset:2048
    ds_read_b64_tr_b16 v[142:143], v8 offset:2304
    ds_read_b64_tr_b16 v[144:145], v8 offset:3072
    ds_read_b64_tr_b16 v[146:147], v8 offset:3328
    s_waitcnt vmcnt(24) lgkmcnt(4)
    v_mfma_f32_32x32x16_bf16 v[12:27], v[132:135], v[76:79], v[12:27]
    s_add_u32 m0, s50, 0
    s_lshl_b32 s48, s61, 16
    s_add_u32 s49, s42, s48
    buffer_load_dwordx4 v9, s[8:11], s49 offen lds
    v_mfma_f32_32x32x16_bf16 v[28:43], v[136:139], v[76:79], v[28:43]
    s_add_u32 m0, s50, 1024
    s_lshl_b32 s48, s61, 16
    s_add_u32 s49, s47, s48
    buffer_load_dwordx4 v9, s[8:11], s49 offen lds
    s_add_u32 s61, s61, 1
    s_cmp_lt_u32 s61, s57
    s_cselect_b32 s61, s61, 0
    v_mfma_f32_32x32x16_bf16 v[44:59], v[132:135], v[80:83], v[44:59]
    s_lshl_b32 s49, s60, 12
    s_add_u32 s48, s40, s49
    buffer_load_dwordx4 v[76:79], v7, s[12:15], s48 offen sc1
    v_mfma_f32_32x32x16_bf16 v[60:75], v[136:139], v[80:83], v[60:75]
    s_lshl_b32 s49, s60, 12
    s_add_u32 s48, s41, s49
    buffer_load_dwordx4 v[80:83], v7, s[12:15], s48 offen sc1
    s_add_u32 s60, s60, 1
    s_cmp_lt_u32 s60, s57
    s_cselect_b32 s60, s60, 0
    s_waitcnt vmcnt(22)
    ds_read_b64_tr_b16 v[132:133], v8 offset:4096
    ds_read_b64_tr_b16 v[134:135], v8 offset:4352
    ds_read_b64_tr_b16 v[136:137], v8 offset:5120
    ds_read_b64_tr_b16 v[138:139], v8 offset:5376
    s_waitcnt vmcnt(24) lgkmcnt(4)
    v_mfma_f32_32x32x16_bf16 v[12:27], v[140:143], v[84:87], v[12:27]
    s_add_u32 m0, s50, 2048
    s_lshl_b32 s48, s63, 16
    s_add_u32 s49, s42, s48
    buffer_load_dwordx4 v9, s[20:23], s49 offen lds
    v_mfma_f32_32x32x16_bf16 v[28:43], v[144:147], v[84:87], v[28:43]
    s_add_u32 m0, s50, 3072
    s_lshl_b32 s48, s63, 16
    s_add_u32 s49, s47, s48
    buffer_load_dwordx4 v9, s[20:23], s49 offen lds
    s_add_u32 s63, s63, 1
    s_and_b32 s63, s63, 7
    v_mfma_f32_32x32x16_bf16 v[44:59], v[140:143], v[88:91], v[44:59]
    v_mfma_f32_32x32x16_bf16 v[60:75], v[144:147], v[88:91], v[60:75]
    s_waitcnt vmcnt(20)
    ds_read_b64_tr_b16 v[140:141], v8 offset:6144
    ds_read_b64_tr_b16 v[142:143], v8 offset:6400
    ds_read_b64_tr_b16 v[144:145], v8 offset:7168
    ds_read_b64_tr_b16 v[146:147], v8 offset:7424
    s_waitcnt vmcnt(22) lgkmcnt(4)
    v_mfma_f32_32x32x16_bf16 v[12:27], v[132:135], v[92:95], v[12:27]
    s_add_u32 m0, s50, 4096
    s_lshl_b32 s48, s63, 16
    s_add_u32 s49, s42, s48
    buffer_load_dwordx4 v9, s[20:23], s49 offen lds
    v_mfma_f32_32x32x16_bf16 v[28:43], v[136:139], v[92:95], v[28:43]
    s_add_u32 m0, s50, 5120
    s_lshl_b32 s48, s63, 16
    s_add_u32 s49, s47, s48
    buffer_load_dwordx4 v9, s[20:23], s49 offen lds
    s_add_u32 s63, s63, 1
    s_and_b32 s63, s63, 7
    v_mfma_f32_32x32x16_bf16 v[44:59], v[132:135], v[96:99], v[44:59]
    v_mfma_f32_32x32x16_bf16 v[60:75], v[136:139], v[96:99], v[60:75]
    s_waitcnt vmcnt(18)
    ds_read_b64_tr_b16 v[132:133], v8 offset:8192
    ds_read_b64_tr_b16 v[134:135], v8 offset:8448
    ds_read_b64_tr_b16 v[136:137], v8 offset:9216
    ds_read_b64_tr_b16 v[138:139], v8 offset:9472
    s_waitcnt vmcnt(20) lgkmcnt(4)
    v_mfma_f32_32x32x16_bf16 v[12:27], v[140:143], v[100:103], v[12:27]
    s_add_u32 m0, s50, 6144
    s_lshl_b32 s48, s63, 16
    s_add_u32 s49, s42, s48
    buffer_load_dwordx4 v9, s[20:23], s49 offen lds
    v_mfma_f32_32x32x16_bf16 v[28:43], v[144:147], v[100:103], v[28:43]
    s_add_u32 m0, s50, 7168
    s_lshl_b32 s48, s63, 16
    s_add_u32 s49, s47, s48
    buffer_load_dwordx4 v9, s[20:23], s49 offen lds
    s_add_u32 s63, s63, 1
    s_and_b32 s63, s63, 7
    v_mfma_f32_32x32x16_bf16 v[44:59], v[140:143], v[104:107], v[44:59]
    v_mfma_f32_32x32x16_bf16 v[60:75], v[144:147], v[104:107], v[60:75]
    s_waitcnt vmcnt(16)
    ds_read_b64_tr_b16 v[140:141], v8 offset:10240
    ds_read_b64_tr_b16 v[142:143], v8 offset:10496
    ds_read_b64_tr_b16 v[144:145], v8 offset:11264
    ds_read_b64_tr_b16 v[146:147], v8 offset:11520
    s_waitcnt vmcnt(18) lgkmcnt(4)
    v_mfma_f32_32x32x16_bf16 v[12:27], v[132:135], v[108:111], v[12:27]
    s_add_u32 m0, s50, 8192
    s_lshl_b32 s48, s63, 16
    s_add_u32 s49, s42, s48
    buffer_load_dwordx4 v9, s[20:23], s49 offen lds
    v_mfma_f32_32x32x16_bf16 v[28:43], v[136:139], v[108:111], v[28:43]
    s_add_u32 m0, s50, 9216
    s_lshl_b32 s48, s63, 16
    s_add_u32 s49, s47, s48
    buffer_load_dwordx4 v9, s[20:23], s49 offen lds
    s_add_u32 s63, s63, 1
    s_and_b32 s63, s63, 7
    v_mfma_f32_32x32x16_bf16 v[44:59], v[132:135], v[112:115], v[44:59]
    v_mfma_f32_32x32x16_bf16 v[60:75], v[136:139], v[112:115], v[60:75]
    s_waitcnt vmcnt(14)
    ds_read_b64_tr_b16 v[132:133], v8 offset:12288
    ds_read_b64_tr_b16 v[134:135], v8 offset:12544
    ds_read_b64_tr_b16 v[136:137], v8 offset:13312
    ds_read_b64_tr_b16 v[138:139], v8 offset:13568
    s_waitcnt vmcnt(16) lgkmcnt(4)
    v_mfma_f32_32x32x16_bf16 v[12:27], v[140:143], v[116:119], v[12:27]
    s_add_u32 m0, s50, 10240
    s_lshl_b32 s48, s63, 16
    s_add_u32 s49, s42, s48
    buffer_load_dwordx4 v9, s[20:23], s49 offen lds
    v_mfma_f32_32x32x16_bf16 v[28:43], v[144:147], v[116:119], v[28:43]
    s_add_u32 m0, s50, 11264
    s_lshl_b32 s48, s63, 16
    s_add_u32 s49, s47, s48
    buffer_load_dwordx4 v9, s[20:23], s49 offen lds
    s_add_u32 s63, s63, 1
    s_and_b32 s63, s63, 7
    v_mfma_f32_32x32x16_bf16 v[44:59], v[140:143], v[120:123], v[44:59]
    v_mfma_f32_32x32x16_bf16 v[60:75], v[144:147], v[120:123], v[60:75]
    s_waitcnt vmcnt(12)
    ds_read_b64_tr_b16 v[140:141], v8 offset:0
    ds_read_b64_tr_b16 v[142:143], v8 offset:256
    ds_read_b64_tr_b16 v[144:145], v8 offset:1024
    ds_read_b64_tr_b16 v[146:147], v8 offset:1280
    s_waitcnt vmcnt(14) lgkmcnt(4)
    v_mfma_f32_32x32x16_bf16 v[12:27], v[132:135], v[124:127], v[12:27]
    s_add_u32 m0, s50, 12288
    s_lshl_b32 s48, s63, 16
    s_add_u32 s49, s42, s48
    buffer_load_dwordx4 v9, s[20:23], s49 offen lds
    v_mfma_f32_32x32x16_bf16 v[28:43], v[136:139], v[124:127], v[28:43]
    s_add_u32 m0, s50, 13312
    s_lshl_b32 s48, s63, 16
    s_add_u32 s49, s47, s48
    buffer_load_dwordx4 v9, s[20:23], s49 offen lds
    s_add_u32 s63, s63, 1
    s_and_b32 s63, s63, 7
    v_mfma_f32_32x32x16_bf16 v[44:59], v[132:135], v[128:131], v[44:59]
    v_mfma_f32_32x32x16_bf16 v[60:75], v[136:139], v[128:131], v[60:75]
    s_waitcnt vmcnt(12) lgkmcnt(0)
    s_cmp_ge_u32 s36, 2
    s_cbranch_scc1 Lsk_363
    v_mfma_f32_32x32x16_bf16 v[12:27], v[140:143], v[76:79], v[12:27]
    v_mfma_f32_32x32x16_bf16 v[28:43], v[144:147], v[76:79], v[28:43]
    v_mfma_f32_32x32x16_bf16 v[44:59], v[140:143], v[80:83], v[44:59]
    v_mfma_f32_32x32x16_bf16 v[60:75], v[144:147], v[80:83], v[60:75]
Lsk_363:
    s_add_u32 m0, s50, 0
    s_lshl_b32 s48, s63, 16
    s_add_u32 s49, s42, s48
    buffer_load_dwordx4 v9, s[20:23], s49 offen lds
    s_add_u32 m0, s50, 1024
    s_lshl_b32 s48, s63, 16
    s_add_u32 s49, s47, s48
    buffer_load_dwordx4 v9, s[20:23], s49 offen lds
    s_add_u32 s63, s63, 1
    s_and_b32 s63, s63, 7
    v_mov_b32 v2, 163584
    v_mov_b32 v3, 0x10
    s_mov_b64 exec, 1
    ds_or_b32 v2, v3 offset:12
    s_mov_b64 exec, -1
Lws_364:
    ds_read_b32 v3, v2 offset:0
    s_waitcnt lgkmcnt(0)
    v_readfirstlane_b32 s46, v3
    s_and_b32 s46, s46, 0x10
    s_cmp_eq_u32 s46, 0x10
    s_cbranch_scc1 Lwd_365
    s_sleep 4
    s_add_u32 s92, s92, 1
    s_cmp_gt_u32 s92, 0x400000
    s_cbranch_scc1 k_end
    s_branch Lws_364
Lwd_365:
    s_lshl_b32 s49, s62, 12
    s_add_u32 s48, s55, s49
    buffer_load_dwordx4 v[84:87], v7, s[12:15], s48 offen sc1
    s_lshl_b32 s49, s62, 12
    s_add_u32 s48, s56, s49
    buffer_load_dwordx4 v[88:91], v7, s[12:15], s48 offen sc1
    s_add_u32 s62, s62, 1
    s_and_b32 s62, s62, 7
    s_lshl_b32 s49, s62, 12
    s_add_u32 s48, s55, s49
    buffer_load_dwordx4 v[92:95], v7, s[12:15], s48 offen sc1
    s_lshl_b32 s49, s62, 12
    s_add_u32 s48, s56, s49
    buffer_load_dwordx4 v[96:99], v7, s[12:15], s48 offen sc1
    s_add_u32 s62, s62, 1
    s_and_b32 s62, s62, 7
    s_lshl_b32 s49, s62, 12
    s_add_u32 s48, s55, s49
    buffer_load_dwordx4 v[100:103], v7, s[12:15], s48 offen sc1
    s_lshl_b32 s49, s62, 12
    s_add_u32 s48, s56, s49
    buffer_load_dwordx4 v[104:107], v7, s[12:15], s48 offen sc1
    s_add_u32 s62, s62, 1
    s_and_b32 s62, s62, 7
    s_lshl_b32 s49, s62, 12
    s_add_u32 s48, s55, s49
    buffer_load_dwordx4 v[108:111], v7, s[12:15], s48 offen sc1
    s_lshl_b32 s49, s62, 12
    s_add_u32 s48, s56, s49
    buffer_load_dwordx4 v[112:115], v7, s[12:15], s48 offen sc1
    s_add_u32 s62, s62, 1
    s_and_b32 s62, s62, 7
    s_lshl_b32 s49, s62, 12
    s_add_u32 s48, s55, s49
    buffer_load_dwordx4 v[116:119], v7, s[12:15], s48 offen sc1
    s_lshl_b32 s49, s62, 12
    s_add_u32 s48, s56, s49
    buffer_load_dwordx4 v[120:123], v7, s[12:15], s48 offen sc1
    s_add_u32 s62, s62, 1
    s_and_b32 s62, s62, 7
    s_lshl_b32 s49, s62, 12
    s_add_u32 s48, s55, s49
    buffer_load_dwordx4 v[124:127], v7, s[12:15], s48 offen sc1
    s_lshl_b32 s49, s62, 12
    s_add_u32 s48, s56, s49
    buffer_load_dwordx4 v[128:131], v7, s[12:15], s48 offen sc1
    s_add_u32 s62, s62, 1
    s_and_b32 s62, s62, 7
    s_lshl_b32 s49, s62, 12
    s_add_u32 s48, s55, s49
    buffer_load_dwordx4 v[76:79], v7, s[12:15], s48 offen sc1
    s_lshl_b32 s49, s62, 12
    s_add_u32 s48, s56, s49
    buffer_load_dwordx4 v[80:83], v7, s[12:15], s48 offen sc1
    s_add_u32 s62, s62, 1
    s_and_b32 s62, s62, 7
    s_waitcnt vmcnt(26)
    ds_read_b64_tr_b16 v[132:133], v8 offset:2048
    ds_read_b64_tr_b16 v[134:135], v8 offset:2304
    ds_read_b64_tr_b16 v[136:137], v8 offset:3072
    ds_read_b64_tr_b16 v[138:139], v8 offset:3328
    s_waitcnt vmcnt(24)
    ds_read_b64_tr_b16 v[140:141], v8 offset:4096
    ds_read_b64_tr_b16 v[142:143], v8 offset:4352
    ds_read_b64_tr_b16 v[144:145], v8 offset:5120
    ds_read_b64_tr_b16 v[146:147], v8 offset:5376
    s_waitcnt vmcnt(12) lgkmcnt(4)
    v_mfma_f32_32x32x16_bf16 v[12:27], v[132:135], v[84:87], v[12:27]
    s_add_u32 m0, s50, 2048
    s_lshl_b32 s48, s63, 16
    s_add_u32 s49, s42, s48
    buffer_load_dwordx4 v9, s[20:23], s49 offen lds
    v_mfma_f32_32x32x16_bf16 v[28:43], v[136:139], v[84:87], v[28:43]
    s_add_u32 m0, s50, 3072
    s_lshl_b32 s48, s63, 16
    s_add_u32 s49, s47, s48
    buffer_load_dwordx4 v9, s[20:23], s49 offen lds
    s_add_u32 s63, s63, 1
    s_and_b32 s63, s63, 7
    v_mfma_f32_32x32x16_bf16 v[44:59], v[132:135], v[88:91], v[44:59]
    s_lshl_b32 s49, s62, 12
    s_add_u32 s48, s55, s49
    buffer_load_dwordx4 v[84:87], v7, s[12:15], s48 offen sc1
    v_mfma_f32_32x32x16_bf16 v[60:75], v[136:139], v[88:91], v[60:75]
    s_lshl_b32 s49, s62, 12
    s_add_u32 s48, s56, s49
    buffer_load_dwordx4 v[88:91], v7, s[12:15], s48 offen sc1
    s_add_u32 s62, s62, 1
    s_and_b32 s62, s62, 7
    s_waitcnt vmcnt(26)
    ds_read_b64_tr_b16 v[132:133], v8 offset:6144
    ds_read_b64_tr_b16 v[134:135], v8 offset:6400
    ds_read_b64_tr_b16 v[136:137], v8 offset:7168
    ds_read_b64_tr_b16 v[138:139], v8 offset:7424
    s_waitcnt vmcnt(14) lgkmcnt(4)
    v_mfma_f32_32x32x16_bf16 v[12:27], v[140:143], v[92:95], v[12:27]
    v_mfma_f32_32x32x16_bf16 v[28:43], v[144:147], v[92:95], v[28:43]
    v_mfma_f32_32x32x16_bf16 v[44:59], v[140:143], v[96:99], v[44:59]
    v_mfma_f32_32x32x16_bf16 v[60:75], v[144:147], v[96:99], v[60:75]
    s_waitcnt vmcnt(24)
    ds_read_b64_tr_b16 v[140:141], v8 offset:8192
    ds_read_b64_tr_b16 v[142:143], v8 offset:8448
    ds_read_b64_tr_b16 v[144:145], v8 offset:9216
    ds_read_b64_tr_b16 v[146:147], v8 offset:9472
    s_waitcnt vmcnt(12) lgkmcnt(4)
    v_mfma_f32_32x32x16_bf16 v[12:27], v[132:135], v[100:103], v[12:27]
    v_mfma_f32_32x32x16_bf16 v[28:43], v[136:139], v[100:103], v[28:43]
    v_mfma_f32_32x32x16_bf16 v[44:59], v[132:135], v[104:107], v[44:59]
    v_mfma_f32_32x32x16_bf16 v[60:75], v[136:139], v[104:107], v[60:75]
    s_waitcnt vmcnt(22)
    ds_read_b64_tr_b16 v[132:133], v8 offset:10240
    ds_read_b64_tr_b16 v[134:135], v8 offset:10496
    ds_read_b64_tr_b16 v[136:137], v8 offset:11264
    ds_read_b64_tr_b16 v[138:139], v8 offset:11520
    s_waitcnt vmcnt(10) lgkmcnt(4)
    v_mfma_f32_32x32x16_bf16 v[12:27], v[140:143], v[108:111], v[12:27]
    v_mfma_f32_32x32x16_bf16 v[28:43], v[144:147], v[108:111], v[28:43]
    v_mfma_f32_32x32x16_bf16 v[44:59], v[140:143], v[112:115], v[44:59]
    v_mfma_f32_32x32x16_bf16 v[60:75], v[144:147], v[112:115], v[60:75]
    s_waitcnt vmcnt(20)
    ds_read_b64_tr_b16 v[140:141], v8 offset:12288
    ds_read_b64_tr_b16 v[142:143], v8 offset:12544
    ds_read_b64_tr_b16 v[144:145], v8 offset:13312
    ds_read_b64_tr_b16 v[146:147], v8 offset:13568
    s_waitcnt vmcnt(8) lgkmcnt(4)
    v_mfma_f32_32x32x16_bf16 v[12:27], v[132:135], v[116:119], v[12:27]
    v_mfma_f32_32x32x16_bf16 v[28:43], v[136:139], v[116:119], v[28:43]
    v_mfma_f32_32x32x16_bf16 v[44:59], v[132:135], v[120:123], v[44:59]
    v_mfma_f32_32x32x16_bf16 v[60:75], v[136:139], v[120:123], v[60:75]
    s_waitcnt vmcnt(18)
    ds_read_b64_tr_b16 v[132:133], v8 offset:0
    ds_read_b64_tr_b16 v[134:135], v8 offset:256
    ds_read_b64_tr_b16 v[136:137], v8 offset:1024
    ds_read_b64_tr_b16 v[138:139], v8 offset:1280
    s_waitcnt vmcnt(6) lgkmcnt(4)
    v_mfma_f32_32x32x16_bf16 v[12:27], v[140:143], v[124:127], v[12:27]
    v_mfma_f32_32x32x16_bf16 v[28:43], v[144:147], v[124:127], v[28:43]
    v_mfma_f32_32x32x16_bf16 v[44:59], v[140:143], v[128:131], v[44:59]
    v_mfma_f32_32x32x16_bf16 v[60:75], v[144:147], v[128:131], v[60:75]
    s_waitcnt vmcnt(2)
    ds_read_b64_tr_b16 v[140:141], v8 offset:2048
    ds_read_b64_tr_b16 v[142:143], v8 offset:2304
    ds_read_b64_tr_b16 v[144:145], v8 offset:3072
    ds_read_b64_tr_b16 v[146:147], v8 offset:3328
    s_waitcnt vmcnt(4) lgkmcnt(4)
    v_mfma_f32_32x32x16_bf16 v[12:27], v[132:135], v[76:79], v[12:27]
    v_mfma_f32_32x32x16_bf16 v[28:43], v[136:139], v[76:79], v[28:43]
    v_mfma_f32_32x32x16_bf16 v[44:59], v[132:135], v[80:83], v[44:59]
    v_mfma_f32_32x32x16_bf16 v[60:75], v[136:139], v[80:83], v[60:75]
    s_waitcnt vmcnt(0) lgkmcnt(0)
    v_mfma_f32_32x32x16_bf16 v[12:27], v[140:143], v[84:87], v[12:27]
    v_mfma_f32_32x32x16_bf16 v[28:43], v[144:147], v[84:87], v[28:43]
    v_mfma_f32_32x32x16_bf16 v[44:59], v[140:143], v[88:91], v[44:59]
    v_mfma_f32_32x32x16_bf16 v[60:75], v[144:147], v[88:91], v[60:75]
    v_add_u32 v4, s50, v7
    s_nop 10
    ds_write_b128 v4, v[28:31] offset:0
    ds_write_b128 v4, v[32:35] offset:1024
    ds_write_b128 v4, v[36:39] offset:2048
    ds_write_b128 v4, v[40:43] offset:3072
    ds_write_b128 v4, v[44:47] offset:4096
    ds_write_b128 v4, v[48:51] offset:5120
    ds_write_b128 v4, v[52:55] offset:6144
    ds_write_b128 v4, v[56:59] offset:7168
    ds_write_b128 v4, v[60:63] offset:8192
    ds_write_b128 v4, v[64:67] offset:9216
    ds_write_b128 v4, v[68:71] offset:10240
    ds_write_b128 v4, v[72:75] offset:11264
    s_waitcnt lgkmcnt(0)
    v_mov_b32 v2, 163648
    v_mov_b32 v3, 1
    s_waitcnt lgkmcnt(0)
    s_mov_b64 exec, 1
    ds_add_u32 v2, v3 offset:28
Lsb_366:
    ds_read_b32 v3, v2 offset:28
    s_waitcnt lgkmcnt(0)
    v_readfirstlane_b32 s46, v3
    s_cmp_ge_u32 s46, 4
    s_cbranch_scc1 Lsbd_367
    s_sleep 1
    s_add_u32 s92, s92, 1
    s_cmp_gt_u32 s92, 0x400000
    s_cbranch_scc1 k_end
    s_branch Lsb_366
Lsbd_367:
    s_mov_b64 exec, -1
    s_xor_b32 s48, s36, 1
    s_mul_i32 s48, s48, 14336
    s_add_u32 s48, s48, 98304
    v_add_u32 v5, s48, v7
    ds_read_b128 v[28:31], v5 offset:0
    ds_read_b128 v[32:35], v5 offset:1024
    ds_read_b128 v[36:39], v5 offset:2048
    ds_read_b128 v[40:43], v5 offset:3072
    s_xor_b32 s48, s36, 2
    s_mul_i32 s48, s48, 14336
    s_add_u32 s48, s48, 98304
    v_add_u32 v5, s48, v7
    ds_read_b128 v[44:47], v5 offset:4096
    ds_read_b128 v[48:51], v5 offset:5120
    ds_read_b128 v[52:55], v5 offset:6144
    ds_read_b128 v[56:59], v5 offset:7168
    s_xor_b32 s48, s36, 3
    s_mul_i32 s48, s48, 14336
    s_add_u32 s48, s48, 98304
    v_add_u32 v5, s48, v7
    ds_read_b128 v[60:63], v5 offset:8192
    ds_read_b128 v[64:67], v5 offset:9216
    ds_read_b128 v[68:71], v5 offset:10240
    ds_read_b128 v[72:75], v5 offset:11264
    s_waitcnt lgkmcnt(8)
    v_add_f32 v12, v12, v28
    v_add_f32 v13, v13, v29
    v_add_f32 v14, v14, v30
    v_add_f32 v15, v15, v31
    v_add_f32 v16, v16, v32
    v_add_f32 v17, v17, v33
    v_add_f32 v18, v18, v34
    v_add_f32 v19, v19, v35
    v_add_f32 v20, v20, v36
    v_add_f32 v21, v21, v37
    v_add_f32 v22, v22, v38
    v_add_f32 v23, v23, v39
    v_add_f32 v24, v24, v40
    v_add_f32 v25, v25, v41
    v_add_f32 v26, v26, v42
    v_add_f32 v27, v27, v43
    s_waitcnt lgkmcnt(4)
    v_add_f32 v12, v12, v44
    v_add_f32 v13, v13, v45
    v_add_f32 v14, v14, v46
    v_add_f32 v15, v15, v47
    v_add_f32 v16, v16, v48
    v_add_f32 v17, v17, v49
    v_add_f32 v18, v18, v50
    v_add_f32 v19, v19, v51
    v_add_f32 v20, v20, v52
    v_add_f32 v21, v21, v53
    v_add_f32 v22, v22, v54
    v_add_f32 v23, v23, v55
    v_add_f32 v24, v24, v56
    v_add_f32 v25, v25, v57
    v_add_f32 v26, v26, v58
    v_add_f32 v27, v27, v59
    s_waitcnt lgkmcnt(0)
    v_add_f32 v12, v12, v60
    v_add_f32 v13, v13, v61
    v_add_f32 v14, v14, v62
    v_add_f32 v15, v15, v63
    v_add_f32 v16, v16, v64
    v_add_f32 v17, v17, v65
    v_add_f32 v18, v18, v66
    v_add_f32 v19, v19, v67
    v_add_f32 v20, v20, v68
    v_add_f32 v21, v21, v69
    v_add_f32 v22, v22, v70
    v_add_f32 v23, v23, v71
    v_add_f32 v24, v24, v72
    v_add_f32 v25, v25, v73
    v_add_f32 v26, v26, v74
    v_add_f32 v27, v27, v75
    s_mov_b32 s16, s88
    s_and_b32 s17, s89, 0xffff
    s_mov_b32 s18, 0x200000
    s_mov_b32 s19, 0x20000
    v_and_b32 v148, 31, v1
    v_lshlrev_b32 v148, 10, v148
    v_lshrrev_b32 v4, 5, v1
    v_lshl_add_u32 v148, v4, 4, v148
    s_lshl_b32 s43, s37, 16
    s_lshl_b32 s44, s51, 15
    s_add_u32 s43, s43, s44
    s_lshl_b32 s44, s38, 7
    s_add_u32 s43, s43, s44
    s_lshl_b32 s44, s52, 6
    s_add_u32 s43, s43, s44
    v_cvt_pk_bf16_f32 v44, v12, v13
    v_cvt_pk_bf16_f32 v45, v14, v15
    v_cvt_pk_bf16_f32 v46, v16, v17
    v_cvt_pk_bf16_f32 v47, v18, v19
    v_cvt_pk_bf16_f32 v48, v20, v21
    v_cvt_pk_bf16_f32 v49, v22, v23
    v_cvt_pk_bf16_f32 v50, v24, v25
    v_cvt_pk_bf16_f32 v51, v26, v27
    s_nop 1
    v_permlane32_swap_b32 v44, v46
    v_permlane32_swap_b32 v45, v47
    v_permlane32_swap_b32 v48, v50
    v_permlane32_swap_b32 v49, v51
    s_nop 1
    buffer_store_dwordx4 v[44:47], v148, s[16:19], s43 offen offset:0
    buffer_store_dwordx4 v[48:51], v148, s[16:19], s43 offen offset:32
    s_endpgm
k_loader:
    s_barrier
    s_barrier
    s_barrier
    s_barrier
    s_barrier
    s_barrier
    s_barrier
    s_barrier
    s_barrier
    s_barrier
    s_and_b32 s43, s2, 7
    s_lshl_b32 s37, s43, 2
    s_lshr_b32 s43, s2, 3
    s_and_b32 s43, s43, 3
    s_add_u32 s37, s37, s43
    v_lshlrev_b32 v4, 4, v1
    s_lshl_b32 s40, s37, 10
    s_add_u32 s41, s40, 0x400000
    s_add_u32 s40, s40, 0x200000
    s_mov_b32 s42, 0
    v_mov_b32 v6, 163584
    v_mov_b32 v2, 163584
    v_mov_b32 v3, 0x1
    s_mov_b64 exec, 1
    ds_or_b32 v2, v3 offset:12
    s_mov_b64 exec, -1
Lpk_368:
    ds_read_b32 v7, v6 offset:56
    s_waitcnt lgkmcnt(0)
    v_readfirstlane_b32 s43, v7
    s_lshr_b32 s44, s43, 1
    s_and_b32 s43, s43, s44
    s_and_b32 s43, s43, 0x5555
    s_andn2_b32 s43, s43, s42
    s_cbranch_scc1 Lpkd_369
    s_sleep 1
    s_add_u32 s92, s92, 1
    s_cmp_gt_u32 s92, 0x400000
    s_cbranch_scc1 k_end
    s_branch Lpk_368
Lpkd_369:
    s_ff1_i32_b32 s47, s43
    s_bitset1_b32 s42, s47
    s_lshl_b32 s47, s47, 17
    s_add_u32 s44, s40, s47
    s_add_u32 s45, s41, s47
    s_mov_b32 m0, 0
    s_add_u32 s43, s44, 0
    buffer_load_dwordx4 v4, s[12:15], s43 offen sc1 lds
    s_mov_b32 m0, 8192
    s_add_u32 s43, s45, 0
    buffer_load_dwordx4 v4, s[12:15], s43 offen sc1 lds
    s_mov_b32 m0, 1024
    s_add_u32 s43, s44, 32768
    buffer_load_dwordx4 v4, s[12:15], s43 offen sc1 lds
    s_mov_b32 m0, 9248
    s_add_u32 s43, s45, 32768
    buffer_load_dwordx4 v4, s[12:15], s43 offen sc1 lds
    s_mov_b32 m0, 2048
    s_add_u32 s43, s44, 65536
    buffer_load_dwordx4 v4, s[12:15], s43 offen sc1 lds
    s_mov_b32 m0, 10304
    s_add_u32 s43, s45, 65536
    buffer_load_dwordx4 v4, s[12:15], s43 offen sc1 lds
    s_mov_b32 m0, 3072
    s_add_u32 s43, s44, 98304
    buffer_load_dwordx4 v4, s[12:15], s43 offen sc1 lds
    s_mov_b32 m0, 11360
    s_add_u32 s43, s45, 98304
    buffer_load_dwordx4 v4, s[12:15], s43 offen sc1 lds
    s_mov_b32 m0, 4096
    s_add_u32 s43, s44, 131072
    buffer_load_dwordx4 v4, s[12:15], s43 offen sc1 lds
    s_mov_b32 m0, 12416
    s_add_u32 s43, s45, 131072
    buffer_load_dwordx4 v4, s[12:15], s43 offen sc1 lds
    s_mov_b32 m0, 5120
    s_add_u32 s43, s44, 163840
    buffer_load_dwordx4 v4, s[12:15], s43 offen sc1 lds
    s_mov_b32 m0, 13472
    s_add_u32 s43, s45, 163840
    buffer_load_dwordx4 v4, s[12:15], s43 offen sc1 lds
    s_mov_b32 m0, 6144
    s_add_u32 s43, s44, 196608
    buffer_load_dwordx4 v4, s[12:15], s43 offen sc1 lds
    s_mov_b32 m0, 14528
    s_add_u32 s43, s45, 196608
    buffer_load_dwordx4 v4, s[12:15], s43 offen sc1 lds
    s_mov_b32 m0, 7168
    s_add_u32 s43, s44, 229376
    buffer_load_dwordx4 v4, s[12:15], s43 offen sc1 lds
    s_mov_b32 m0, 15584
    s_add_u32 s43, s45, 229376
    buffer_load_dwordx4 v4, s[12:15], s43 offen sc1 lds
    s_waitcnt vmcnt(0)
    v_mov_b32 v7, 1
    ds_write_b32 v6, v7 offset:8
Lpk_370:
    ds_read_b32 v7, v6 offset:56
    s_waitcnt lgkmcnt(0)
    v_readfirstlane_b32 s43, v7
    s_lshr_b32 s44, s43, 1
    s_and_b32 s43, s43, s44
    s_and_b32 s43, s43, 0x5555
    s_andn2_b32 s43, s43, s42
    s_cbranch_scc1 Lpkd_371
    s_sleep 1
    s_add_u32 s92, s92, 1
    s_cmp_gt_u32 s92, 0x400000
    s_cbranch_scc1 k_end
    s_branch Lpk_370
Lpkd_371:
    s_ff1_i32_b32 s47, s43
    s_bitset1_b32 s42, s47
    s_lshl_b32 s47, s47, 17
    s_add_u32 s44, s40, s47
    s_add_u32 s45, s41, s47
    s_mov_b32 m0, 16640
    s_add_u32 s43, s44, 0
    buffer_load_dwordx4 v4, s[12:15], s43 offen sc1 lds
    s_mov_b32 m0, 24832
    s_add_u32 s43, s45, 0
    buffer_load_dwordx4 v4, s[12:15], s43 offen sc1 lds
    s_mov_b32 m0, 17664
    s_add_u32 s43, s44, 32768
    buffer_load_dwordx4 v4, s[12:15], s43 offen sc1 lds
    s_mov_b32 m0, 25888
    s_add_u32 s43, s45, 32768
    buffer_load_dwordx4 v4, s[12:15], s43 offen sc1 lds
    s_mov_b32 m0, 18688
    s_add_u32 s43, s44, 65536
    buffer_load_dwordx4 v4, s[12:15], s43 offen sc1 lds
    s_mov_b32 m0, 26944
    s_add_u32 s43, s45, 65536
    buffer_load_dwordx4 v4, s[12:15], s43 offen sc1 lds
    s_mov_b32 m0, 19712
    s_add_u32 s43, s44, 98304
    buffer_load_dwordx4 v4, s[12:15], s43 offen sc1 lds
    s_mov_b32 m0, 28000
    s_add_u32 s43, s45, 98304
    buffer_load_dwordx4 v4, s[12:15], s43 offen sc1 lds
    s_mov_b32 m0, 20736
    s_add_u32 s43, s44, 131072
    buffer_load_dwordx4 v4, s[12:15], s43 offen sc1 lds
    s_mov_b32 m0, 29056
    s_add_u32 s43, s45, 131072
    buffer_load_dwordx4 v4, s[12:15], s43 offen sc1 lds
    s_mov_b32 m0, 21760
    s_add_u32 s43, s44, 163840
    buffer_load_dwordx4 v4, s[12:15], s43 offen sc1 lds
    s_mov_b32 m0, 30112
    s_add_u32 s43, s45, 163840
    buffer_load_dwordx4 v4, s[12:15], s43 offen sc1 lds
    s_mov_b32 m0, 22784
    s_add_u32 s43, s44, 196608
    buffer_load_dwordx4 v4, s[12:15], s43 offen sc1 lds
    s_mov_b32 m0, 31168
    s_add_u32 s43, s45, 196608
    buffer_load_dwordx4 v4, s[12:15], s43 offen sc1 lds
    s_mov_b32 m0, 23808
    s_add_u32 s43, s44, 229376
    buffer_load_dwordx4 v4, s[12:15], s43 offen sc1 lds
    s_mov_b32 m0, 32224
    s_add_u32 s43, s45, 229376
    buffer_load_dwordx4 v4, s[12:15], s43 offen sc1 lds
    s_waitcnt vmcnt(0)
    v_mov_b32 v7, 2
    ds_write_b32 v6, v7 offset:8
Lpk_372:
    ds_read_b32 v7, v6 offset:56
    s_waitcnt lgkmcnt(0)
    v_readfirstlane_b32 s43, v7
    s_lshr_b32 s44, s43, 1
    s_and_b32 s43, s43, s44
    s_and_b32 s43, s43, 0x5555
    s_andn2_b32 s43, s43, s42
    s_cbranch_scc1 Lpkd_373
    s_sleep 1
    s_add_u32 s92, s92, 1
    s_cmp_gt_u32 s92, 0x400000
    s_cbranch_scc1 k_end
    s_branch Lpk_372
Lpkd_373:
    s_ff1_i32_b32 s47, s43
    s_bitset1_b32 s42, s47
    s_lshl_b32 s47, s47, 17
    s_add_u32 s44, s40, s47
    s_add_u32 s45, s41, s47
    s_mov_b32 m0, 33280
    s_add_u32 s43, s44, 0
    buffer_load_dwordx4 v4, s[12:15], s43 offen sc1 lds
    s_mov_b32 m0, 41472
    s_add_u32 s43, s45, 0
    buffer_load_dwordx4 v4, s[12:15], s43 offen sc1 lds
    s_mov_b32 m0, 34304
    s_add_u32 s43, s44, 32768
    buffer_load_dwordx4 v4, s[12:15], s43 offen sc1 lds
    s_mov_b32 m0, 42528
    s_add_u32 s43, s45, 32768
    buffer_load_dwordx4 v4, s[12:15], s43 offen sc1 lds
    s_mov_b32 m0, 35328
    s_add_u32 s43, s44, 65536
    buffer_load_dwordx4 v4, s[12:15], s43 offen sc1 lds
    s_mov_b32 m0, 43584
    s_add_u32 s43, s45, 65536
    buffer_load_dwordx4 v4, s[12:15], s43 offen sc1 lds
    s_mov_b32 m0, 36352
    s_add_u32 s43, s44, 98304
    buffer_load_dwordx4 v4, s[12:15], s43 offen sc1 lds
    s_mov_b32 m0, 44640
    s_add_u32 s43, s45, 98304
    buffer_load_dwordx4 v4, s[12:15], s43 offen sc1 lds
    s_mov_b32 m0, 37376
    s_add_u32 s43, s44, 131072
    buffer_load_dwordx4 v4, s[12:15], s43 offen sc1 lds
    s_mov_b32 m0, 45696
    s_add_u32 s43, s45, 131072
    buffer_load_dwordx4 v4, s[12:15], s43 offen sc1 lds
    s_mov_b32 m0, 38400
    s_add_u32 s43, s44, 163840
    buffer_load_dwordx4 v4, s[12:15], s43 offen sc1 lds
    s_mov_b32 m0, 46752
    s_add_u32 s43, s45, 163840
    buffer_load_dwordx4 v4, s[12:15], s43 offen sc1 lds
    s_mov_b32 m0, 39424
    s_add_u32 s43, s44, 196608
    buffer_load_dwordx4 v4, s[12:15], s43 offen sc1 lds
    s_mov_b32 m0, 47808
    s_add_u32 s43, s45, 196608
    buffer_load_dwordx4 v4, s[12:15], s43 offen sc1 lds
    s_mov_b32 m0, 40448
    s_add_u32 s43, s44, 229376
    buffer_load_dwordx4 v4, s[12:15], s43 offen sc1 lds
    s_mov_b32 m0, 48864
    s_add_u32 s43, s45, 229376
    buffer_load_dwordx4 v4, s[12:15], s43 offen sc1 lds
    s_waitcnt vmcnt(0)
    v_mov_b32 v7, 3
    ds_write_b32 v6, v7 offset:8
Lpk_374:
    ds_read_b32 v7, v6 offset:56
    s_waitcnt lgkmcnt(0)
    v_readfirstlane_b32 s43, v7
    s_lshr_b32 s44, s43, 1
    s_and_b32 s43, s43, s44
    s_and_b32 s43, s43, 0x5555
    s_andn2_b32 s43, s43, s42
    s_cbranch_scc1 Lpkd_375
    s_sleep 1
    s_add_u32 s92, s92, 1
    s_cmp_gt_u32 s92, 0x400000
    s_cbranch_scc1 k_end
    s_branch Lpk_374
Lpkd_375:
    s_ff1_i32_b32 s47, s43
    s_bitset1_b32 s42, s47
    s_lshl_b32 s47, s47, 17
    s_add_u32 s44, s40, s47
    s_add_u32 s45, s41, s47
    s_mov_b32 m0, 49920
    s_add_u32 s43, s44, 0
    buffer_load_dwordx4 v4, s[12:15], s43 offen sc1 lds
    s_mov_b32 m0, 58112
    s_add_u32 s43, s45, 0
    buffer_load_dwordx4 v4, s[12:15], s43 offen sc1 lds
    s_mov_b32 m0, 50944
    s_add_u32 s43, s44, 32768
    buffer_load_dwordx4 v4, s[12:15], s43 offen sc1 lds
    s_mov_b32 m0, 59168
    s_add_u32 s43, s45, 32768
    buffer_load_dwordx4 v4, s[12:15], s43 offen sc1 lds
    s_mov_b32 m0, 51968
    s_add_u32 s43, s44, 65536
    buffer_load_dwordx4 v4, s[12:15], s43 offen sc1 lds
    s_mov_b32 m0, 60224
    s_add_u32 s43, s45, 65536
    buffer_load_dwordx4 v4, s[12:15], s43 offen sc1 lds
    s_mov_b32 m0, 52992
    s_add_u32 s43, s44, 98304
    buffer_load_dwordx4 v4, s[12:15], s43 offen sc1 lds
    s_mov_b32 m0, 61280
    s_add_u32 s43, s45, 98304
    buffer_load_dwordx4 v4, s[12:15], s43 offen sc1 lds
    s_mov_b32 m0, 54016
    s_add_u32 s43, s44, 131072
    buffer_load_dwordx4 v4, s[12:15], s43 offen sc1 lds
    s_mov_b32 m0, 62336
    s_add_u32 s43, s45, 131072
    buffer_load_dwordx4 v4, s[12:15], s43 offen sc1 lds
    s_mov_b32 m0, 55040
    s_add_u32 s43, s44, 163840
    buffer_load_dwordx4 v4, s[12:15], s43 offen sc1 lds
    s_mov_b32 m0, 63392
    s_add_u32 s43, s45, 163840
    buffer_load_dwordx4 v4, s[12:15], s43 offen sc1 lds
    s_mov_b32 m0, 56064
    s_add_u32 s43, s44, 196608
    buffer_load_dwordx4 v4, s[12:15], s43 offen sc1 lds
    s_mov_b32 m0, 64448
    s_add_u32 s43, s45, 196608
    buffer_load_dwordx4 v4, s[12:15], s43 offen sc1 lds
    s_mov_b32 m0, 57088
    s_add_u32 s43, s44, 229376
    buffer_load_dwordx4 v4, s[12:15], s43 offen sc1 lds
    s_mov_b32 m0, 65504
    s_add_u32 s43, s45, 229376
    buffer_load_dwordx4 v4, s[12:15], s43 offen sc1 lds
    v_mov_b32 v2, 163584
Lwm_376:
    ds_read_b128 v[8:11], v2 offset:32
    s_waitcnt lgkmcnt(0)
    v_min_u32 v8, v8, v9
    v_min3_u32 v8, v8, v10, v11
    s_nop 0
    v_readfirstlane_b32 s46, v8
    s_cmp_ge_u32 s46, 1
    s_cbranch_scc1 Lwmd_377
    s_sleep 16
    s_add_u32 s92, s92, 1
    s_cmp_gt_u32 s92, 0x400000
    s_cbranch_scc1 k_end
    s_branch Lwm_376
Lwmd_377:
Lpk_378:
    ds_read_b32 v7, v6 offset:56
    s_waitcnt lgkmcnt(0)
    v_readfirstlane_b32 s43, v7
    s_lshr_b32 s44, s43, 1
    s_and_b32 s43, s43, s44
    s_and_b32 s43, s43, 0x5555
    s_andn2_b32 s43, s43, s42
    s_cbranch_scc1 Lpkd_379
    s_sleep 1
    s_add_u32 s92, s92, 1
    s_cmp_gt_u32 s92, 0x400000
    s_cbranch_scc1 k_end
    s_branch Lpk_378
Lpkd_379:
    s_ff1_i32_b32 s47, s43
    s_bitset1_b32 s42, s47
    s_lshl_b32 s47, s47, 17
    s_add_u32 s44, s40, s47
    s_add_u32 s45, s41, s47
    s_mov_b32 m0, 0
    s_add_u32 s43, s44, 0
    buffer_load_dwordx4 v4, s[12:15], s43 offen sc1 lds
    s_mov_b32 m0, 8192
    s_add_u32 s43, s45, 0
    buffer_load_dwordx4 v4, s[12:15], s43 offen sc1 lds
    s_mov_b32 m0, 1024
    s_add_u32 s43, s44, 32768
    buffer_load_dwordx4 v4, s[12:15], s43 offen sc1 lds
    s_mov_b32 m0, 9248
    s_add_u32 s43, s45, 32768
    buffer_load_dwordx4 v4, s[12:15], s43 offen sc1 lds
    s_mov_b32 m0, 2048
    s_add_u32 s43, s44, 65536
    buffer_load_dwordx4 v4, s[12:15], s43 offen sc1 lds
    s_mov_b32 m0, 10304
    s_add_u32 s43, s45, 65536
    buffer_load_dwordx4 v4, s[12:15], s43 offen sc1 lds
    s_mov_b32 m0, 3072
    s_add_u32 s43, s44, 98304
    buffer_load_dwordx4 v4, s[12:15], s43 offen sc1 lds
    s_mov_b32 m0, 11360
    s_add_u32 s43, s45, 98304
    buffer_load_dwordx4 v4, s[12:15], s43 offen sc1 lds
    s_mov_b32 m0, 4096
    s_add_u32 s43, s44, 131072
    buffer_load_dwordx4 v4, s[12:15], s43 offen sc1 lds
    s_mov_b32 m0, 12416
    s_add_u32 s43, s45, 131072
    buffer_load_dwordx4 v4, s[12:15], s43 offen sc1 lds
    s_mov_b32 m0, 5120
    s_add_u32 s43, s44, 163840
    buffer_load_dwordx4 v4, s[12:15], s43 offen sc1 lds
    s_mov_b32 m0, 13472
    s_add_u32 s43, s45, 163840
    buffer_load_dwordx4 v4, s[12:15], s43 offen sc1 lds
    s_mov_b32 m0, 6144
    s_add_u32 s43, s44, 196608
    buffer_load_dwordx4 v4, s[12:15], s43 offen sc1 lds
    s_mov_b32 m0, 14528
    s_add_u32 s43, s45, 196608
    buffer_load_dwordx4 v4, s[12:15], s43 offen sc1 lds
    s_mov_b32 m0, 7168
    s_add_u32 s43, s44, 229376
    buffer_load_dwordx4 v4, s[12:15], s43 offen sc1 lds
    s_mov_b32 m0, 15584
    s_add_u32 s43, s45, 229376
    buffer_load_dwordx4 v4, s[12:15], s43 offen sc1 lds
    s_waitcnt vmcnt(16)
    v_mov_b32 v7, 4
    ds_write_b32 v6, v7 offset:8
    v_mov_b32 v2, 163584
Lwm_380:
    ds_read_b128 v[8:11], v2 offset:32
    s_waitcnt lgkmcnt(0)
    v_min_u32 v8, v8, v9
    v_min3_u32 v8, v8, v10, v11
    s_nop 0
    v_readfirstlane_b32 s46, v8
    s_cmp_ge_u32 s46, 2
    s_cbranch_scc1 Lwmd_381
    s_sleep 16
    s_add_u32 s92, s92, 1
    s_cmp_gt_u32 s92, 0x400000
    s_cbranch_scc1 k_end
    s_branch Lwm_380
Lwmd_381:
Lpk_382:
    ds_read_b32 v7, v6 offset:56
    s_waitcnt lgkmcnt(0)
    v_readfirstlane_b32 s43, v7
    s_lshr_b32 s44, s43, 1
    s_and_b32 s43, s43, s44
    s_and_b32 s43, s43, 0x5555
    s_andn2_b32 s43, s43, s42
    s_cbranch_scc1 Lpkd_383
    s_sleep 1
    s_add_u32 s92, s92, 1
    s_cmp_gt_u32 s92, 0x400000
    s_cbranch_scc1 k_end
    s_branch Lpk_382
Lpkd_383:
    s_ff1_i32_b32 s47, s43
    s_bitset1_b32 s42, s47
    s_lshl_b32 s47, s47, 17
    s_add_u32 s44, s40, s47
    s_add_u32 s45, s41, s47
    s_mov_b32 m0, 16640
    s_add_u32 s43, s44, 0
    buffer_load_dwordx4 v4, s[12:15], s43 offen sc1 lds
    s_mov_b32 m0, 24832
    s_add_u32 s43, s45, 0
    buffer_load_dwordx4 v4, s[12:15], s43 offen sc1 lds
    s_mov_b32 m0, 17664
    s_add_u32 s43, s44, 32768
    buffer_load_dwordx4 v4, s[12:15], s43 offen sc1 lds
    s_mov_b32 m0, 25888
    s_add_u32 s43, s45, 32768
    buffer_load_dwordx4 v4, s[12:15], s43 offen sc1 lds
    s_mov_b32 m0, 18688
    s_add_u32 s43, s44, 65536
    buffer_load_dwordx4 v4, s[12:15], s43 offen sc1 lds
    s_mov_b32 m0, 26944
    s_add_u32 s43, s45, 65536
    buffer_load_dwordx4 v4, s[12:15], s43 offen sc1 lds
    s_mov_b32 m0, 19712
    s_add_u32 s43, s44, 98304
    buffer_load_dwordx4 v4, s[12:15], s43 offen sc1 lds
    s_mov_b32 m0, 28000
    s_add_u32 s43, s45, 98304
    buffer_load_dwordx4 v4, s[12:15], s43 offen sc1 lds
    s_mov_b32 m0, 20736
    s_add_u32 s43, s44, 131072
    buffer_load_dwordx4 v4, s[12:15], s43 offen sc1 lds
    s_mov_b32 m0, 29056
    s_add_u32 s43, s45, 131072
    buffer_load_dwordx4 v4, s[12:15], s43 offen sc1 lds
    s_mov_b32 m0, 21760
    s_add_u32 s43, s44, 163840
    buffer_load_dwordx4 v4, s[12:15], s43 offen sc1 lds
    s_mov_b32 m0, 30112
    s_add_u32 s43, s45, 163840
    buffer_load_dwordx4 v4, s[12:15], s43 offen sc1 lds
    s_mov_b32 m0, 22784
    s_add_u32 s43, s44, 196608
    buffer_load_dwordx4 v4, s[12:15], s43 offen sc1 lds
    s_mov_b32 m0, 31168
    s_add_u32 s43, s45, 196608
    buffer_load_dwordx4 v4, s[12:15], s43 offen sc1 lds
    s_mov_b32 m0, 23808
    s_add_u32 s43, s44, 229376
    buffer_load_dwordx4 v4, s[12:15], s43 offen sc1 lds
    s_mov_b32 m0, 32224
    s_add_u32 s43, s45, 229376
    buffer_load_dwordx4 v4, s[12:15], s43 offen sc1 lds
    s_waitcnt vmcnt(16)
    v_mov_b32 v7, 5
    ds_write_b32 v6, v7 offset:8
    v_mov_b32 v2, 163584
Lwm_384:
    ds_read_b128 v[8:11], v2 offset:32
    s_waitcnt lgkmcnt(0)
    v_min_u32 v8, v8, v9
    v_min3_u32 v8, v8, v10, v11
    s_nop 0
    v_readfirstlane_b32 s46, v8
    s_cmp_ge_u32 s46, 3
    s_cbranch_scc1 Lwmd_385
    s_sleep 16
    s_add_u32 s92, s92, 1
    s_cmp_gt_u32 s92, 0x400000
    s_cbranch_scc1 k_end
    s_branch Lwm_384
Lwmd_385:
Lpk_386:
    ds_read_b32 v7, v6 offset:56
    s_waitcnt lgkmcnt(0)
    v_readfirstlane_b32 s43, v7
    s_lshr_b32 s44, s43, 1
    s_and_b32 s43, s43, s44
    s_and_b32 s43, s43, 0x5555
    s_andn2_b32 s43, s43, s42
    s_cbranch_scc1 Lpkd_387
    s_sleep 1
    s_add_u32 s92, s92, 1
    s_cmp_gt_u32 s92, 0x400000
    s_cbranch_scc1 k_end
    s_branch Lpk_386
Lpkd_387:
    s_ff1_i32_b32 s47, s43
    s_bitset1_b32 s42, s47
    s_lshl_b32 s47, s47, 17
    s_add_u32 s44, s40, s47
    s_add_u32 s45, s41, s47
    s_mov_b32 m0, 33280
    s_add_u32 s43, s44, 0
    buffer_load_dwordx4 v4, s[12:15], s43 offen sc1 lds
    s_mov_b32 m0, 41472
    s_add_u32 s43, s45, 0
    buffer_load_dwordx4 v4, s[12:15], s43 offen sc1 lds
    s_mov_b32 m0, 34304
    s_add_u32 s43, s44, 32768
    buffer_load_dwordx4 v4, s[12:15], s43 offen sc1 lds
    s_mov_b32 m0, 42528
    s_add_u32 s43, s45, 32768
    buffer_load_dwordx4 v4, s[12:15], s43 offen sc1 lds
    s_mov_b32 m0, 35328
    s_add_u32 s43, s44, 65536
    buffer_load_dwordx4 v4, s[12:15], s43 offen sc1 lds
    s_mov_b32 m0, 43584
    s_add_u32 s43, s45, 65536
    buffer_load_dwordx4 v4, s[12:15], s43 offen sc1 lds
    s_mov_b32 m0, 36352
    s_add_u32 s43, s44, 98304
    buffer_load_dwordx4 v4, s[12:15], s43 offen sc1 lds
    s_mov_b32 m0, 44640
    s_add_u32 s43, s45, 98304
    buffer_load_dwordx4 v4, s[12:15], s43 offen sc1 lds
    s_mov_b32 m0, 37376
    s_add_u32 s43, s44, 131072
    buffer_load_dwordx4 v4, s[12:15], s43 offen sc1 lds
    s_mov_b32 m0, 45696
    s_add_u32 s43, s45, 131072
    buffer_load_dwordx4 v4, s[12:15], s43 offen sc1 lds
    s_mov_b32 m0, 38400
    s_add_u32 s43, s44, 163840
    buffer_load_dwordx4 v4, s[12:15], s43 offen sc1 lds
    s_mov_b32 m0, 46752
    s_add_u32 s43, s45, 163840
    buffer_load_dwordx4 v4, s[12:15], s43 offen sc1 lds
    s_mov_b32 m0, 39424
    s_add_u32 s43, s44, 196608
    buffer_load_dwordx4 v4, s[12:15], s43 offen sc1 lds
    s_mov_b32 m0, 47808
    s_add_u32 s43, s45, 196608
    buffer_load_dwordx4 v4, s[12:15], s43 offen sc1 lds
    s_mov_b32 m0, 40448
    s_add_u32 s43, s44, 229376
    buffer_load_dwordx4 v4, s[12:15], s43 offen sc1 lds
    s_mov_b32 m0, 48864
    s_add_u32 s43, s45, 229376
    buffer_load_dwordx4 v4, s[12:15], s43 offen sc1 lds
    s_waitcnt vmcnt(16)
    v_mov_b32 v7, 6
    ds_write_b32 v6, v7 offset:8
    v_mov_b32 v2, 163584
Lwm_388:
    ds_read_b128 v[8:11], v2 offset:32
    s_waitcnt lgkmcnt(0)
    v_min_u32 v8, v8, v9
    v_min3_u32 v8, v8, v10, v11
    s_nop 0
    v_readfirstlane_b32 s46, v8
    s_cmp_ge_u32 s46, 4
    s_cbranch_scc1 Lwmd_389
    s_sleep 16
    s_add_u32 s92, s92, 1
    s_cmp_gt_u32 s92, 0x400000
    s_cbranch_scc1 k_end
    s_branch Lwm_388
Lwmd_389:
Lpk_390:
    ds_read_b32 v7, v6 offset:56
    s_waitcnt lgkmcnt(0)
    v_readfirstlane_b32 s43, v7
    s_lshr_b32 s44, s43, 1
    s_and_b32 s43, s43, s44
    s_and_b32 s43, s43, 0x5555
    s_andn2_b32 s43, s43, s42
    s_cbranch_scc1 Lpkd_391
    s_sleep 1
    s_add_u32 s92, s92, 1
    s_cmp_gt_u32 s92, 0x400000
    s_cbranch_scc1 k_end
    s_branch Lpk_390
Lpkd_391:
    s_ff1_i32_b32 s47, s43
    s_bitset1_b32 s42, s47
    s_lshl_b32 s47, s47, 17
    s_add_u32 s44, s40, s47
    s_add_u32 s45, s41, s47
    s_mov_b32 m0, 49920
    s_add_u32 s43, s44, 0
    buffer_load_dwordx4 v4, s[12:15], s43 offen sc1 lds
    s_mov_b32 m0, 58112
    s_add_u32 s43, s45, 0
    buffer_load_dwordx4 v4, s[12:15], s43 offen sc1 lds
    s_mov_b32 m0, 50944
    s_add_u32 s43, s44, 32768
    buffer_load_dwordx4 v4, s[12:15], s43 offen sc1 lds
    s_mov_b32 m0, 59168
    s_add_u32 s43, s45, 32768
    buffer_load_dwordx4 v4, s[12:15], s43 offen sc1 lds
    s_mov_b32 m0, 51968
    s_add_u32 s43, s44, 65536
    buffer_load_dwordx4 v4, s[12:15], s43 offen sc1 lds
    s_mov_b32 m0, 60224
    s_add_u32 s43, s45, 65536
    buffer_load_dwordx4 v4, s[12:15], s43 offen sc1 lds
    s_mov_b32 m0, 52992
    s_add_u32 s43, s44, 98304
    buffer_load_dwordx4 v4, s[12:15], s43 offen sc1 lds
    s_mov_b32 m0, 61280
    s_add_u32 s43, s45, 98304
    buffer_load_dwordx4 v4, s[12:15], s43 offen sc1 lds
    s_mov_b32 m0, 54016
    s_add_u32 s43, s44, 131072
    buffer_load_dwordx4 v4, s[12:15], s43 offen sc1 lds
    s_mov_b32 m0, 62336
    s_add_u32 s43, s45, 131072
    buffer_load_dwordx4 v4, s[12:15], s43 offen sc1 lds
    s_mov_b32 m0, 55040
    s_add_u32 s43, s44, 163840
    buffer_load_dwordx4 v4, s[12:15], s43 offen sc1 lds
    s_mov_b32 m0, 63392
    s_add_u32 s43, s45, 163840
    buffer_load_dwordx4 v4, s[12:15], s43 offen sc1 lds
    s_mov_b32 m0, 56064
    s_add_u32 s43, s44, 196608
    buffer_load_dwordx4 v4, s[12:15], s43 offen sc1 lds
    s_mov_b32 m0, 64448
    s_add_u32 s43, s45, 196608
    buffer_load_dwordx4 v4, s[12:15], s43 offen sc1 lds
    s_mov_b32 m0, 57088
    s_add_u32 s43, s44, 229376
    buffer_load_dwordx4 v4, s[12:15], s43 offen sc1 lds
    s_mov_b32 m0, 65504
    s_add_u32 s43, s45, 229376
    buffer_load_dwordx4 v4, s[12:15], s43 offen sc1 lds
    s_waitcnt vmcnt(16)
    v_mov_b32 v7, 7
    ds_write_b32 v6, v7 offset:8
    s_waitcnt vmcnt(0)
    v_mov_b32 v7, 8
    ds_write_b32 v6, v7 offset:8
    s_waitcnt lgkmcnt(0)
    s_endpgm
k_sentinel:
    s_mov_b32 s20, s90
    s_and_b32 s21, s91, 0xffff
    s_mov_b32 s22, 0x100
    s_mov_b32 s23, 0x20000
    v_mov_b32 v7, 0
    v_mov_b32 v8, 163584
    v_lshlrev_b32 v4, 2, v1
    s_lshl_b32 s39, s2, 7
    s_add_u32 s39, s39, 0x1680000
    s_mov_b64 exec, 0xff
    buffer_store_dword v7, v4, s[12:15], s39 offen sc1
    s_mov_b64 exec, -1
    v_lshlrev_b32 v9, 4, v1
    s_and_b32 s43, s2, 7
    s_lshr_b32 s44, s2, 3
    s_lshr_b32 s45, s43, 1
    s_lshl_b32 s45, s45, 2
    s_and_b32 s46, s44, 3
    s_add_u32 s37, s45, s46
    s_and_b32 s45, s43, 1
    s_lshl_b32 s45, s45, 3
    s_lshr_b32 s46, s44, 2
    s_add_u32 s38, s45, s46
    s_mov_b32 s42, s37
    s_and_b32 s43, s2, 7
    s_lshr_b32 s44, s2, 3
    s_lshl_b32 s37, s43, 1
    s_and_b32 s45, s44, 1
    s_add_u32 s37, s37, s45
    s_lshr_b32 s38, s44, 1
    s_cmp_ge_u32 s38, 15
    s_cselect_b32 s40, 0x4, 0
    s_and_b32 s43, s2, 7
    s_lshr_b32 s44, s2, 3
    s_lshl_b32 s37, s43, 2
    s_and_b32 s45, s44, 3
    s_add_u32 s37, s37, s45
    s_lshr_b32 s38, s44, 2
    s_lshr_b32 s47, s37, 1
    v_mov_b32 v5, 0
    s_mov_b32 s46, -1
    v_writelane_b32 v5, s46, 0
    v_writelane_b32 v5, s46, 5
    v_writelane_b32 v5, s46, 6
    v_writelane_b32 v5, s46, 7
    s_sub_u32 s43, s37, 1
    s_cmp_lt_u32 s43, 30
    s_cselect_b32 s46, 8, 4
    v_writelane_b32 v5, s46, 1
    s_mov_b32 s46, 16
    v_writelane_b32 v5, s46, 2
    s_mov_b32 s46, 15
    v_writelane_b32 v5, s46, 3
    s_mov_b32 s46, 32
    v_writelane_b32 v5, s46, 4
    v_mov_b32 v6, 1
    s_barrier
    s_waitcnt vmcnt(0)
    s_barrier
    s_barrier
    s_barrier
    s_barrier
    s_barrier
    s_mov_b64 exec, 0xffff
    buffer_load_dword v6, v9, s[20:23], 0 offen sc1
    s_barrier
Lp1_392:
    s_waitcnt vmcnt(0)
    v_cmp_le_u32 vcc, 16, v6
    s_cmp_eq_u32 vcc_lo, 0xffff
    s_cbranch_scc1 Lp1ok_393
    s_add_u32 s92, s92, 1
    s_cmp_gt_u32 s92, 0x400000
    s_cbranch_scc1 k_end
    s_sleep 16
    buffer_load_dword v6, v9, s[20:23], 0 offen sc1
    s_branch Lp1_392
Lp1ok_393:
    s_barrier
    s_barrier
    s_barrier
    s_mov_b64 exec, 0xff
Lp2_394:
    s_add_u32 s92, s92, 1
    s_cmp_gt_u32 s92, 0x400000
    s_cbranch_scc1 k_end
    s_sleep 4
    ds_read_b32 v6, v8 offset:12
    s_waitcnt lgkmcnt(0)
    v_readfirstlane_b32 s41, v6
    s_andn2_b32 s41, s41, s40
    s_cbranch_scc0 Lp2_394
    buffer_load_dword v6, v4, s[12:15], s39 offen sc1
    s_waitcnt vmcnt(0)
    v_cmp_ge_u32 vcc, v6, v5
    v_readlane_b32 s43, v6, 5
    v_readlane_b32 s44, v6, 6
    v_readlane_b32 s45, v6, 7
    s_or_b32 s40, s40, vcc_lo
    s_and_b32 s44, s44, s45
    v_mov_b32 v10, s43
    v_mov_b32 v11, s44
    s_and_b32 s43, s43, s44
    s_cmp_eq_u32 s43, 0xffff
    s_cselect_b32 s43, 1, 0
    s_or_b32 s40, s40, s43
    v_mov_b32 v6, s40
    ds_write2_b32 v8, v10, v11 offset0:13 offset1:14
    ds_write_b32 v8, v6 offset:0
    s_and_b32 s43, s40, 0x1f
    s_cmp_lg_u32 s43, 0x1f
    s_cbranch_scc1 Lp2_394
    s_waitcnt lgkmcnt(0)
    s_endpgm
k_end:
    s_endpgm
.section .rodata,"a"
.p2align 6
.amdhsa_kernel parallel_sum__softmax_full_mha__mixer_s_mlp__prompt_kernel
  .amdhsa_next_free_vgpr 168
  .amdhsa_next_free_sgpr 100
  .amdhsa_accum_offset 168
  .amdhsa_group_segment_fixed_size 0
  .amdhsa_kernarg_size 88
  .amdhsa_user_sgpr_count 2
  .amdhsa_user_sgpr_kernarg_segment_ptr 1
  .amdhsa_system_sgpr_workgroup_id_x 1
.end_amdhsa_kernel
```
